```python
import torch

def _softmax(x, axis=-1):
    return torch.softmax(x, dim=axis)
def _gelu(x):
    return torch.nn.functional.gelu(x, approximate="tanh")
def _silu(x):
    return torch.nn.functional.silu(x)
def _sigmoid(x):
    return torch.sigmoid(x)
def _layernorm(x, axis=-1, eps=1e-5):
    m = x.mean(dim=axis, keepdim=True)
    v = x.var(dim=axis, keepdim=True, unbiased=False)
    return (x - m) / torch.sqrt(v + eps)
def _scatter_add(tgt, idx, src, axis=0):
    return tgt.clone().index_add_(axis, idx, src)
def _segment_sum(src, seg, n):
    out = torch.zeros((n,) + src.shape[1:], dtype=src.dtype)
    return out.index_add_(0, seg, src)
def _pad(x, pw):
    flat = tuple(v for pair in reversed(pw) for v in pair)
    return torch.nn.functional.pad(x, flat)

kernel_name = 'gated_mix__linear_kernel_hedgehog__dense_activation_mish__prompt'

def setup_inputs():

    _w = (lambda a: (lambda t: t.to(torch.bfloat16) if t.is_floating_point() else t)(torch.as_tensor(a)))
    def _A_setup():
        B, S, D, H = 1, 2048, 448, 16
        Dh = D // H
        return {
            "x": _w((lambda *s: torch.randn(*s, dtype=torch.bfloat16) * 0.05)(B, S, D)),
            "wqkv": _w((lambda *s: torch.randn(*s, dtype=torch.bfloat16) * 0.8)(D, 3 * D)),
            "w_phi": _w((lambda *s: torch.randn(*s, dtype=torch.bfloat16) * 0.8)(H, Dh, Dh) * (Dh ** -0.5)),
            "wo": _w((lambda *s: torch.randn(*s, dtype=torch.bfloat16) * 0.05)(D, D)),
        }
    _A_in = _A_setup()

    def _B_setup():
        B, S, D, F = 1, 2048, 448, 1792
        return {
            "x": _w((lambda *s: torch.randn(*s, dtype=torch.bfloat16) * 0.05)(B, S, D)),
            "w1": _w((lambda *s: torch.randn(*s, dtype=torch.bfloat16) * 6.4)(D, F) * (D ** -0.5)),
            "b1": _w((lambda *s: torch.randn(*s, dtype=torch.bfloat16) * 0.1)(F)),
            "w2": _w((lambda *s: torch.randn(*s, dtype=torch.bfloat16) * 0.1)(F, D) * (F ** -0.5)),
        }
    _B_in = _B_setup()

    return {
        "A_x": _A_in["x"],
        "A_wqkv": _A_in["wqkv"],
        "A_w_phi": _A_in["w_phi"],
        "A_wo": _A_in["wo"],
        "B_x": _B_in["x"],
        "B_w1": _B_in["w1"],
        "B_b1": _B_in["b1"],
        "B_w2": _B_in["w2"],
        "gate_w": _w((lambda *s: torch.randn(*s, dtype=torch.bfloat16) * 0.05)(448) * 16.0),
    }

def reference(A_x, A_wqkv, A_w_phi, A_wo, B_x, B_w1, B_b1, B_w2, gate_w):
    def _A_ref(x, wqkv, w_phi, wo):
        B, S, D = x.shape
        H = 16; Dh = D // H
        qkv = (lambda x, *d: x.permute(*d))((x @ wqkv).reshape(B, S, 3, H, Dh), 2, 0, 3, 1, 4)
        q, k, v = qkv[0], qkv[1], qkv[2]
        pq = torch.einsum("bhsd,hdf->bhsf", q, w_phi)
        pk = torch.einsum("bhsd,hdf->bhsf", k, w_phi)
        phi_q = torch.concatenate([_softmax(pq, axis=-1), _softmax(-pq, axis=-1)], axis=-1)
        phi_k = torch.concatenate([_softmax(pk, axis=-1), _softmax(-pk, axis=-1)], axis=-1)
        kv = torch.einsum("bhsf,bhsd->bhfd", phi_k, v)
        z  = torch.einsum("bhsf->bhf", phi_k)
        num = torch.einsum("bhqf,bhfd->bhqd", phi_q, kv)
        den = torch.einsum("bhqf,bhf->bhq", phi_q, z)[..., None] + 1e-6
        o = num / den
        return (lambda x, *d: x.permute(*d))(o, 0, 2, 1, 3).reshape(B, S, D) @ wo

    def _B_ref(x, w1, b1, w2):
        h = torch.einsum("bsd,df->bsf", x, w1) + b1
        sp = torch.log1p(torch.exp(-torch.abs(h))) + torch.where(h > 0, h, torch.zeros_like(h))
        act = h * torch.tanh(sp)
        return torch.einsum("bsf,fd->bsd", act, w2)

    x = A_x
    g = _sigmoid((x * gate_w).sum(-1, keepdims=True))
    a = _A_ref(x, A_wqkv, A_w_phi, A_wo)
    b = _B_ref(x, B_w1, B_b1, B_w2)
    return g * a + (1 - g) * b
```

```asm
; @launch grid=(256,1,1) block=(512,1,1) lds=163840
.amdgcn_target "amdgcn-amd-amdhsa--gfx950"
.text
.globl gated_mix__linear_kernel_hedgehog__dense_activation_mish__prompt_kernel
.p2align 8
.type gated_mix__linear_kernel_hedgehog__dense_activation_mish__prompt_kernel,@function
gated_mix__linear_kernel_hedgehog__dense_activation_mish__prompt_kernel:
    s_cmp_ge_u32 s2, 256
    s_cbranch_scc1 L_end
    s_getpc_b64 s[4:5]
L_pc:
    s_load_dwordx16 s[64:79], s[0:1], 0
    s_load_dwordx8 s[80:87], s[0:1], 64
    v_lshrrev_b32 v1, 6, v0
    s_lshr_b32 s94, s2, 3
    v_and_b32 v2, 1, v0
    v_readfirstlane_b32 s44, v1
    v_lshl_add_u32 v2, v1, 1, v2
    s_lshl_b32 s52, s94, 4
    v_add_lshl_u32 v2, v2, s52, 7
    v_min_u32 v2, L_codeend-L_pc-4, v2
    v_and_b32 v0, 63, v0
    global_load_dword v108, v2, s[4:5]
    s_bfe_u32 s55, s2, 0x20001
    s_lshl_b32 s53, s55, 4
    s_sub_u32 s53, s53, 16
    s_mul_i32 s54, s55, 12
    s_add_u32 s54, s54, 60
    s_cmp_lt_u32 s94, 16
    s_cselect_b32 s53, s54, s53
    s_lshl_b32 s54, s55, 2
    s_add_u32 s54, s54, 112
    s_cmp_lt_u32 s94, 4
    s_cselect_b32 s53, s54, s53
    s_add_u32 s53, s53, s94
    s_lshr_b32 s46, s53, 3
    s_and_b32 s53, s53, 7
    s_and_b32 s45, s2, 1
    s_lshl_b32 s45, s45, 3
    s_add_u32 s45, s45, s53
    s_lshl_b32 s51, s44, 10
    v_lshrrev_b32 v1, 3, v0
    s_lshl_b32 s53, s44, 3
    v_add_u32 v1, s53, v1
    v_lshrrev_b32 v2, 1, v1
    v_xor_b32 v2, v2, v0
    v_and_b32 v2, 7, v2
    v_mul_u32_u24 v1, 896, v1
    v_lshl_add_u32 v1, v2, 4, v1
    s_mul_i32 s53, s45, 114688
    v_add_u32_e64 v5, s53, v1
    s_mov_b32 s10, 1835008
    s_mov_b32 s11, 0x20000
    s_waitcnt lgkmcnt(0)
    s_mov_b32 s8, s64
    s_mov_b32 s9, s65
    s_mov_b32 s6, 0
    s_mov_b32 s7, 0
    s_add_u32 m0, s51, 98304
    s_nop 0
    buffer_load_dwordx4 v5, s[8:11], s6 offen lds
    s_add_u32 m0, s51, 106496
    s_add_u32 s52, s6, 57344
    buffer_load_dwordx4 v5, s[8:11], s52 offen lds
    s_mul_i32 s53, s46, 448
    s_and_b32 s53, s53, 0xffffff80
    s_lshl_b32 s54, s46, 7
    s_sub_u32 s54, s54, 128
    s_mul_i32 s55, s46, 384
    s_sub_u32 s55, s55, 5376
    s_cmp_lt_u32 s46, 14
    s_cselect_b32 s96, s54, s55
    s_cselect_b32 s97, 640, 0
    s_cmp_lt_u32 s46, 8
    s_cselect_b32 s96, s53, s96
    s_cselect_b32 s97, 0, s97
    s_movk_i32 s95, 2688
    s_cselect_b32 s95, 3584, s95
    s_cselect_b32 s90, 63, 15
    s_cmp_eq_u32 s46, 14
    s_cselect_b32 s90, 28, s90
    s_lshr_b32 s53, 0xa400, s46
    s_and_b32 s53, s53, 1
    s_cselect_b32 s90, 0, s90
    v_lshrrev_b32 v3, 5, v0
    s_lshl_b32 s53, s44, 1
    v_add_u32 v24, s53, v3
    v_and_b32 v25, 3, v24
    v_lshlrev_b32 v25, 2, v25
    v_and_b32 v26, 31, v0
    s_lshr_b32 s53, s44, 2
    v_xor_b32 v25, v25, v26
    v_xor_b32 v25, s53, v25
    v_mul_u32_u24 v24, s95, v24
    v_lshl_add_u32 v24, v25, 4, v24
    v_lshrrev_b32 v26, 4, v25
    v_mul_u32_u24 v26, s97, v26
    v_add3_u32 v4, v24, v26, s96
    v_cmp_ne_u32 s[56:57], s90, v25
    s_mov_b32 s15, 0x20000
    s_mul_i32 s14, s95, 448
    s_lshl_b32 s95, s95, 4
    s_waitcnt lgkmcnt(0)
    s_mov_b32 s8, s64
    s_mov_b32 s9, s65
    s_cmp_lt_u32 s46, 8
    s_cselect_b32 s12, s74, s66
    s_cselect_b32 s13, s75, s67
    s_add_u32 m0, s51, 0
    s_mov_b64 exec, s[56:57]
    buffer_load_dwordx4 v4, s[12:15], s7 offen lds
    s_mov_b64 exec, -1
    s_add_u32 s7, s7, s95
    s_add_u32 m0, s51, 8192
    s_mov_b64 exec, s[56:57]
    buffer_load_dwordx4 v4, s[12:15], s7 offen lds
    s_mov_b64 exec, -1
    s_add_u32 s7, s7, s95
    s_add_u32 m0, s51, 16384
    s_mov_b64 exec, s[56:57]
    buffer_load_dwordx4 v4, s[12:15], s7 offen lds
    s_mov_b64 exec, -1
    s_add_u32 s7, s7, s95
    s_add_u32 m0, s51, 24576
    s_mov_b64 exec, s[56:57]
    buffer_load_dwordx4 v4, s[12:15], s7 offen lds
    s_mov_b64 exec, -1
    s_load_dword s49, s[86:87], 0
    s_add_u32 s3, s46, s45
    s_mul_i32 s53, s3, 43
    s_lshr_b32 s53, s53, 8
    s_mul_i32 s53, s53, 6
    s_sub_u32 s3, s3, s53
    s_add_u32 s53, s44, s3
    s_sub_u32 s54, s53, 6
    s_cmp_ge_u32 s53, 7
    s_cselect_b32 s53, s54, s53
    s_cmp_eq_u32 s44, 0
    s_cselect_b32 s53, 0, s53
    s_lshl_b32 s53, s53, 7
    s_mul_i32 s54, s46, 448
    s_lshl_b32 s55, s44, 6
    s_add_u32 s54, s54, s55
    s_cmp_lt_u32 s46, 8
    s_cselect_b32 s53, s54, s53
    s_cselect_b32 s36, s76, s80
    s_cselect_b32 s37, s77, s81
    s_movk_i32 s38, 896
    s_cselect_b32 s38, 3584, s38
    s_mov_b32 s39, 0x20000
    v_lshlrev_b32_e64 v1, 1, v0
    buffer_load_ushort v32, v1, s[36:39], s53 offen
    s_add_u32 s6, s3, 1
    s_sub_u32 s7, s6, 6
    s_cmp_ge_u32 s6, 7
    s_cselect_b32 s6, s7, s6
    s_mul_i32 s7, s6, s95
    s_lshl_b32 s7, s7, 2
    s_lshl_b32 s6, s6, 7
    s_add_u32 m0, s51, 114688
    s_nop 0
    buffer_load_dwordx4 v5, s[8:11], s6 offen lds
    s_add_u32 m0, s51, 122880
    s_add_u32 s52, s6, 57344
    buffer_load_dwordx4 v5, s[8:11], s52 offen lds
    s_mov_b32 s16, s86
    s_mov_b32 s17, s87
    s_mov_b32 s18, 268435456
    s_mov_b32 s19, 0x20000
    s_mov_b32 s20, s78
    s_mov_b32 s21, s79
    s_mov_b32 s22, 1605632
    s_mov_b32 s23, 0x20000
    s_mov_b32 s24, s70
    s_mov_b32 s25, s71
    s_mov_b32 s26, 401408
    s_mov_b32 s27, 0x20000
    s_mov_b32 s28, s82
    s_mov_b32 s29, s83
    s_mov_b32 s30, 1835008
    s_mov_b32 s31, 0x20000
    s_mov_b32 s32, s68
    s_mov_b32 s33, s69
    s_mov_b32 s34, 25088
    s_mov_b32 s35, 0x20000
    s_lshl_b32 s52, s94, 3
    s_add_u32 s52, s52, s44
    s_mul_i32 s53, s52, 49
    s_mul_i32 s54, s52, 13
    s_and_b32 s52, s2, 7
    s_mul_i32 s55, s52, 7
    s_add_u32 s53, s53, s55
    s_lshl_b32 s55, s52, 1
    s_add_u32 s54, s54, s55
    v_min_u32 v1, 6, v0
    v_min_u32_e64 v2, 1, v0
    v_add_lshl_u32 v104, v1, s53, 7
    v_add_lshl_u32 v105, v2, s54, 7
    s_lshl_b32 s52, s2, 3
    s_add_u32 s52, s52, s44
    s_and_b32 s52, s52, 1023
    s_lshl_b32 s52, s52, 7
    s_add_u32 s52, s52, 131072
    v_mov_b32 v106, s52
    s_mov_b32 s40, 1069066811
    s_mov_b32 s41, 1069066811
    s_mov_b32 s42, 1069066811
    s_mov_b32 s43, 3216550459
    s_mov_b32 s58, 0
    s_mov_b32 s59, -1
    v_lshlrev_b32 v7, 4, v0
    v_and_b32 v1, 15, v0
    v_lshrrev_b32_e64 v30, 4, v0
    v_bfe_u32 v2, v0, 1, 3
    v_xor_b32 v2, v2, v30
    v_lshlrev_b32 v2, 4, v2
    v_lshl_add_u32 v1, v1, 7, v2
    s_and_b32 s52, s44, 3
    s_lshl_b32 s52, s52, 12
    s_cmp_lt_u32 s46, 14
    s_cselect_b32 s52, s52, 0
    s_add_u32 s52, s52, 98304
    v_add_u32 v16, s52, v1
    v_xor_b32 v17, 64, v16
    v_bfe_u32 v28, v0, 2, 2
    v_lshl_add_u32 v27, v30, 3, v28
    v_lshlrev_b32 v27, 9, v27
    v_lshlrev_b32 v28, 6, v28
    v_and_b32 v26, 16, v0
    v_or_b32 v28, v28, v26
    v_and_b32_e64 v29, 1, v0
    v_bfe_u32 v26, v0, 1, 1
    v_lshl_add_u32 v29, v29, 2, v26
    v_add_u32 v31, 2, v29
    s_cmp_ge_u32 s46, 14
    s_cbranch_scc1 L_Q
    s_sub_u32 s85, s94, 4
    s_mul_i32 s86, s85, 43
    s_lshr_b32 s86, s86, 7
    s_mul_i32 s87, s86, 3
    s_sub_u32 s48, s85, s87
    s_bfe_u32 s84, s94, 0x20002
    s_and_b32 s87, s94, 3
    s_add_u32 s87, s87, 3
    s_cmp_lt_u32 s94, 16
    s_cselect_b32 s86, s86, s84
    s_cselect_b32 s48, s48, s87
    s_mul_i32 s84, s86, 2
    s_add_u32 s48, s48, s84
    s_sub_u32 s84, s48, 7
    s_cmp_ge_u32 s48, 7
    s_cselect_b32 s48, s84, s48
    s_and_b32 s84, s2, 6
    s_lshl_b32 s47, s84, 1
    s_andn2_b32 s84, 1, s2
    s_lshl_b32 s84, s84, 4
    s_add_u32 s47, s47, s84
    s_add_u32 s47, s47, s86
    s_mul_i32 s60, s44, 200704
    s_mul_i32 s61, s44, 50176
    s_lshl_b32 s62, s44, 12
    s_lshl_b32 s63, s44, 11
    s_add_u32 s63, s63, 98304
    v_lshrrev_b32 v1, 3, v0
    v_lshlrev_b32 v2, 1, v1
    v_and_b32 v2, 4, v2
    v_and_b32 v26, 7, v0
    v_xor_b32_e64 v2, v2, v26
    v_mul_u32_u24 v1, 896, v1
    v_lshl_add_u32 v1, v2, 4, v1
    s_lshl_b32 s84, s48, 7
    v_add_u32 v6, s84, v1
    v_lshlrev_b32_e64 v1, 9, v3
    v_bfe_u32 v2, v0, 2, 2
    v_lshl_add_u32 v1, v2, 7, v1
    v_lshrrev_b32_e64 v2, 1, v2
    v_lshl_add_u32 v1, v2, 6, v1
    v_bfe_u32 v2, v0, 4, 1
    v_lshl_add_u32 v1, v2, 5, v1
    v_and_b32_e64 v2, 3, v0
    v_lshl_add_u32 v1, v2, 3, v1
    v_xor_b32 v2, 64, v1
    v_add_u32 v136, s62, v1
    v_add_u32_e64 v137, s62, v2
    v_add_u32 v138, 0x10000, v136
    v_add_u32 v139, 0x10000, v137
    v_add_u32 v140, s63, v1
    v_add_u32_e64 v141, s63, v2
    s_lshr_b32 s85, s47, 1
    s_lshl_b32 s81, s85, 3
    s_add_u32 s81, s81, s44
    s_lshl_b32 s81, s81, 7
    s_and_b32 s86, s47, 1
    s_lshl_b32 s86, s86, 3
    s_add_u32 s81, s81, s86
    s_add_u32 s81, s81, 131072
    s_mul_i32 s82, s47, 224
    s_mul_i32 s86, s44, 14
    s_add_u32 s82, s82, s86
    s_lshl_b32 s82, s82, 10
    s_add_u32 s82, s82, 4194304
    s_lshl_b32 s86, s44, 1
    s_lshl_b32 s78, s47, 5
    s_add_u32 s78, s78, s86
    s_lshl_b32 s78, s78, 11
    s_add_u32 s78, s78, 2097152
    s_add_u32 s96, s78, 32768
    s_lshl_b32 s85, s85, 4
    s_add_u32 s85, s85, s86
    s_lshl_b32 s79, s85, 7
    s_add_u32 s79, s79, 147456
    s_cmp_ge_u32 s46, 8
    s_cbranch_scc1 L_KV
    s_mul_i32 s52, s46, 448
    s_lshl_b32 s53, s44, 7
    s_add_u32 s53, s53, 147456
    v_lshl_add_u32 v107, v0, 2, s53
    s_and_b32 s53, s52, 127
    s_lshr_b32 s91, s44, 2
    s_lshl_b32 s54, s91, 9
    s_lshl_b32 s91, s91, 8
    s_add_u32 s91, s53, s91
    s_add_u32 s54, s54, 147456
    v_and_b32 v1, 16, v0
    v_lshlrev_b32_e64 v2, 2, v1
    v_lshl_add_u32 v2, v3, 4, v2
    v_add_u32 v109, s54, v2
    v_lshlrev_b32 v1, 6, v1
    v_lshl_add_u32 v1, v3, 9, v1
    v_and_b32_e64 v2, 15, v0
    v_lshl_add_u32 v18, v2, 4, v1
    v_lshl_add_u32 v26, v29, 3, s91
    v_add_u32 v25, 0, v26
    v_xor_b32 v8, v25, v28
    v_add_u32 v8, v8, v27
    v_add_u32 v25, 16, v26
    v_xor_b32 v9, v25, v28
    v_add_u32 v9, v9, v27
    v_add_u32 v25, 64, v26
    v_xor_b32 v10, v25, v28
    v_add_u32_e64 v10, v10, v27
    v_add_u32 v25, 80, v26
    v_xor_b32 v11, v25, v28
    v_add_u32 v11, v11, v27
    v_add_u32 v25, 128, v26
    v_xor_b32 v12, v25, v28
    v_add_u32 v12, v12, v27
    v_add_u32 v25, 144, v26
    v_xor_b32 v13, v25, v28
    v_add_u32 v13, v13, v27
    v_add_u32 v25, 192, v26
    v_xor_b32 v14, v25, v28
    v_add_u32 v14, v14, v27
    v_add_u32 v25, 208, v26
    v_xor_b32 v15, v25, v28
    v_add_u32 v15, v15, v27
    v_mov_b32 v20, 0.5
    v_mov_b32 v21, 0.5
    v_mov_b32 v22, 1.0
    v_mov_b32_e64 v23, 1.0
    s_lshl_b32 s98, s45, 2
    s_and_b32 s84, s44, 3
    s_add_u32 s98, s98, s84
    s_mul_i32 s98, s98, 112
    s_mul_i32 s84, s46, 14
    s_add_u32 s98, s98, s84
    s_and_b32 s84, s44, 4
    s_lshl_b32 s84, s84, 1
    s_add_u32 s98, s98, s84
    s_lshl_b32 s98, s98, 10
    s_add_u32 s98, s98, 4194304
    s_add_u32 s99, s98, 4096
    s_lshl_b32 s90, s45, 3
    s_add_u32 s90, s90, s46
    s_lshl_b32 s90, s90, 7
    s_lshl_b32 s84, s44, 2
    s_add_u32 s90, s90, s84
    s_add_u32 s90, s90, 131072
    s_cmp_ge_u32 s44, 4
    s_cbranch_scc1 L_F3
    s_add_u32 m0, s51, 32768
    s_mov_b64 exec, s[56:57]
    buffer_load_dwordx4 v4, s[12:15], s7 offen lds
    s_mov_b64 exec, -1
    s_add_u32 s7, s7, s95
    s_add_u32 m0, s51, 40960
    s_mov_b64 exec, s[56:57]
    buffer_load_dwordx4 v4, s[12:15], s7 offen lds
    s_mov_b64 exec, -1
    s_add_u32 s7, s7, s95
    s_add_u32 m0, s51, 49152
    s_mov_b64 exec, s[56:57]
    buffer_load_dwordx4 v4, s[12:15], s7 offen lds
    s_mov_b64 exec, -1
    s_add_u32 s7, s7, s95
    s_add_u32 m0, s51, 57344
    s_mov_b64 exec, s[56:57]
    buffer_load_dwordx4 v4, s[12:15], s7 offen lds
    s_mov_b64 exec, -1
    s_waitcnt lgkmcnt(0)
    s_lshr_b32 s80, s49, 16
    s_add_u32 s80, s80, 0x2a5b
    s_and_b32 s80, s80, 0x3fff
    s_lshl_b32 s50, s80, 16
    s_mul_i32 s49, s49, 1664525
    s_add_u32 s49, s49, 1013904223
    s_lshr_b32 s49, s49, 16
    s_or_b32 s49, s49, s50
    s_waitcnt vmcnt(6)
    v_lshlrev_b32_e64 v34, 16, v32
    ds_write_b32 v107, v34
    s_waitcnt lgkmcnt(0)
    s_barrier
    ds_read_b128 v[144:147], v16 offset:0
    ds_read_b128 v[148:151], v16 offset:2048
    ds_read_b64_tr_b16 v[160:161], v8 offset:0
    ds_read_b64_tr_b16 v[162:163], v8 offset:2048
    ds_read_b64_tr_b16 v[164:165], v9 offset:0
    ds_read_b64_tr_b16 v[166:167], v9 offset:2048
    ds_read_b64_tr_b16 v[168:169], v10 offset:0
    ds_read_b64_tr_b16 v[170:171], v10 offset:2048
    ds_read_b64_tr_b16 v[172:173], v11 offset:0
    ds_read_b64_tr_b16 v[174:175], v11 offset:2048
    ds_read_b128 v[192:195], v109 offset:0
    ds_read_b128 v[196:199], v109 offset:32
    ds_read_b128 v[200:203], v109 offset:0
    ds_read_b128 v[204:207], v109 offset:32
    ds_read_b128 v[208:211], v109 offset:128
    ds_read_b128 v[212:215], v109 offset:160
    ds_read_b128 v[216:219], v109 offset:128
    ds_read_b128 v[220:223], v109 offset:160
    ds_read_b128 v[224:227], v109 offset:256
    ds_read_b128 v[228:231], v109 offset:288
    ds_read_b128 v[232:235], v109 offset:256
    ds_read_b128 v[236:239], v109 offset:288
    ds_read_b128 v[240:243], v109 offset:384
    ds_read_b128 v[244:247], v109 offset:416
    ds_read_b128 v[248:251], v109 offset:384
    ds_read_b128 v[252:255], v109 offset:416
    s_waitcnt lgkmcnt(15)
    v_mfma_f32_16x16x32_bf16 v[192:195], v[160:163], v[144:147], v[192:195]
    ds_read_b64_tr_b16 v[176:177], v12 offset:0
    s_waitcnt lgkmcnt(14)
    v_mfma_f32_16x16x32_bf16 v[200:203], v[160:163], v[148:151], v[200:203]
    ds_read_b64_tr_b16 v[178:179], v12 offset:2048
    v_mfma_f32_16x16x32_bf16 v[196:199], v[164:167], v[144:147], v[196:199]
    ds_read_b64_tr_b16 v[180:181], v13 offset:0
    s_waitcnt lgkmcnt(15)
    v_mfma_f32_16x16x32_bf16 v[204:207], v[164:167], v[148:151], v[204:207]
    ds_read_b64_tr_b16 v[182:183], v13 offset:2048
    ds_read_b64_tr_b16 v[184:185], v14 offset:0
    s_waitcnt lgkmcnt(15)
    v_mfma_f32_16x16x32_bf16 v[208:211], v[168:171], v[144:147], v[208:211]
    ds_read_b64_tr_b16 v[186:187], v14 offset:2048
    s_waitcnt lgkmcnt(15)
    v_mfma_f32_16x16x32_bf16 v[216:219], v[168:171], v[148:151], v[216:219]
    ds_read_b64_tr_b16 v[188:189], v15 offset:0
    v_mfma_f32_16x16x32_bf16 v[212:215], v[172:175], v[144:147], v[212:215]
    ds_read_b64_tr_b16 v[190:191], v15 offset:2048
    s_waitcnt lgkmcnt(15)
    v_mfma_f32_16x16x32_bf16 v[220:223], v[172:175], v[148:151], v[220:223]
    s_add_u32 s6, s3, 2
    s_sub_u32 s7, s6, 6
    s_cmp_ge_u32 s6, 7
    s_cselect_b32 s6, s7, s6
    s_mul_i32 s7, s6, s95
    s_lshl_b32 s7, s7, 2
    s_lshl_b32 s6, s6, 7
    s_add_u32 m0, s51, 131072
    s_nop 0
    buffer_load_dwordx4 v5, s[8:11], s6 offen lds
    s_add_u32 m0, s51, 139264
    s_add_u32 s52, s6, 57344
    buffer_load_dwordx4 v5, s[8:11], s52 offen lds
    s_waitcnt lgkmcnt(6)
    v_mfma_f32_16x16x32_bf16 v[224:227], v[176:179], v[144:147], v[224:227]
    ds_read_b128 v[152:155], v17 offset:0
    v_mfma_f32_16x16x32_bf16 v[232:235], v[176:179], v[148:151], v[232:235]
    ds_read_b128 v[156:159], v17 offset:2048
    ds_read_b64_tr_b16 v[160:161], v8 offset:16384
    s_waitcnt lgkmcnt(7)
    v_mfma_f32_16x16x32_bf16 v[228:231], v[180:183], v[144:147], v[228:231]
    ds_read_b64_tr_b16 v[162:163], v8 offset:18432
    v_mfma_f32_16x16x32_bf16 v[236:239], v[180:183], v[148:151], v[236:239]
    ds_read_b64_tr_b16 v[164:165], v9 offset:16384
    ds_read_b64_tr_b16 v[166:167], v9 offset:18432
    s_waitcnt lgkmcnt(8)
    v_mfma_f32_16x16x32_bf16 v[240:243], v[184:187], v[144:147], v[240:243]
    ds_read_b64_tr_b16 v[168:169], v10 offset:16384
    v_mfma_f32_16x16x32_bf16 v[248:251], v[184:187], v[148:151], v[248:251]
    ds_read_b64_tr_b16 v[170:171], v10 offset:18432
    ds_read_b64_tr_b16 v[172:173], v11 offset:16384
    s_waitcnt lgkmcnt(9)
    v_mfma_f32_16x16x32_bf16 v[244:247], v[188:191], v[144:147], v[244:247]
    ds_read_b64_tr_b16 v[174:175], v11 offset:18432
    v_mfma_f32_16x16x32_bf16 v[252:255], v[188:191], v[148:151], v[252:255]
    s_add_u32 m0, s51, 65536
    s_nop 0
    buffer_load_dwordx4 v4, s[12:15], s7 offen lds
    s_add_u32 s7, s7, s95
    s_add_u32 m0, s51, 73728
    s_nop 0
    buffer_load_dwordx4 v4, s[12:15], s7 offen lds
    s_add_u32 s7, s7, s95
    s_waitcnt lgkmcnt(6)
    v_mfma_f32_16x16x32_bf16 v[192:195], v[160:163], v[152:155], v[192:195]
    ds_read_b64_tr_b16 v[176:177], v12 offset:16384
    v_mfma_f32_16x16x32_bf16 v[200:203], v[160:163], v[156:159], v[200:203]
    ds_read_b64_tr_b16 v[178:179], v12 offset:18432
    s_waitcnt lgkmcnt(6)
    v_mfma_f32_16x16x32_bf16 v[196:199], v[164:167], v[152:155], v[196:199]
    ds_read_b64_tr_b16 v[180:181], v13 offset:16384
    v_mfma_f32_16x16x32_bf16 v[204:207], v[164:167], v[156:159], v[204:207]
    ds_read_b64_tr_b16 v[182:183], v13 offset:18432
    ds_read_b64_tr_b16 v[184:185], v14 offset:16384
    s_waitcnt lgkmcnt(7)
    v_mfma_f32_16x16x32_bf16 v[208:211], v[168:171], v[152:155], v[208:211]
    ds_read_b64_tr_b16 v[186:187], v14 offset:18432
    v_mfma_f32_16x16x32_bf16 v[216:219], v[168:171], v[156:159], v[216:219]
    ds_read_b64_tr_b16 v[188:189], v15 offset:16384
    s_waitcnt lgkmcnt(7)
    v_mfma_f32_16x16x32_bf16 v[212:215], v[172:175], v[152:155], v[212:215]
    ds_read_b64_tr_b16 v[190:191], v15 offset:18432
    v_mfma_f32_16x16x32_bf16 v[220:223], v[172:175], v[156:159], v[220:223]
    s_add_u32 m0, s51, 81920
    s_nop 0
    buffer_load_dwordx4 v4, s[12:15], s7 offen lds
    s_add_u32 s7, s7, s95
    s_add_u32 m0, s51, 90112
    s_nop 0
    buffer_load_dwordx4 v4, s[12:15], s7 offen lds
    s_waitcnt lgkmcnt(0)
    v_mfma_f32_16x16x32_bf16 v[224:227], v[176:179], v[152:155], v[224:227]
    s_waitcnt vmcnt(6)
    s_barrier
    v_mfma_f32_16x16x32_bf16 v[232:235], v[176:179], v[156:159], v[232:235]
    ds_read_b128 v[144:147], v16 offset:16384
    v_mfma_f32_16x16x32_bf16 v[228:231], v[180:183], v[152:155], v[228:231]
    ds_read_b128 v[148:151], v16 offset:18432
    ds_read_b64_tr_b16 v[160:161], v8 offset:32768
    v_mfma_f32_16x16x32_bf16 v[236:239], v[180:183], v[156:159], v[236:239]
    ds_read_b64_tr_b16 v[162:163], v8 offset:34816
    ds_read_b64_tr_b16 v[164:165], v9 offset:32768
    v_mfma_f32_16x16x32_bf16 v[240:243], v[184:187], v[152:155], v[240:243]
    ds_read_b64_tr_b16 v[166:167], v9 offset:34816
    v_mfma_f32_16x16x32_bf16 v[248:251], v[184:187], v[156:159], v[248:251]
    ds_read_b64_tr_b16 v[168:169], v10 offset:32768
    ds_read_b64_tr_b16 v[170:171], v10 offset:34816
    v_mfma_f32_16x16x32_bf16 v[244:247], v[188:191], v[152:155], v[244:247]
    ds_read_b64_tr_b16 v[172:173], v11 offset:32768
    ds_read_b64_tr_b16 v[174:175], v11 offset:34816
    v_mfma_f32_16x16x32_bf16 v[252:255], v[188:191], v[156:159], v[252:255]
    s_add_u32 s6, s3, 3
    s_sub_u32 s7, s6, 6
    s_cmp_ge_u32 s6, 7
    s_cselect_b32 s6, s7, s6
    s_mul_i32 s7, s6, s95
    s_lshl_b32 s7, s7, 2
    s_lshl_b32 s6, s6, 7
    s_add_u32 m0, s51, 98304
    s_nop 0
    buffer_load_dwordx4 v5, s[8:11], s6 offen lds
    s_add_u32 m0, s51, 106496
    s_add_u32 s52, s6, 57344
    buffer_load_dwordx4 v5, s[8:11], s52 offen lds
    s_waitcnt lgkmcnt(6)
    v_mfma_f32_16x16x32_bf16 v[192:195], v[160:163], v[144:147], v[192:195]
    ds_read_b64_tr_b16 v[176:177], v12 offset:32768
    v_mfma_f32_16x16x32_bf16 v[200:203], v[160:163], v[148:151], v[200:203]
    ds_read_b64_tr_b16 v[178:179], v12 offset:34816
    s_waitcnt lgkmcnt(6)
    v_mfma_f32_16x16x32_bf16 v[196:199], v[164:167], v[144:147], v[196:199]
    ds_read_b64_tr_b16 v[180:181], v13 offset:32768
    v_mfma_f32_16x16x32_bf16 v[204:207], v[164:167], v[148:151], v[204:207]
    ds_read_b64_tr_b16 v[182:183], v13 offset:34816
    ds_read_b64_tr_b16 v[184:185], v14 offset:32768
    s_waitcnt lgkmcnt(7)
    v_mfma_f32_16x16x32_bf16 v[208:211], v[168:171], v[144:147], v[208:211]
    ds_read_b64_tr_b16 v[186:187], v14 offset:34816
    v_mfma_f32_16x16x32_bf16 v[216:219], v[168:171], v[148:151], v[216:219]
    ds_read_b64_tr_b16 v[188:189], v15 offset:32768
    s_waitcnt lgkmcnt(7)
    v_mfma_f32_16x16x32_bf16 v[212:215], v[172:175], v[144:147], v[212:215]
    ds_read_b64_tr_b16 v[190:191], v15 offset:34816
    v_mfma_f32_16x16x32_bf16 v[220:223], v[172:175], v[148:151], v[220:223]
    s_add_u32 m0, s51, 0
    s_nop 0
    buffer_load_dwordx4 v4, s[12:15], s7 offen lds
    s_add_u32 s7, s7, s95
    s_add_u32 m0, s51, 8192
    s_nop 0
    buffer_load_dwordx4 v4, s[12:15], s7 offen lds
    s_add_u32 s7, s7, s95
    s_waitcnt lgkmcnt(6)
    v_mfma_f32_16x16x32_bf16 v[224:227], v[176:179], v[144:147], v[224:227]
    ds_read_b128 v[152:155], v17 offset:16384
    v_mfma_f32_16x16x32_bf16 v[232:235], v[176:179], v[148:151], v[232:235]
    ds_read_b128 v[156:159], v17 offset:18432
    ds_read_b64_tr_b16 v[160:161], v8 offset:49152
    s_waitcnt lgkmcnt(7)
    v_mfma_f32_16x16x32_bf16 v[228:231], v[180:183], v[144:147], v[228:231]
    ds_read_b64_tr_b16 v[162:163], v8 offset:51200
    ds_read_b64_tr_b16 v[164:165], v9 offset:49152
    v_mfma_f32_16x16x32_bf16 v[236:239], v[180:183], v[148:151], v[236:239]
    ds_read_b64_tr_b16 v[166:167], v9 offset:51200
    ds_read_b64_tr_b16 v[168:169], v10 offset:49152
    s_waitcnt lgkmcnt(9)
    v_mfma_f32_16x16x32_bf16 v[240:243], v[184:187], v[144:147], v[240:243]
    ds_read_b64_tr_b16 v[170:171], v10 offset:51200
    ds_read_b64_tr_b16 v[172:173], v11 offset:49152
    v_mfma_f32_16x16x32_bf16 v[248:251], v[184:187], v[148:151], v[248:251]
    ds_read_b64_tr_b16 v[174:175], v11 offset:51200
    s_add_u32 m0, s51, 16384
    s_nop 0
    buffer_load_dwordx4 v4, s[12:15], s7 offen lds
    s_add_u32 s7, s7, s95
    s_waitcnt lgkmcnt(10)
    v_mfma_f32_16x16x32_bf16 v[244:247], v[188:191], v[144:147], v[244:247]
    s_add_u32 m0, s51, 24576
    s_nop 0
    buffer_load_dwordx4 v4, s[12:15], s7 offen lds
    buffer_load_dword v108, v104, s[20:23], 0 offen
    v_mfma_f32_16x16x32_bf16 v[252:255], v[188:191], v[148:151], v[252:255]
    buffer_load_dword v108, v105, s[24:27], 0 offen
    buffer_load_dword v108, v106, s[16:19], 0 offen
    s_waitcnt lgkmcnt(6)
    v_mfma_f32_16x16x32_bf16 v[192:195], v[160:163], v[152:155], v[192:195]
    ds_read_b64_tr_b16 v[176:177], v12 offset:49152
    v_mfma_f32_16x16x32_bf16 v[200:203], v[160:163], v[156:159], v[200:203]
    ds_read_b64_tr_b16 v[178:179], v12 offset:51200
    s_waitcnt lgkmcnt(6)
    v_mfma_f32_16x16x32_bf16 v[196:199], v[164:167], v[152:155], v[196:199]
    ds_read_b64_tr_b16 v[180:181], v13 offset:49152
    v_mfma_f32_16x16x32_bf16 v[204:207], v[164:167], v[156:159], v[204:207]
    ds_read_b64_tr_b16 v[182:183], v13 offset:51200
    s_waitcnt lgkmcnt(6)
    v_mfma_f32_16x16x32_bf16 v[208:211], v[168:171], v[152:155], v[208:211]
    ds_read_b64_tr_b16 v[184:185], v14 offset:49152
    v_mfma_f32_16x16x32_bf16 v[216:219], v[168:171], v[156:159], v[216:219]
    ds_read_b64_tr_b16 v[186:187], v14 offset:51200
    s_waitcnt lgkmcnt(6)
    v_mfma_f32_16x16x32_bf16 v[212:215], v[172:175], v[152:155], v[212:215]
    ds_read_b64_tr_b16 v[188:189], v15 offset:49152
    v_mfma_f32_16x16x32_bf16 v[220:223], v[172:175], v[156:159], v[220:223]
    ds_read_b64_tr_b16 v[190:191], v15 offset:51200
    s_waitcnt lgkmcnt(0)
    v_mfma_f32_16x16x32_bf16 v[224:227], v[176:179], v[152:155], v[224:227]
    v_xor_b32 v8, 0x10000, v8
    v_xor_b32 v9, 0x10000, v9
    v_xor_b32 v10, 0x10000, v10
    v_xor_b32 v11, 0x10000, v11
    v_xor_b32 v12, 0x10000, v12
    v_xor_b32 v13, 0x10000, v13
    v_xor_b32 v14, 0x10000, v14
    v_xor_b32 v15, 0x10000, v15
    s_waitcnt vmcnt(9)
    s_barrier
    v_mfma_f32_16x16x32_bf16 v[232:235], v[176:179], v[156:159], v[232:235]
    ds_read_b128 v[144:147], v16 offset:32768
    v_mfma_f32_16x16x32_bf16 v[228:231], v[180:183], v[152:155], v[228:231]
    ds_read_b128 v[148:151], v16 offset:34816
    ds_read_b64_tr_b16 v[160:161], v8 offset:0
    v_mfma_f32_16x16x32_bf16 v[236:239], v[180:183], v[156:159], v[236:239]
    ds_read_b64_tr_b16 v[162:163], v8 offset:2048
    ds_read_b64_tr_b16 v[164:165], v9 offset:0
    v_mfma_f32_16x16x32_bf16 v[240:243], v[184:187], v[152:155], v[240:243]
    ds_read_b64_tr_b16 v[166:167], v9 offset:2048
    v_mfma_f32_16x16x32_bf16 v[248:251], v[184:187], v[156:159], v[248:251]
    ds_read_b64_tr_b16 v[168:169], v10 offset:0
    ds_read_b64_tr_b16 v[170:171], v10 offset:2048
    v_mfma_f32_16x16x32_bf16 v[244:247], v[188:191], v[152:155], v[244:247]
    ds_read_b64_tr_b16 v[172:173], v11 offset:0
    ds_read_b64_tr_b16 v[174:175], v11 offset:2048
    v_mfma_f32_16x16x32_bf16 v[252:255], v[188:191], v[156:159], v[252:255]
    s_add_u32 s6, s3, 4
    s_sub_u32 s7, s6, 6
    s_cmp_ge_u32 s6, 7
    s_cselect_b32 s6, s7, s6
    s_mul_i32 s7, s6, s95
    s_lshl_b32 s7, s7, 2
    s_lshl_b32 s6, s6, 7
    s_add_u32 m0, s51, 114688
    s_nop 0
    buffer_load_dwordx4 v5, s[8:11], s6 offen lds
    s_add_u32 m0, s51, 122880
    s_add_u32 s52, s6, 57344
    buffer_load_dwordx4 v5, s[8:11], s52 offen lds
    s_waitcnt lgkmcnt(6)
    v_mfma_f32_16x16x32_bf16 v[192:195], v[160:163], v[144:147], v[192:195]
    ds_read_b64_tr_b16 v[176:177], v12 offset:0
    v_mfma_f32_16x16x32_bf16 v[200:203], v[160:163], v[148:151], v[200:203]
    ds_read_b64_tr_b16 v[178:179], v12 offset:2048
    s_waitcnt lgkmcnt(6)
    v_mfma_f32_16x16x32_bf16 v[196:199], v[164:167], v[144:147], v[196:199]
    ds_read_b64_tr_b16 v[180:181], v13 offset:0
    v_mfma_f32_16x16x32_bf16 v[204:207], v[164:167], v[148:151], v[204:207]
    ds_read_b64_tr_b16 v[182:183], v13 offset:2048
    ds_read_b64_tr_b16 v[184:185], v14 offset:0
    s_waitcnt lgkmcnt(7)
    v_mfma_f32_16x16x32_bf16 v[208:211], v[168:171], v[144:147], v[208:211]
    ds_read_b64_tr_b16 v[186:187], v14 offset:2048
    v_mfma_f32_16x16x32_bf16 v[216:219], v[168:171], v[148:151], v[216:219]
    ds_read_b64_tr_b16 v[188:189], v15 offset:0
    s_waitcnt lgkmcnt(7)
    v_mfma_f32_16x16x32_bf16 v[212:215], v[172:175], v[144:147], v[212:215]
    ds_read_b64_tr_b16 v[190:191], v15 offset:2048
    v_mfma_f32_16x16x32_bf16 v[220:223], v[172:175], v[148:151], v[220:223]
    s_add_u32 m0, s51, 32768
    s_nop 0
    buffer_load_dwordx4 v4, s[12:15], s7 offen lds
    s_add_u32 s7, s7, s95
    s_add_u32 m0, s51, 40960
    s_nop 0
    buffer_load_dwordx4 v4, s[12:15], s7 offen lds
    s_add_u32 s7, s7, s95
    s_waitcnt lgkmcnt(6)
    v_mfma_f32_16x16x32_bf16 v[224:227], v[176:179], v[144:147], v[224:227]
    ds_read_b128 v[152:155], v17 offset:32768
    v_mfma_f32_16x16x32_bf16 v[232:235], v[176:179], v[148:151], v[232:235]
    ds_read_b128 v[156:159], v17 offset:34816
    ds_read_b64_tr_b16 v[160:161], v8 offset:16384
    s_waitcnt lgkmcnt(7)
    v_mfma_f32_16x16x32_bf16 v[228:231], v[180:183], v[144:147], v[228:231]
    ds_read_b64_tr_b16 v[162:163], v8 offset:18432
    v_mfma_f32_16x16x32_bf16 v[236:239], v[180:183], v[148:151], v[236:239]
    ds_read_b64_tr_b16 v[164:165], v9 offset:16384
    ds_read_b64_tr_b16 v[166:167], v9 offset:18432
    s_waitcnt lgkmcnt(8)
    v_mfma_f32_16x16x32_bf16 v[240:243], v[184:187], v[144:147], v[240:243]
    ds_read_b64_tr_b16 v[168:169], v10 offset:16384
    v_mfma_f32_16x16x32_bf16 v[248:251], v[184:187], v[148:151], v[248:251]
    ds_read_b64_tr_b16 v[170:171], v10 offset:18432
    ds_read_b64_tr_b16 v[172:173], v11 offset:16384
    s_waitcnt lgkmcnt(9)
    v_mfma_f32_16x16x32_bf16 v[244:247], v[188:191], v[144:147], v[244:247]
    ds_read_b64_tr_b16 v[174:175], v11 offset:18432
    v_mfma_f32_16x16x32_bf16 v[252:255], v[188:191], v[148:151], v[252:255]
    s_add_u32 m0, s51, 49152
    s_nop 0
    buffer_load_dwordx4 v4, s[12:15], s7 offen lds
    s_add_u32 s7, s7, s95
    s_add_u32 m0, s51, 57344
    s_nop 0
    buffer_load_dwordx4 v4, s[12:15], s7 offen lds
    s_waitcnt lgkmcnt(6)
    v_mfma_f32_16x16x32_bf16 v[192:195], v[160:163], v[152:155], v[192:195]
    ds_read_b64_tr_b16 v[176:177], v12 offset:16384
    v_mfma_f32_16x16x32_bf16 v[200:203], v[160:163], v[156:159], v[200:203]
    ds_read_b64_tr_b16 v[178:179], v12 offset:18432
    s_waitcnt lgkmcnt(6)
    v_mfma_f32_16x16x32_bf16 v[196:199], v[164:167], v[152:155], v[196:199]
    ds_read_b64_tr_b16 v[180:181], v13 offset:16384
    v_mfma_f32_16x16x32_bf16 v[204:207], v[164:167], v[156:159], v[204:207]
    ds_read_b64_tr_b16 v[182:183], v13 offset:18432
    s_waitcnt lgkmcnt(6)
    v_mfma_f32_16x16x32_bf16 v[208:211], v[168:171], v[152:155], v[208:211]
    ds_read_b64_tr_b16 v[184:185], v14 offset:16384
    v_mfma_f32_16x16x32_bf16 v[216:219], v[168:171], v[156:159], v[216:219]
    ds_read_b64_tr_b16 v[186:187], v14 offset:18432
    s_waitcnt lgkmcnt(6)
    v_mfma_f32_16x16x32_bf16 v[212:215], v[172:175], v[152:155], v[212:215]
    ds_read_b64_tr_b16 v[188:189], v15 offset:16384
    v_mfma_f32_16x16x32_bf16 v[220:223], v[172:175], v[156:159], v[220:223]
    ds_read_b64_tr_b16 v[190:191], v15 offset:18432
    s_waitcnt lgkmcnt(0)
    v_mfma_f32_16x16x32_bf16 v[224:227], v[176:179], v[152:155], v[224:227]
    v_xor_b32 v8, 0x10000, v8
    v_xor_b32 v9, 0x10000, v9
    v_xor_b32 v10, 0x10000, v10
    v_xor_b32 v11, 0x10000, v11
    v_xor_b32 v12, 0x10000, v12
    v_xor_b32 v13, 0x10000, v13
    v_xor_b32 v14, 0x10000, v14
    v_xor_b32 v15, 0x10000, v15
    s_waitcnt vmcnt(9)
    s_barrier
    v_mfma_f32_16x16x32_bf16 v[232:235], v[176:179], v[156:159], v[232:235]
    ds_read_b128 v[144:147], v16 offset:0
    v_mfma_f32_16x16x32_bf16 v[228:231], v[180:183], v[152:155], v[228:231]
    ds_read_b128 v[148:151], v16 offset:2048
    ds_read_b64_tr_b16 v[160:161], v8 offset:0
    v_mfma_f32_16x16x32_bf16 v[236:239], v[180:183], v[156:159], v[236:239]
    ds_read_b64_tr_b16 v[162:163], v8 offset:2048
    ds_read_b64_tr_b16 v[164:165], v9 offset:0
    v_mfma_f32_16x16x32_bf16 v[240:243], v[184:187], v[152:155], v[240:243]
    ds_read_b64_tr_b16 v[166:167], v9 offset:2048
    v_mfma_f32_16x16x32_bf16 v[248:251], v[184:187], v[156:159], v[248:251]
    ds_read_b64_tr_b16 v[168:169], v10 offset:0
    ds_read_b64_tr_b16 v[170:171], v10 offset:2048
    v_mfma_f32_16x16x32_bf16 v[244:247], v[188:191], v[152:155], v[244:247]
    ds_read_b64_tr_b16 v[172:173], v11 offset:0
    ds_read_b64_tr_b16 v[174:175], v11 offset:2048
    v_mfma_f32_16x16x32_bf16 v[252:255], v[188:191], v[156:159], v[252:255]
    s_add_u32 m0, s63, 49152
    s_add_u32 s52, s60, 0
    buffer_load_dwordx4 v6, s[20:23], s52 offen lds
    s_add_u32 m0, s63, 50176
    s_add_u32 s52, s60, 7168
    buffer_load_dwordx4 v6, s[20:23], s52 offen lds
    s_waitcnt lgkmcnt(6)
    v_mfma_f32_16x16x32_bf16 v[192:195], v[160:163], v[144:147], v[192:195]
    ds_read_b64_tr_b16 v[176:177], v12 offset:0
    v_mfma_f32_16x16x32_bf16 v[200:203], v[160:163], v[148:151], v[200:203]
    ds_read_b64_tr_b16 v[178:179], v12 offset:2048
    s_waitcnt lgkmcnt(6)
    v_mfma_f32_16x16x32_bf16 v[196:199], v[164:167], v[144:147], v[196:199]
    ds_read_b64_tr_b16 v[180:181], v13 offset:0
    v_mfma_f32_16x16x32_bf16 v[204:207], v[164:167], v[148:151], v[204:207]
    ds_read_b64_tr_b16 v[182:183], v13 offset:2048
    ds_read_b64_tr_b16 v[184:185], v14 offset:0
    s_waitcnt lgkmcnt(7)
    v_mfma_f32_16x16x32_bf16 v[208:211], v[168:171], v[144:147], v[208:211]
    ds_read_b64_tr_b16 v[186:187], v14 offset:2048
    v_mfma_f32_16x16x32_bf16 v[216:219], v[168:171], v[148:151], v[216:219]
    ds_read_b64_tr_b16 v[188:189], v15 offset:0
    s_waitcnt lgkmcnt(7)
    v_mfma_f32_16x16x32_bf16 v[212:215], v[172:175], v[144:147], v[212:215]
    ds_read_b64_tr_b16 v[190:191], v15 offset:2048
    v_mfma_f32_16x16x32_bf16 v[220:223], v[172:175], v[148:151], v[220:223]
    s_add_u32 s6, s3, 5
    s_sub_u32 s7, s6, 6
    s_cmp_ge_u32 s6, 7
    s_cselect_b32 s6, s7, s6
    s_mul_i32 s7, s6, s95
    s_lshl_b32 s7, s7, 2
    s_lshl_b32 s6, s6, 7
    s_add_u32 m0, s51, 131072
    s_nop 0
    buffer_load_dwordx4 v5, s[8:11], s6 offen lds
    s_add_u32 m0, s51, 139264
    s_add_u32 s52, s6, 57344
    buffer_load_dwordx4 v5, s[8:11], s52 offen lds
    s_waitcnt lgkmcnt(6)
    v_mfma_f32_16x16x32_bf16 v[224:227], v[176:179], v[144:147], v[224:227]
    ds_read_b128 v[152:155], v17 offset:0
    v_mfma_f32_16x16x32_bf16 v[232:235], v[176:179], v[148:151], v[232:235]
    ds_read_b128 v[156:159], v17 offset:2048
    ds_read_b64_tr_b16 v[160:161], v8 offset:16384
    s_waitcnt lgkmcnt(7)
    v_mfma_f32_16x16x32_bf16 v[228:231], v[180:183], v[144:147], v[228:231]
    ds_read_b64_tr_b16 v[162:163], v8 offset:18432
    v_mfma_f32_16x16x32_bf16 v[236:239], v[180:183], v[148:151], v[236:239]
    ds_read_b64_tr_b16 v[164:165], v9 offset:16384
    ds_read_b64_tr_b16 v[166:167], v9 offset:18432
    s_waitcnt lgkmcnt(8)
    v_mfma_f32_16x16x32_bf16 v[240:243], v[184:187], v[144:147], v[240:243]
    ds_read_b64_tr_b16 v[168:169], v10 offset:16384
    v_mfma_f32_16x16x32_bf16 v[248:251], v[184:187], v[148:151], v[248:251]
    ds_read_b64_tr_b16 v[170:171], v10 offset:18432
    ds_read_b64_tr_b16 v[172:173], v11 offset:16384
    s_waitcnt lgkmcnt(9)
    v_mfma_f32_16x16x32_bf16 v[244:247], v[188:191], v[144:147], v[244:247]
    ds_read_b64_tr_b16 v[174:175], v11 offset:18432
    v_mfma_f32_16x16x32_bf16 v[252:255], v[188:191], v[148:151], v[252:255]
    s_add_u32 m0, s51, 65536
    s_nop 0
    buffer_load_dwordx4 v4, s[12:15], s7 offen lds
    s_add_u32 s7, s7, s95
    s_add_u32 m0, s51, 73728
    s_nop 0
    buffer_load_dwordx4 v4, s[12:15], s7 offen lds
    s_add_u32 s7, s7, s95
    s_waitcnt lgkmcnt(6)
    v_mfma_f32_16x16x32_bf16 v[192:195], v[160:163], v[152:155], v[192:195]
    ds_read_b64_tr_b16 v[176:177], v12 offset:16384
    v_mfma_f32_16x16x32_bf16 v[200:203], v[160:163], v[156:159], v[200:203]
    ds_read_b64_tr_b16 v[178:179], v12 offset:18432
    s_waitcnt lgkmcnt(6)
    v_mfma_f32_16x16x32_bf16 v[196:199], v[164:167], v[152:155], v[196:199]
    ds_read_b64_tr_b16 v[180:181], v13 offset:16384
    v_mfma_f32_16x16x32_bf16 v[204:207], v[164:167], v[156:159], v[204:207]
    ds_read_b64_tr_b16 v[182:183], v13 offset:18432
    ds_read_b64_tr_b16 v[184:185], v14 offset:16384
    s_waitcnt lgkmcnt(7)
    v_mfma_f32_16x16x32_bf16 v[208:211], v[168:171], v[152:155], v[208:211]
    ds_read_b64_tr_b16 v[186:187], v14 offset:18432
    v_mfma_f32_16x16x32_bf16 v[216:219], v[168:171], v[156:159], v[216:219]
    ds_read_b64_tr_b16 v[188:189], v15 offset:16384
    s_waitcnt lgkmcnt(7)
    v_mfma_f32_16x16x32_bf16 v[212:215], v[172:175], v[152:155], v[212:215]
    ds_read_b64_tr_b16 v[190:191], v15 offset:18432
    v_mfma_f32_16x16x32_bf16 v[220:223], v[172:175], v[156:159], v[220:223]
    s_add_u32 m0, s51, 81920
    s_nop 0
    buffer_load_dwordx4 v4, s[12:15], s7 offen lds
    s_add_u32 s7, s7, s95
    s_add_u32 m0, s51, 90112
    s_nop 0
    buffer_load_dwordx4 v4, s[12:15], s7 offen lds
    s_waitcnt vmcnt(6)
    ds_read_b64_tr_b16 v[24:25], v140 offset:49152
    ds_read_b64_tr_b16 v[26:27], v140 offset:50176
    ds_read_b64_tr_b16 v[28:29], v141 offset:49152
    ds_read_b64_tr_b16 v[30:31], v141 offset:50176
    s_waitcnt lgkmcnt(0)
    v_mfma_f32_16x16x32_bf16 v[224:227], v[176:179], v[152:155], v[224:227]
    s_barrier
    v_mfma_f32_16x16x32_bf16 v[232:235], v[176:179], v[156:159], v[232:235]
    ds_read_b128 v[144:147], v16 offset:16384
    v_mfma_f32_16x16x32_bf16 v[228:231], v[180:183], v[152:155], v[228:231]
    ds_read_b128 v[148:151], v16 offset:18432
    ds_read_b64_tr_b16 v[160:161], v8 offset:32768
    v_mfma_f32_16x16x32_bf16 v[236:239], v[180:183], v[156:159], v[236:239]
    ds_read_b64_tr_b16 v[162:163], v8 offset:34816
    ds_read_b64_tr_b16 v[164:165], v9 offset:32768
    v_mfma_f32_16x16x32_bf16 v[240:243], v[184:187], v[152:155], v[240:243]
    ds_read_b64_tr_b16 v[166:167], v9 offset:34816
    v_mfma_f32_16x16x32_bf16 v[248:251], v[184:187], v[156:159], v[248:251]
    ds_read_b64_tr_b16 v[168:169], v10 offset:32768
    ds_read_b64_tr_b16 v[170:171], v10 offset:34816
    v_mfma_f32_16x16x32_bf16 v[244:247], v[188:191], v[152:155], v[244:247]
    ds_read_b64_tr_b16 v[172:173], v11 offset:32768
    ds_read_b64_tr_b16 v[174:175], v11 offset:34816
    v_mfma_f32_16x16x32_bf16 v[252:255], v[188:191], v[156:159], v[252:255]
    s_add_u32 m0, s63, 49152
    s_add_u32 s52, s60, 14336
    buffer_load_dwordx4 v6, s[20:23], s52 offen lds
    s_add_u32 m0, s63, 50176
    s_add_u32 s52, s60, 21504
    buffer_load_dwordx4 v6, s[20:23], s52 offen lds
    s_waitcnt lgkmcnt(6)
    v_mfma_f32_16x16x32_bf16 v[192:195], v[160:163], v[144:147], v[192:195]
    ds_read_b64_tr_b16 v[176:177], v12 offset:32768
    v_mfma_f32_16x16x32_bf16 v[200:203], v[160:163], v[148:151], v[200:203]
    ds_read_b64_tr_b16 v[178:179], v12 offset:34816
    s_waitcnt lgkmcnt(6)
    v_mfma_f32_16x16x32_bf16 v[196:199], v[164:167], v[144:147], v[196:199]
    ds_read_b64_tr_b16 v[180:181], v13 offset:32768
    v_mfma_f32_16x16x32_bf16 v[204:207], v[164:167], v[148:151], v[204:207]
    ds_read_b64_tr_b16 v[182:183], v13 offset:34816
    ds_read_b64_tr_b16 v[184:185], v14 offset:32768
    s_waitcnt lgkmcnt(7)
    v_mfma_f32_16x16x32_bf16 v[208:211], v[168:171], v[144:147], v[208:211]
    ds_read_b64_tr_b16 v[186:187], v14 offset:34816
    v_mfma_f32_16x16x32_bf16 v[216:219], v[168:171], v[148:151], v[216:219]
    ds_read_b64_tr_b16 v[188:189], v15 offset:32768
    s_waitcnt lgkmcnt(7)
    v_mfma_f32_16x16x32_bf16 v[212:215], v[172:175], v[144:147], v[212:215]
    ds_read_b64_tr_b16 v[190:191], v15 offset:34816
    v_mfma_f32_16x16x32_bf16 v[220:223], v[172:175], v[148:151], v[220:223]
    s_add_u32 s6, s3, 6
    s_sub_u32 s7, s6, 6
    s_cmp_ge_u32 s6, 7
    s_cselect_b32 s6, s7, s6
    s_mul_i32 s7, s6, s95
    s_lshl_b32 s7, s7, 2
    s_lshl_b32 s6, s6, 7
    s_add_u32 m0, s51, 98304
    s_nop 0
    buffer_load_dwordx4 v5, s[8:11], s6 offen lds
    s_add_u32 m0, s51, 106496
    s_add_u32 s52, s6, 57344
    buffer_load_dwordx4 v5, s[8:11], s52 offen lds
    s_waitcnt lgkmcnt(6)
    v_mfma_f32_16x16x32_bf16 v[224:227], v[176:179], v[144:147], v[224:227]
    ds_read_b128 v[152:155], v17 offset:16384
    v_mfma_f32_16x16x32_bf16 v[232:235], v[176:179], v[148:151], v[232:235]
    ds_read_b128 v[156:159], v17 offset:18432
    ds_read_b64_tr_b16 v[160:161], v8 offset:49152
    s_waitcnt lgkmcnt(7)
    v_mfma_f32_16x16x32_bf16 v[228:231], v[180:183], v[144:147], v[228:231]
    ds_read_b64_tr_b16 v[162:163], v8 offset:51200
    v_mfma_f32_16x16x32_bf16 v[236:239], v[180:183], v[148:151], v[236:239]
    ds_read_b64_tr_b16 v[164:165], v9 offset:49152
    ds_read_b64_tr_b16 v[166:167], v9 offset:51200
    s_waitcnt lgkmcnt(8)
    v_mfma_f32_16x16x32_bf16 v[240:243], v[184:187], v[144:147], v[240:243]
    ds_read_b64_tr_b16 v[168:169], v10 offset:49152
    v_mfma_f32_16x16x32_bf16 v[248:251], v[184:187], v[148:151], v[248:251]
    ds_read_b64_tr_b16 v[170:171], v10 offset:51200
    ds_read_b64_tr_b16 v[172:173], v11 offset:49152
    s_waitcnt lgkmcnt(9)
    v_mfma_f32_16x16x32_bf16 v[244:247], v[188:191], v[144:147], v[244:247]
    ds_read_b64_tr_b16 v[174:175], v11 offset:51200
    v_mfma_f32_16x16x32_bf16 v[252:255], v[188:191], v[148:151], v[252:255]
    s_add_u32 m0, s51, 0
    s_nop 0
    buffer_load_dwordx4 v4, s[12:15], s7 offen lds
    s_add_u32 s7, s7, s95
    s_add_u32 m0, s51, 8192
    s_nop 0
    buffer_load_dwordx4 v4, s[12:15], s7 offen lds
    s_add_u32 s7, s7, s95
    s_waitcnt lgkmcnt(6)
    v_mfma_f32_16x16x32_bf16 v[192:195], v[160:163], v[152:155], v[192:195]
    ds_read_b64_tr_b16 v[176:177], v12 offset:49152
    v_mfma_f32_16x16x32_bf16 v[200:203], v[160:163], v[156:159], v[200:203]
    ds_read_b64_tr_b16 v[178:179], v12 offset:51200
    s_waitcnt lgkmcnt(6)
    v_mfma_f32_16x16x32_bf16 v[196:199], v[164:167], v[152:155], v[196:199]
    ds_read_b64_tr_b16 v[180:181], v13 offset:49152
    v_mfma_f32_16x16x32_bf16 v[204:207], v[164:167], v[156:159], v[204:207]
    ds_read_b64_tr_b16 v[182:183], v13 offset:51200
    ds_read_b64_tr_b16 v[184:185], v14 offset:49152
    s_waitcnt lgkmcnt(7)
    v_mfma_f32_16x16x32_bf16 v[208:211], v[168:171], v[152:155], v[208:211]
    ds_read_b64_tr_b16 v[186:187], v14 offset:51200
    v_mfma_f32_16x16x32_bf16 v[216:219], v[168:171], v[156:159], v[216:219]
    ds_read_b64_tr_b16 v[188:189], v15 offset:49152
    s_waitcnt lgkmcnt(7)
    v_mfma_f32_16x16x32_bf16 v[212:215], v[172:175], v[152:155], v[212:215]
    ds_read_b64_tr_b16 v[190:191], v15 offset:51200
    v_mfma_f32_16x16x32_bf16 v[220:223], v[172:175], v[156:159], v[220:223]
    s_add_u32 m0, s51, 16384
    s_nop 0
    buffer_load_dwordx4 v4, s[12:15], s7 offen lds
    s_add_u32 s7, s7, s95
    s_add_u32 m0, s51, 24576
    s_nop 0
    buffer_load_dwordx4 v4, s[12:15], s7 offen lds
    s_waitcnt vmcnt(6)
    ds_read_b64_tr_b16 v[32:33], v140 offset:49152
    ds_read_b64_tr_b16 v[34:35], v140 offset:50176
    ds_read_b64_tr_b16 v[36:37], v141 offset:49152
    ds_read_b64_tr_b16 v[38:39], v141 offset:50176
    s_waitcnt lgkmcnt(0)
    v_mfma_f32_16x16x32_bf16 v[224:227], v[176:179], v[152:155], v[224:227]
    v_xor_b32 v8, 0x10000, v8
    v_xor_b32 v9, 0x10000, v9
    v_xor_b32 v10, 0x10000, v10
    v_xor_b32 v11, 0x10000, v11
    v_xor_b32 v12, 0x10000, v12
    v_xor_b32 v13, 0x10000, v13
    v_xor_b32 v14, 0x10000, v14
    v_xor_b32 v15, 0x10000, v15
    s_barrier
    v_mfma_f32_16x16x32_bf16 v[232:235], v[176:179], v[156:159], v[232:235]
    ds_read_b128 v[144:147], v16 offset:32768
    v_mfma_f32_16x16x32_bf16 v[228:231], v[180:183], v[152:155], v[228:231]
    ds_read_b128 v[148:151], v16 offset:34816
    ds_read_b64_tr_b16 v[160:161], v8 offset:0
    v_mfma_f32_16x16x32_bf16 v[236:239], v[180:183], v[156:159], v[236:239]
    ds_read_b64_tr_b16 v[162:163], v8 offset:2048
    ds_read_b64_tr_b16 v[164:165], v9 offset:0
    v_mfma_f32_16x16x32_bf16 v[240:243], v[184:187], v[152:155], v[240:243]
    ds_read_b64_tr_b16 v[166:167], v9 offset:2048
    v_mfma_f32_16x16x32_bf16 v[248:251], v[184:187], v[156:159], v[248:251]
    ds_read_b64_tr_b16 v[168:169], v10 offset:0
    ds_read_b64_tr_b16 v[170:171], v10 offset:2048
    v_mfma_f32_16x16x32_bf16 v[244:247], v[188:191], v[152:155], v[244:247]
    ds_read_b64_tr_b16 v[172:173], v11 offset:0
    ds_read_b64_tr_b16 v[174:175], v11 offset:2048
    v_mfma_f32_16x16x32_bf16 v[252:255], v[188:191], v[156:159], v[252:255]
    s_add_u32 m0, s63, 49152
    s_add_u32 s52, s60, 28672
    buffer_load_dwordx4 v6, s[20:23], s52 offen lds
    s_add_u32 m0, s63, 50176
    s_add_u32 s52, s60, 35840
    buffer_load_dwordx4 v6, s[20:23], s52 offen lds
    s_waitcnt lgkmcnt(6)
    v_mfma_f32_16x16x32_bf16 v[192:195], v[160:163], v[144:147], v[192:195]
    ds_read_b64_tr_b16 v[176:177], v12 offset:0
    v_mfma_f32_16x16x32_bf16 v[200:203], v[160:163], v[148:151], v[200:203]
    ds_read_b64_tr_b16 v[178:179], v12 offset:2048
    s_waitcnt lgkmcnt(6)
    v_mfma_f32_16x16x32_bf16 v[196:199], v[164:167], v[144:147], v[196:199]
    ds_read_b64_tr_b16 v[180:181], v13 offset:0
    v_mfma_f32_16x16x32_bf16 v[204:207], v[164:167], v[148:151], v[204:207]
    ds_read_b64_tr_b16 v[182:183], v13 offset:2048
    ds_read_b64_tr_b16 v[184:185], v14 offset:0
    s_waitcnt lgkmcnt(7)
    v_mfma_f32_16x16x32_bf16 v[208:211], v[168:171], v[144:147], v[208:211]
    ds_read_b64_tr_b16 v[186:187], v14 offset:2048
    v_mfma_f32_16x16x32_bf16 v[216:219], v[168:171], v[148:151], v[216:219]
    ds_read_b64_tr_b16 v[188:189], v15 offset:0
    s_waitcnt lgkmcnt(7)
    v_mfma_f32_16x16x32_bf16 v[212:215], v[172:175], v[144:147], v[212:215]
    ds_read_b64_tr_b16 v[190:191], v15 offset:2048
    v_mfma_f32_16x16x32_bf16 v[220:223], v[172:175], v[148:151], v[220:223]
    s_add_u32 m0, s62, 32768
    s_add_u32 s52, s60, 43008
    buffer_load_dwordx4 v6, s[20:23], s52 offen lds
    s_add_u32 m0, s62, 33792
    s_add_u32 s52, s60, 50176
    buffer_load_dwordx4 v6, s[20:23], s52 offen lds
    s_waitcnt lgkmcnt(6)
    v_mfma_f32_16x16x32_bf16 v[224:227], v[176:179], v[144:147], v[224:227]
    ds_read_b128 v[152:155], v17 offset:32768
    v_mfma_f32_16x16x32_bf16 v[232:235], v[176:179], v[148:151], v[232:235]
    ds_read_b128 v[156:159], v17 offset:34816
    ds_read_b64_tr_b16 v[160:161], v8 offset:16384
    s_waitcnt lgkmcnt(7)
    v_mfma_f32_16x16x32_bf16 v[228:231], v[180:183], v[144:147], v[228:231]
    ds_read_b64_tr_b16 v[162:163], v8 offset:18432
    v_mfma_f32_16x16x32_bf16 v[236:239], v[180:183], v[148:151], v[236:239]
    ds_read_b64_tr_b16 v[164:165], v9 offset:16384
    ds_read_b64_tr_b16 v[166:167], v9 offset:18432
    s_waitcnt lgkmcnt(8)
    v_mfma_f32_16x16x32_bf16 v[240:243], v[184:187], v[144:147], v[240:243]
    ds_read_b64_tr_b16 v[168:169], v10 offset:16384
    v_mfma_f32_16x16x32_bf16 v[248:251], v[184:187], v[148:151], v[248:251]
    ds_read_b64_tr_b16 v[170:171], v10 offset:18432
    ds_read_b64_tr_b16 v[172:173], v11 offset:16384
    s_waitcnt lgkmcnt(9)
    v_mfma_f32_16x16x32_bf16 v[244:247], v[188:191], v[144:147], v[244:247]
    ds_read_b64_tr_b16 v[174:175], v11 offset:18432
    v_mfma_f32_16x16x32_bf16 v[252:255], v[188:191], v[148:151], v[252:255]
    s_add_u32 m0, s62, 34816
    s_add_u32 s52, s60, 57344
    buffer_load_dwordx4 v6, s[20:23], s52 offen lds
    s_add_u32 m0, s62, 35840
    s_add_u32 s52, s60, 64512
    buffer_load_dwordx4 v6, s[20:23], s52 offen lds
    s_waitcnt lgkmcnt(6)
    v_mfma_f32_16x16x32_bf16 v[192:195], v[160:163], v[152:155], v[192:195]
    ds_read_b64_tr_b16 v[176:177], v12 offset:16384
    v_mfma_f32_16x16x32_bf16 v[200:203], v[160:163], v[156:159], v[200:203]
    ds_read_b64_tr_b16 v[178:179], v12 offset:18432
    s_waitcnt lgkmcnt(6)
    v_mfma_f32_16x16x32_bf16 v[196:199], v[164:167], v[152:155], v[196:199]
    ds_read_b64_tr_b16 v[180:181], v13 offset:16384
    v_mfma_f32_16x16x32_bf16 v[204:207], v[164:167], v[156:159], v[204:207]
    ds_read_b64_tr_b16 v[182:183], v13 offset:18432
    ds_read_b64_tr_b16 v[184:185], v14 offset:16384
    s_waitcnt lgkmcnt(7)
    v_mfma_f32_16x16x32_bf16 v[208:211], v[168:171], v[152:155], v[208:211]
    ds_read_b64_tr_b16 v[186:187], v14 offset:18432
    v_mfma_f32_16x16x32_bf16 v[216:219], v[168:171], v[156:159], v[216:219]
    ds_read_b64_tr_b16 v[188:189], v15 offset:16384
    s_waitcnt lgkmcnt(7)
    v_mfma_f32_16x16x32_bf16 v[212:215], v[172:175], v[152:155], v[212:215]
    ds_read_b64_tr_b16 v[190:191], v15 offset:18432
    v_mfma_f32_16x16x32_bf16 v[220:223], v[172:175], v[156:159], v[220:223]
    s_add_u32 m0, s63, 16384
    s_add_u32 s52, s60, 71680
    buffer_load_dwordx4 v6, s[20:23], s52 offen lds
    s_add_u32 m0, s63, 17408
    s_add_u32 s52, s60, 78848
    buffer_load_dwordx4 v6, s[20:23], s52 offen lds
    s_waitcnt vmcnt(6)
    ds_read_b64_tr_b16 v[40:41], v140 offset:49152
    ds_read_b64_tr_b16 v[42:43], v140 offset:50176
    ds_read_b64_tr_b16 v[44:45], v141 offset:49152
    ds_read_b64_tr_b16 v[46:47], v141 offset:50176
    s_waitcnt lgkmcnt(0)
    v_mfma_f32_16x16x32_bf16 v[224:227], v[176:179], v[152:155], v[224:227]
    v_xor_b32 v8, 0x10000, v8
    v_xor_b32 v9, 0x10000, v9
    v_xor_b32 v10, 0x10000, v10
    v_xor_b32 v11, 0x10000, v11
    v_xor_b32 v12, 0x10000, v12
    v_xor_b32 v13, 0x10000, v13
    v_xor_b32 v14, 0x10000, v14
    v_xor_b32 v15, 0x10000, v15
    s_barrier
    v_mfma_f32_16x16x32_bf16 v[232:235], v[176:179], v[156:159], v[232:235]
    ds_read_b128 v[144:147], v16 offset:0
    v_mfma_f32_16x16x32_bf16 v[228:231], v[180:183], v[152:155], v[228:231]
    ds_read_b128 v[148:151], v16 offset:2048
    ds_read_b64_tr_b16 v[160:161], v8 offset:0
    v_mfma_f32_16x16x32_bf16 v[236:239], v[180:183], v[156:159], v[236:239]
    ds_read_b64_tr_b16 v[162:163], v8 offset:2048
    ds_read_b64_tr_b16 v[164:165], v9 offset:0
    v_mfma_f32_16x16x32_bf16 v[240:243], v[184:187], v[152:155], v[240:243]
    ds_read_b64_tr_b16 v[166:167], v9 offset:2048
    v_mfma_f32_16x16x32_bf16 v[248:251], v[184:187], v[156:159], v[248:251]
    ds_read_b64_tr_b16 v[168:169], v10 offset:0
    ds_read_b64_tr_b16 v[170:171], v10 offset:2048
    v_mfma_f32_16x16x32_bf16 v[244:247], v[188:191], v[152:155], v[244:247]
    ds_read_b64_tr_b16 v[172:173], v11 offset:0
    ds_read_b64_tr_b16 v[174:175], v11 offset:2048
    v_mfma_f32_16x16x32_bf16 v[252:255], v[188:191], v[156:159], v[252:255]
    s_add_u32 m0, s63, 49152
    s_add_u32 s52, s61, 12544
    buffer_load_dwordx4 v6, s[24:27], s52 offen lds
    s_add_u32 m0, s63, 50176
    s_add_u32 s52, s61, 19712
    buffer_load_dwordx4 v6, s[24:27], s52 offen lds
    s_waitcnt lgkmcnt(6)
    v_mfma_f32_16x16x32_bf16 v[192:195], v[160:163], v[144:147], v[192:195]
    ds_read_b64_tr_b16 v[176:177], v12 offset:0
    v_mfma_f32_16x16x32_bf16 v[200:203], v[160:163], v[148:151], v[200:203]
    ds_read_b64_tr_b16 v[178:179], v12 offset:2048
    s_waitcnt lgkmcnt(6)
    v_mfma_f32_16x16x32_bf16 v[196:199], v[164:167], v[144:147], v[196:199]
    ds_read_b64_tr_b16 v[180:181], v13 offset:0
    v_mfma_f32_16x16x32_bf16 v[204:207], v[164:167], v[148:151], v[204:207]
    ds_read_b64_tr_b16 v[182:183], v13 offset:2048
    ds_read_b64_tr_b16 v[184:185], v14 offset:0
    s_waitcnt lgkmcnt(7)
    v_mfma_f32_16x16x32_bf16 v[208:211], v[168:171], v[144:147], v[208:211]
    ds_read_b64_tr_b16 v[186:187], v14 offset:2048
    v_mfma_f32_16x16x32_bf16 v[216:219], v[168:171], v[148:151], v[216:219]
    ds_read_b64_tr_b16 v[188:189], v15 offset:0
    s_waitcnt lgkmcnt(7)
    v_mfma_f32_16x16x32_bf16 v[212:215], v[172:175], v[144:147], v[212:215]
    ds_read_b64_tr_b16 v[190:191], v15 offset:2048
    v_mfma_f32_16x16x32_bf16 v[220:223], v[172:175], v[148:151], v[220:223]
    s_add_u32 m0, s62, 65536
    s_add_u32 s52, s60, 86016
    buffer_load_dwordx4 v6, s[20:23], s52 offen lds
    s_add_u32 m0, s62, 66560
    s_add_u32 s52, s60, 93184
    buffer_load_dwordx4 v6, s[20:23], s52 offen lds
    s_waitcnt lgkmcnt(6)
    v_mfma_f32_16x16x32_bf16 v[224:227], v[176:179], v[144:147], v[224:227]
    ds_read_b128 v[152:155], v17 offset:0
    ds_read_b128 v[156:159], v17 offset:2048
    v_mfma_f32_16x16x32_bf16 v[232:235], v[176:179], v[148:151], v[232:235]
    ds_read_b64_tr_b16 v[160:161], v8 offset:16384
    ds_read_b64_tr_b16 v[162:163], v8 offset:18432
    s_waitcnt lgkmcnt(8)
    v_mfma_f32_16x16x32_bf16 v[228:231], v[180:183], v[144:147], v[228:231]
    ds_read_b64_tr_b16 v[164:165], v9 offset:16384
    ds_read_b64_tr_b16 v[166:167], v9 offset:18432
    ds_read_b64_tr_b16 v[168:169], v10 offset:16384
    v_mfma_f32_16x16x32_bf16 v[236:239], v[180:183], v[148:151], v[236:239]
    ds_read_b64_tr_b16 v[170:171], v10 offset:18432
    ds_read_b64_tr_b16 v[172:173], v11 offset:16384
    s_waitcnt lgkmcnt(11)
    v_mfma_f32_16x16x32_bf16 v[240:243], v[184:187], v[144:147], v[240:243]
    ds_read_b64_tr_b16 v[174:175], v11 offset:18432
    s_add_u32 m0, s62, 67584
    s_add_u32 s52, s60, 100352
    buffer_load_dwordx4 v6, s[20:23], s52 offen lds
    v_mfma_f32_16x16x32_bf16 v[248:251], v[184:187], v[148:151], v[248:251]
    s_add_u32 m0, s62, 68608
    s_add_u32 s52, s60, 107520
    buffer_load_dwordx4 v6, s[20:23], s52 offen lds
    s_waitcnt vmcnt(10)
    s_waitcnt vmcnt(8)
    s_waitcnt vmcnt(6)
    ds_read_b64_tr_b16 v[48:49], v136 offset:32768
    s_waitcnt lgkmcnt(11)
    v_mfma_f32_16x16x32_bf16 v[244:247], v[188:191], v[144:147], v[244:247]
    ds_read_b64_tr_b16 v[50:51], v136 offset:33792
    ds_read_b64_tr_b16 v[52:53], v137 offset:32768
    v_mfma_f32_16x16x32_bf16 v[252:255], v[188:191], v[148:151], v[252:255]
    ds_read_b64_tr_b16 v[54:55], v137 offset:33792
    ds_read_b64_tr_b16 v[56:57], v136 offset:34816
    ds_read_b64_tr_b16 v[58:59], v136 offset:35840
    s_waitcnt lgkmcnt(12)
    v_mfma_f32_16x16x32_bf16 v[192:195], v[160:163], v[152:155], v[192:195]
    ds_read_b64_tr_b16 v[176:177], v12 offset:16384
    ds_read_b64_tr_b16 v[178:179], v12 offset:18432
    v_mfma_f32_16x16x32_bf16 v[200:203], v[160:163], v[156:159], v[200:203]
    ds_read_b64_tr_b16 v[180:181], v13 offset:16384
    ds_read_b64_tr_b16 v[182:183], v13 offset:18432
    s_waitcnt lgkmcnt(14)
    v_mfma_f32_16x16x32_bf16 v[196:199], v[164:167], v[152:155], v[196:199]
    ds_read_b64_tr_b16 v[184:185], v14 offset:16384
    ds_read_b64_tr_b16 v[186:187], v14 offset:18432
    v_mfma_f32_16x16x32_bf16 v[204:207], v[164:167], v[156:159], v[204:207]
    ds_read_b64_tr_b16 v[188:189], v15 offset:16384
    ds_read_b64_tr_b16 v[190:191], v15 offset:18432
    s_waitcnt lgkmcnt(15)
    v_mfma_f32_16x16x32_bf16 v[208:211], v[168:171], v[152:155], v[208:211]
    s_add_u32 m0, s63, 32768
    s_add_u32 s52, s60, 114688
    buffer_load_dwordx4 v6, s[20:23], s52 offen lds
    s_add_u32 m0, s63, 33792
    s_add_u32 s52, s60, 121856
    buffer_load_dwordx4 v6, s[20:23], s52 offen lds
    v_mfma_f32_16x16x32_bf16 v[216:219], v[168:171], v[156:159], v[216:219]
    ds_read_b64_tr_b16 v[60:61], v137 offset:34816
    ds_read_b64_tr_b16 v[62:63], v137 offset:35840
    s_waitcnt lgkmcnt(15)
    v_mfma_f32_16x16x32_bf16 v[212:215], v[172:175], v[152:155], v[212:215]
    ds_read_b64_tr_b16 v[64:65], v140 offset:16384
    ds_read_b64_tr_b16 v[66:67], v140 offset:17408
    v_mfma_f32_16x16x32_bf16 v[220:223], v[172:175], v[156:159], v[220:223]
    ds_read_b64_tr_b16 v[68:69], v141 offset:16384
    ds_read_b64_tr_b16 v[70:71], v141 offset:17408
    s_waitcnt lgkmcnt(0)
    v_mfma_f32_16x16x32_bf16 v[224:227], v[176:179], v[152:155], v[224:227]
    s_barrier
    v_mfma_f32_16x16x32_bf16 v[232:235], v[176:179], v[156:159], v[232:235]
    v_mfma_f32_16x16x32_bf16 v[228:231], v[180:183], v[152:155], v[228:231]
    v_mfma_f32_16x16x32_bf16 v[236:239], v[180:183], v[156:159], v[236:239]
    v_mfma_f32_16x16x32_bf16 v[240:243], v[184:187], v[152:155], v[240:243]
    v_mfma_f32_16x16x32_bf16 v[248:251], v[184:187], v[156:159], v[248:251]
    v_mfma_f32_16x16x32_bf16 v[244:247], v[188:191], v[152:155], v[244:247]
    v_mfma_f32_16x16x32_bf16 v[252:255], v[188:191], v[156:159], v[252:255]
    v_pk_mul_f32 v[192:193], v[192:193], s[40:41]
    v_pk_mul_f32 v[194:195], v[194:195], s[40:41]
    v_pk_mul_f32 v[196:197], v[196:197], s[40:41]
    v_pk_mul_f32 v[198:199], v[198:199], s[40:41]
    v_exp_f32 v168, v192
    v_exp_f32 v169, v193
    v_exp_f32 v170, v194
    v_exp_f32 v171, v195
    v_exp_f32 v172, v196
    v_exp_f32 v173, v197
    v_exp_f32 v174, v198
    v_exp_f32_e64 v175, v199
    v_pk_fma_f32 v[176:177], v[168:169], v[20:21], v[22:23]
    v_pk_fma_f32 v[178:179], v[170:171], v[20:21], v[22:23]
    v_pk_fma_f32 v[180:181], v[172:173], v[20:21], v[22:23]
    v_pk_fma_f32 v[182:183], v[174:175], v[20:21], v[22:23]
    v_pk_fma_f32 v[176:177], v[176:177], v[168:169], v[22:23]
    v_pk_fma_f32 v[178:179], v[178:179], v[170:171], v[22:23]
    v_pk_fma_f32 v[180:181], v[180:181], v[172:173], v[22:23]
    v_pk_fma_f32 v[182:183], v[182:183], v[174:175], v[22:23]
    v_rcp_f32 v176, v176
    v_rcp_f32 v177, v177
    v_rcp_f32 v178, v178
    v_rcp_f32 v179, v179
    v_rcp_f32 v180, v180
    v_rcp_f32 v181, v181
    v_rcp_f32 v182, v182
    v_rcp_f32 v183, v183
    v_pk_fma_f32 v[176:177], v[192:193], v[176:177], v[192:193] neg_lo:[1,0,0] neg_hi:[1,0,0]
    v_pk_fma_f32 v[178:179], v[194:195], v[178:179], v[194:195] neg_lo:[1,0,0] neg_hi:[1,0,0]
    v_pk_fma_f32 v[180:181], v[196:197], v[180:181], v[196:197] neg_lo:[1,0,0] neg_hi:[1,0,0]
    v_pk_fma_f32 v[182:183], v[198:199], v[182:183], v[198:199] neg_lo:[1,0,0] neg_hi:[1,0,0]
    v_cvt_pk_bf16_f32 v192, v176, v177
    v_cvt_pk_bf16_f32 v193, v178, v179
    v_cvt_pk_bf16_f32 v194, v180, v181
    v_cvt_pk_bf16_f32 v195, v182, v183
    v_pk_mul_f32 v[200:201], v[200:201], s[40:41]
    v_pk_mul_f32 v[202:203], v[202:203], s[40:41]
    v_pk_mul_f32 v[204:205], v[204:205], s[40:41]
    v_pk_mul_f32 v[206:207], v[206:207], s[40:41]
    v_exp_f32 v168, v200
    v_exp_f32 v169, v201
    v_exp_f32 v170, v202
    v_exp_f32 v171, v203
    v_exp_f32 v172, v204
    v_exp_f32 v173, v205
    v_exp_f32 v174, v206
    v_exp_f32 v175, v207
    v_pk_fma_f32 v[176:177], v[168:169], v[20:21], v[22:23]
    v_pk_fma_f32 v[178:179], v[170:171], v[20:21], v[22:23]
    v_pk_fma_f32 v[180:181], v[172:173], v[20:21], v[22:23]
    v_pk_fma_f32 v[182:183], v[174:175], v[20:21], v[22:23]
    v_pk_fma_f32 v[176:177], v[176:177], v[168:169], v[22:23]
    v_pk_fma_f32 v[178:179], v[178:179], v[170:171], v[22:23]
    v_pk_fma_f32 v[180:181], v[180:181], v[172:173], v[22:23]
    v_pk_fma_f32 v[182:183], v[182:183], v[174:175], v[22:23]
    v_rcp_f32 v176, v176
    v_rcp_f32 v177, v177
    v_rcp_f32 v178, v178
    v_rcp_f32 v179, v179
    v_rcp_f32 v180, v180
    v_rcp_f32 v181, v181
    v_rcp_f32 v182, v182
    v_rcp_f32 v183, v183
    v_pk_fma_f32 v[176:177], v[200:201], v[176:177], v[200:201] neg_lo:[1,0,0] neg_hi:[1,0,0]
    v_pk_fma_f32 v[178:179], v[202:203], v[178:179], v[202:203] neg_lo:[1,0,0] neg_hi:[1,0,0]
    v_pk_fma_f32 v[180:181], v[204:205], v[180:181], v[204:205] neg_lo:[1,0,0] neg_hi:[1,0,0]
    v_pk_fma_f32 v[182:183], v[206:207], v[182:183], v[206:207] neg_lo:[1,0,0] neg_hi:[1,0,0]
    v_cvt_pk_bf16_f32 v200, v176, v177
    v_cvt_pk_bf16_f32 v201, v178, v179
    v_cvt_pk_bf16_f32 v202, v180, v181
    v_cvt_pk_bf16_f32 v203, v182, v183
    buffer_store_dwordx4 v[192:195], v18, s[16:19], s98 offen offset:0 sc1
    buffer_store_dwordx4 v[200:203], v18, s[16:19], s98 offen offset:256 sc1
    v_pk_mul_f32 v[208:209], v[208:209], s[40:41]
    v_pk_mul_f32 v[210:211], v[210:211], s[40:41]
    v_pk_mul_f32 v[212:213], v[212:213], s[40:41]
    v_pk_mul_f32 v[214:215], v[214:215], s[40:41]
    v_exp_f32 v168, v208
    v_exp_f32 v169, v209
    v_exp_f32 v170, v210
    v_exp_f32 v171, v211
    v_exp_f32 v172, v212
    v_exp_f32 v173, v213
    v_exp_f32 v174, v214
    v_exp_f32 v175, v215
    v_pk_fma_f32 v[176:177], v[168:169], v[20:21], v[22:23]
    v_pk_fma_f32 v[178:179], v[170:171], v[20:21], v[22:23]
    v_pk_fma_f32 v[180:181], v[172:173], v[20:21], v[22:23]
    v_pk_fma_f32 v[182:183], v[174:175], v[20:21], v[22:23]
    v_pk_fma_f32 v[176:177], v[176:177], v[168:169], v[22:23]
    v_pk_fma_f32 v[178:179], v[178:179], v[170:171], v[22:23]
    v_pk_fma_f32 v[180:181], v[180:181], v[172:173], v[22:23]
    v_pk_fma_f32 v[182:183], v[182:183], v[174:175], v[22:23]
    v_rcp_f32 v176, v176
    v_rcp_f32 v177, v177
    v_rcp_f32 v178, v178
    v_rcp_f32 v179, v179
    v_rcp_f32 v180, v180
    v_rcp_f32 v181, v181
    v_rcp_f32 v182, v182
    v_rcp_f32 v183, v183
    v_pk_fma_f32 v[176:177], v[208:209], v[176:177], v[208:209] neg_lo:[1,0,0] neg_hi:[1,0,0]
    v_pk_fma_f32 v[178:179], v[210:211], v[178:179], v[210:211] neg_lo:[1,0,0] neg_hi:[1,0,0]
    v_pk_fma_f32 v[180:181], v[212:213], v[180:181], v[212:213] neg_lo:[1,0,0] neg_hi:[1,0,0]
    v_pk_fma_f32 v[182:183], v[214:215], v[182:183], v[214:215] neg_lo:[1,0,0] neg_hi:[1,0,0]
    v_cvt_pk_bf16_f32 v208, v176, v177
    v_cvt_pk_bf16_f32 v209, v178, v179
    v_cvt_pk_bf16_f32 v210, v180, v181
    v_cvt_pk_bf16_f32 v211, v182, v183
    v_pk_mul_f32 v[216:217], v[216:217], s[40:41]
    v_pk_mul_f32 v[218:219], v[218:219], s[40:41]
    v_pk_mul_f32 v[220:221], v[220:221], s[40:41]
    v_pk_mul_f32 v[222:223], v[222:223], s[40:41]
    v_exp_f32 v168, v216
    v_exp_f32 v169, v217
    v_exp_f32 v170, v218
    v_exp_f32 v171, v219
    v_exp_f32 v172, v220
    v_exp_f32 v173, v221
    v_exp_f32 v174, v222
    v_exp_f32 v175, v223
    v_pk_fma_f32 v[176:177], v[168:169], v[20:21], v[22:23]
    v_pk_fma_f32 v[178:179], v[170:171], v[20:21], v[22:23]
    v_pk_fma_f32 v[180:181], v[172:173], v[20:21], v[22:23]
    v_pk_fma_f32 v[182:183], v[174:175], v[20:21], v[22:23]
    v_pk_fma_f32 v[176:177], v[176:177], v[168:169], v[22:23]
    v_pk_fma_f32 v[178:179], v[178:179], v[170:171], v[22:23]
    v_pk_fma_f32 v[180:181], v[180:181], v[172:173], v[22:23]
    v_pk_fma_f32 v[182:183], v[182:183], v[174:175], v[22:23]
    v_rcp_f32 v176, v176
    v_rcp_f32 v177, v177
    v_rcp_f32 v178, v178
    v_rcp_f32 v179, v179
    v_rcp_f32 v180, v180
    v_rcp_f32 v181, v181
    v_rcp_f32 v182, v182
    v_rcp_f32 v183, v183
    v_pk_fma_f32 v[176:177], v[216:217], v[176:177], v[216:217] neg_lo:[1,0,0] neg_hi:[1,0,0]
    v_pk_fma_f32 v[178:179], v[218:219], v[178:179], v[218:219] neg_lo:[1,0,0] neg_hi:[1,0,0]
    v_pk_fma_f32 v[180:181], v[220:221], v[180:181], v[220:221] neg_lo:[1,0,0] neg_hi:[1,0,0]
    v_pk_fma_f32 v[182:183], v[222:223], v[182:183], v[222:223] neg_lo:[1,0,0] neg_hi:[1,0,0]
    v_cvt_pk_bf16_f32 v216, v176, v177
    v_cvt_pk_bf16_f32 v217, v178, v179
    v_cvt_pk_bf16_f32 v218, v180, v181
    v_cvt_pk_bf16_f32 v219, v182, v183
    buffer_store_dwordx4 v[208:211], v18, s[16:19], s98 offen offset:2048 sc1
    buffer_store_dwordx4 v[216:219], v18, s[16:19], s98 offen offset:2304 sc1
    v_pk_mul_f32 v[224:225], v[224:225], s[40:41]
    v_pk_mul_f32 v[226:227], v[226:227], s[40:41]
    v_pk_mul_f32 v[228:229], v[228:229], s[40:41]
    v_pk_mul_f32 v[230:231], v[230:231], s[40:41]
    v_exp_f32 v168, v224
    v_exp_f32 v169, v225
    v_exp_f32 v170, v226
    v_exp_f32 v171, v227
    v_exp_f32 v172, v228
    v_exp_f32 v173, v229
    v_exp_f32 v174, v230
    v_exp_f32 v175, v231
    v_pk_fma_f32 v[176:177], v[168:169], v[20:21], v[22:23]
    v_pk_fma_f32 v[178:179], v[170:171], v[20:21], v[22:23]
    v_pk_fma_f32 v[180:181], v[172:173], v[20:21], v[22:23]
    v_pk_fma_f32 v[182:183], v[174:175], v[20:21], v[22:23]
    v_pk_fma_f32 v[176:177], v[176:177], v[168:169], v[22:23]
    v_pk_fma_f32 v[178:179], v[178:179], v[170:171], v[22:23]
    v_pk_fma_f32 v[180:181], v[180:181], v[172:173], v[22:23]
    v_pk_fma_f32 v[182:183], v[182:183], v[174:175], v[22:23]
    v_rcp_f32 v176, v176
    v_rcp_f32 v177, v177
    v_rcp_f32 v178, v178
    v_rcp_f32 v179, v179
    v_rcp_f32 v180, v180
    v_rcp_f32 v181, v181
    v_rcp_f32 v182, v182
    v_rcp_f32 v183, v183
    v_pk_fma_f32 v[176:177], v[224:225], v[176:177], v[224:225] neg_lo:[1,0,0] neg_hi:[1,0,0]
    v_pk_fma_f32 v[178:179], v[226:227], v[178:179], v[226:227] neg_lo:[1,0,0] neg_hi:[1,0,0]
    v_pk_fma_f32 v[180:181], v[228:229], v[180:181], v[228:229] neg_lo:[1,0,0] neg_hi:[1,0,0]
    v_pk_fma_f32 v[182:183], v[230:231], v[182:183], v[230:231] neg_lo:[1,0,0] neg_hi:[1,0,0]
    v_cvt_pk_bf16_f32 v224, v176, v177
    v_cvt_pk_bf16_f32 v225, v178, v179
    v_cvt_pk_bf16_f32 v226, v180, v181
    v_cvt_pk_bf16_f32 v227, v182, v183
    v_pk_mul_f32 v[232:233], v[232:233], s[40:41]
    v_pk_mul_f32 v[234:235], v[234:235], s[40:41]
    v_pk_mul_f32 v[236:237], v[236:237], s[40:41]
    v_pk_mul_f32 v[238:239], v[238:239], s[40:41]
    v_exp_f32 v168, v232
    v_exp_f32 v169, v233
    v_exp_f32 v170, v234
    v_exp_f32 v171, v235
    v_exp_f32 v172, v236
    v_exp_f32 v173, v237
    v_exp_f32 v174, v238
    v_exp_f32 v175, v239
    v_pk_fma_f32 v[176:177], v[168:169], v[20:21], v[22:23]
    v_pk_fma_f32 v[178:179], v[170:171], v[20:21], v[22:23]
    v_pk_fma_f32 v[180:181], v[172:173], v[20:21], v[22:23]
    v_pk_fma_f32 v[182:183], v[174:175], v[20:21], v[22:23]
    v_pk_fma_f32 v[176:177], v[176:177], v[168:169], v[22:23]
    v_pk_fma_f32 v[178:179], v[178:179], v[170:171], v[22:23]
    v_pk_fma_f32 v[180:181], v[180:181], v[172:173], v[22:23]
    v_pk_fma_f32 v[182:183], v[182:183], v[174:175], v[22:23]
    v_rcp_f32 v176, v176
    v_rcp_f32 v177, v177
    v_rcp_f32 v178, v178
    v_rcp_f32 v179, v179
    v_rcp_f32 v180, v180
    v_rcp_f32 v181, v181
    v_rcp_f32 v182, v182
    v_rcp_f32 v183, v183
    v_pk_fma_f32 v[176:177], v[232:233], v[176:177], v[232:233] neg_lo:[1,0,0] neg_hi:[1,0,0]
    v_pk_fma_f32 v[178:179], v[234:235], v[178:179], v[234:235] neg_lo:[1,0,0] neg_hi:[1,0,0]
    v_pk_fma_f32 v[180:181], v[236:237], v[180:181], v[236:237] neg_lo:[1,0,0] neg_hi:[1,0,0]
    v_pk_fma_f32 v[182:183], v[238:239], v[182:183], v[238:239] neg_lo:[1,0,0] neg_hi:[1,0,0]
    v_cvt_pk_bf16_f32 v232, v176, v177
    v_cvt_pk_bf16_f32 v233, v178, v179
    v_cvt_pk_bf16_f32 v234, v180, v181
    v_cvt_pk_bf16_f32 v235, v182, v183
    buffer_store_dwordx4 v[224:227], v18, s[16:19], s99 offen offset:0 sc1
    buffer_store_dwordx4 v[232:235], v18, s[16:19], s99 offen offset:256 sc1
    v_pk_mul_f32 v[240:241], v[240:241], s[40:41]
    v_pk_mul_f32 v[242:243], v[242:243], s[40:41]
    v_pk_mul_f32 v[244:245], v[244:245], s[40:41]
    v_pk_mul_f32 v[246:247], v[246:247], s[40:41]
    v_exp_f32 v168, v240
    v_exp_f32 v169, v241
    v_exp_f32 v170, v242
    v_exp_f32 v171, v243
    v_exp_f32 v172, v244
    v_exp_f32 v173, v245
    v_exp_f32 v174, v246
    v_exp_f32 v175, v247
    v_pk_fma_f32 v[176:177], v[168:169], v[20:21], v[22:23]
    v_pk_fma_f32 v[178:179], v[170:171], v[20:21], v[22:23]
    v_pk_fma_f32 v[180:181], v[172:173], v[20:21], v[22:23]
    v_pk_fma_f32 v[182:183], v[174:175], v[20:21], v[22:23]
    v_pk_fma_f32 v[176:177], v[176:177], v[168:169], v[22:23]
    v_pk_fma_f32 v[178:179], v[178:179], v[170:171], v[22:23]
    v_pk_fma_f32 v[180:181], v[180:181], v[172:173], v[22:23]
    v_pk_fma_f32 v[182:183], v[182:183], v[174:175], v[22:23]
    v_rcp_f32 v176, v176
    v_rcp_f32 v177, v177
    v_rcp_f32 v178, v178
    v_rcp_f32 v179, v179
    v_rcp_f32 v180, v180
    v_rcp_f32 v181, v181
    v_rcp_f32 v182, v182
    v_rcp_f32 v183, v183
    v_pk_fma_f32 v[176:177], v[240:241], v[176:177], v[240:241] neg_lo:[1,0,0] neg_hi:[1,0,0]
    v_pk_fma_f32 v[178:179], v[242:243], v[178:179], v[242:243] neg_lo:[1,0,0] neg_hi:[1,0,0]
    v_pk_fma_f32 v[180:181], v[244:245], v[180:181], v[244:245] neg_lo:[1,0,0] neg_hi:[1,0,0]
    v_pk_fma_f32 v[182:183], v[246:247], v[182:183], v[246:247] neg_lo:[1,0,0] neg_hi:[1,0,0]
    v_cvt_pk_bf16_f32 v240, v176, v177
    v_cvt_pk_bf16_f32 v241, v178, v179
    v_cvt_pk_bf16_f32 v242, v180, v181
    v_cvt_pk_bf16_f32 v243, v182, v183
    v_pk_mul_f32 v[248:249], v[248:249], s[40:41]
    v_pk_mul_f32 v[250:251], v[250:251], s[40:41]
    v_pk_mul_f32 v[252:253], v[252:253], s[40:41]
    v_pk_mul_f32 v[254:255], v[254:255], s[40:41]
    v_exp_f32 v168, v248
    v_exp_f32 v169, v249
    v_exp_f32 v170, v250
    v_exp_f32 v171, v251
    v_exp_f32 v172, v252
    v_exp_f32 v173, v253
    v_exp_f32 v174, v254
    v_exp_f32 v175, v255
    v_pk_fma_f32 v[176:177], v[168:169], v[20:21], v[22:23]
    v_pk_fma_f32 v[178:179], v[170:171], v[20:21], v[22:23]
    v_pk_fma_f32 v[180:181], v[172:173], v[20:21], v[22:23]
    v_pk_fma_f32 v[182:183], v[174:175], v[20:21], v[22:23]
    v_pk_fma_f32 v[176:177], v[176:177], v[168:169], v[22:23]
    v_pk_fma_f32 v[178:179], v[178:179], v[170:171], v[22:23]
    v_pk_fma_f32 v[180:181], v[180:181], v[172:173], v[22:23]
    v_pk_fma_f32 v[182:183], v[182:183], v[174:175], v[22:23]
    v_rcp_f32 v176, v176
    v_rcp_f32 v177, v177
    v_rcp_f32 v178, v178
    v_rcp_f32 v179, v179
    v_rcp_f32 v180, v180
    v_rcp_f32 v181, v181
    v_rcp_f32 v182, v182
    v_rcp_f32 v183, v183
    v_pk_fma_f32 v[176:177], v[248:249], v[176:177], v[248:249] neg_lo:[1,0,0] neg_hi:[1,0,0]
    v_pk_fma_f32 v[178:179], v[250:251], v[178:179], v[250:251] neg_lo:[1,0,0] neg_hi:[1,0,0]
    v_pk_fma_f32 v[180:181], v[252:253], v[180:181], v[252:253] neg_lo:[1,0,0] neg_hi:[1,0,0]
    v_pk_fma_f32 v[182:183], v[254:255], v[182:183], v[254:255] neg_lo:[1,0,0] neg_hi:[1,0,0]
    v_cvt_pk_bf16_f32 v248, v176, v177
    v_cvt_pk_bf16_f32 v249, v178, v179
    v_cvt_pk_bf16_f32 v250, v180, v181
    v_cvt_pk_bf16_f32 v251, v182, v183
    buffer_store_dwordx4 v[240:243], v18, s[16:19], s99 offen offset:2048 sc1
    buffer_store_dwordx4 v[248:251], v18, s[16:19], s99 offen offset:2304 sc1
    s_waitcnt vmcnt(4)
    s_add_u32 s91, s90, 32
    v_mov_b32 v1, s49
    v_mov_b32_e64 v2, 0
    s_mov_b64 exec, 1
    buffer_store_dword v1, v2, s[16:19], s91 offen sc1
    s_mov_b64 exec, -1
    ds_read_b64_tr_b16 v[72:73], v138 offset:0
    ds_read_b64_tr_b16 v[74:75], v138 offset:1024
    ds_read_b64_tr_b16 v[76:77], v139 offset:0
    ds_read_b64_tr_b16 v[78:79], v139 offset:1024
    ds_read_b64_tr_b16 v[80:81], v138 offset:2048
    ds_read_b64_tr_b16 v[82:83], v138 offset:3072
    ds_read_b64_tr_b16 v[84:85], v139 offset:2048
    ds_read_b64_tr_b16 v[86:87], v139 offset:3072
    ds_read_b64_tr_b16 v[88:89], v140 offset:32768
    ds_read_b64_tr_b16 v[90:91], v140 offset:33792
    ds_read_b64_tr_b16 v[92:93], v141 offset:32768
    ds_read_b64_tr_b16 v[94:95], v141 offset:33792
    s_waitcnt vmcnt(0)
    v_mov_b32 v1, s49
    v_mov_b32_e64 v2, 0
    s_mov_b64 exec, 1
    buffer_store_dword v1, v2, s[16:19], s90 offen sc1
    s_mov_b64 exec, -1
    s_add_u32 m0, s62, 32768
    s_add_u32 s52, s60, 172032
    buffer_load_dwordx4 v6, s[20:23], s52 offen lds
    s_add_u32 m0, s62, 33792
    s_add_u32 s52, s60, 179200
    buffer_load_dwordx4 v6, s[20:23], s52 offen lds
    s_add_u32 m0, s62, 34816
    s_add_u32 s52, s60, 186368
    buffer_load_dwordx4 v6, s[20:23], s52 offen lds
    s_add_u32 m0, s62, 35840
    s_add_u32 s52, s60, 193536
    buffer_load_dwordx4 v6, s[20:23], s52 offen lds
    s_add_u32 m0, s63, 16384
    s_add_u32 s52, s61, 0
    buffer_load_dwordx4 v6, s[24:27], s52 offen lds
    s_add_u32 m0, s63, 17408
    s_add_u32 s52, s61, 7168
    buffer_load_dwordx4 v6, s[24:27], s52 offen lds
    v_and_b32 v4, 1, v0
    v_lshlrev_b32 v4, 2, v4
    v_bfe_u32 v5, v0, 1, 2
    v_min_u32_e64 v5, 2, v5
    v_lshl_add_u32 v5, v5, 4, v4
    buffer_load_dword v5, v5, s[16:19], s81 offen sc1
    s_barrier
    s_waitcnt vmcnt(0) lgkmcnt(0)
L_S2:
    s_nop 1
    s_cmp_lt_u32 s44, 4
    s_cbranch_scc1 L_np
    s_setprio 2
L_np:
    v_cmp_ne_u32 vcc, s49, v5
    s_nop 0
    s_mov_b32 s5, vcc_lo
    s_and_b32 s52, s5, 0x30
    s_cbranch_scc1 L_faslow
L_faok:
    s_add_u32 s90, s82, 0
    buffer_load_dwordx4 v[168:171], v7, s[16:19], s90 offen offset:0 sc1
    s_add_u32 s90, s82, 114688
    buffer_load_dwordx4 v[172:175], v7, s[16:19], s90 offen offset:0 sc1
    buffer_load_dword v5, v4, s[16:19], s81 offen sc1
    s_add_u32 s90, s82, 0
    buffer_load_dwordx4 v[176:179], v7, s[16:19], s90 offen offset:1024 sc1
    s_add_u32 s90, s82, 114688
    buffer_load_dwordx4 v[180:183], v7, s[16:19], s90 offen offset:1024 sc1
    s_add_u32 s90, s82, 0
    buffer_load_dwordx4 v[184:187], v7, s[16:19], s90 offen offset:2048 sc1
    s_add_u32 s90, s82, 114688
    buffer_load_dwordx4 v[188:191], v7, s[16:19], s90 offen offset:2048 sc1
    v_mov_b32 v8, v136
    v_mov_b32 v9, v137
    v_mov_b32 v10, v138
    v_mov_b32 v11, v139
    v_mov_b32 v12, v140
    v_mov_b32 v13, v141
    v_lshrrev_b32 v2, 5, v0
    v_mul_u32_u24 v2, 7, v2
    v_bfe_u32 v3, v0, 2, 2
    v_add_u32_e64 v2, v2, v3
    v_bfe_u32 v3, v2, 1, 1
    v_lshlrev_b32_e64 v2, 7, v2
    v_lshl_add_u32 v2, v3, 6, v2
    v_bfe_u32 v3, v0, 4, 1
    v_lshl_add_u32 v2, v3, 5, v2
    v_and_b32_e64 v3, 3, v0
    v_lshl_add_u32 v2, v3, 3, v2
    v_xor_b32 v3, 64, v2
    v_add_u32 v14, s62, v2
    v_add_u32 v15, s62, v3
    v_add_u32 v16, s63, v2
    v_add_u32 v17, s63, v3
    v_lshlrev_b32 v1, 5, v4
    ds_read_b64_tr_b16 v[96:97], v8 offset:0
    ds_read_b64_tr_b16 v[98:99], v8 offset:1024
    ds_read_b64_tr_b16 v[100:101], v9 offset:0
    ds_read_b64_tr_b16 v[102:103], v9 offset:1024
    ds_read_b64_tr_b16 v[104:105], v8 offset:2048
    ds_read_b64_tr_b16 v[106:107], v8 offset:3072
    ds_read_b64_tr_b16 v[108:109], v9 offset:2048
    ds_read_b64_tr_b16 v[110:111], v9 offset:3072
    ds_read_b64_tr_b16 v[112:113], v12 offset:0
    ds_read_b64_tr_b16 v[114:115], v12 offset:1024
    ds_read_b64_tr_b16 v[116:117], v13 offset:0
    ds_read_b64_tr_b16 v[118:119], v13 offset:1024
    ds_read_b64_tr_b16 v[120:121], v8 offset:32768
    ds_read_b64_tr_b16 v[122:123], v8 offset:33792
    ds_read_b64_tr_b16 v[124:125], v9 offset:32768
    ds_read_b64_tr_b16 v[126:127], v9 offset:33792
    ds_read_b64_tr_b16 v[128:129], v8 offset:34816
    ds_read_b64_tr_b16 v[130:131], v8 offset:35840
    ds_read_b64_tr_b16 v[132:133], v9 offset:34816
    ds_read_b64_tr_b16 v[134:135], v9 offset:35840
    s_waitcnt vmcnt(6)
    v_mfma_f32_32x32x16_bf16 v[192:207], v[24:27], v[168:171], 0
    v_mfma_f32_32x32x16_bf16 v[208:223], v[28:31], v[168:171], 0
    s_add_u32 s90, s82, 0
    buffer_load_dwordx4 v[20:23], v7, s[16:19], s90 offen offset:3072 sc1
    s_waitcnt vmcnt(6)
    v_mfma_f32_32x32x16_bf16 v[224:239], v[24:27], v[172:175], 0
    v_mfma_f32_32x32x16_bf16 v[240:255], v[28:31], v[172:175], 0
    s_add_u32 s90, s82, 114688
    buffer_load_dwordx4 v[144:147], v7, s[16:19], s90 offen offset:3072 sc1
    s_and_b32 s52, s5, 3
    s_cbranch_scc0 L_kn_1
    s_waitcnt vmcnt(6)
    v_cmp_ne_u32_e64 vcc, s49, v5
    s_nop 0
    s_cmp_eq_u64 vcc, 0
    s_cbranch_scc0 L_fabslow_3
L_fabok_2:
L_kn_1:
    s_waitcnt vmcnt(5)
    v_mfma_f32_32x32x16_bf16 v[192:207], v[32:35], v[176:179], v[192:207]
    s_add_u32 s90, s82, 4096
    buffer_load_dwordx4 v[148:151], v7, s[16:19], s90 offen offset:0 sc1
    v_mfma_f32_32x32x16_bf16 v[208:223], v[36:39], v[176:179], v[208:223]
    s_add_u32 s90, s82, 118784
    buffer_load_dwordx4 v[152:155], v7, s[16:19], s90 offen offset:0 sc1
    s_waitcnt vmcnt(6)
    v_mfma_f32_32x32x16_bf16 v[224:239], v[32:35], v[180:183], v[224:239]
    s_waitcnt lgkmcnt(0)
    v_mfma_f32_32x32x16_bf16 v[240:255], v[36:39], v[180:183], v[240:255]
    s_add_u32 m0, s63, 32768
    s_add_u32 s52, s61, 25088
    buffer_load_dwordx4 v6, s[24:27], s52 offen lds
    s_add_u32 m0, s63, 33792
    s_add_u32 s52, s61, 32256
    buffer_load_dwordx4 v6, s[24:27], s52 offen lds
    s_waitcnt vmcnt(7)
    v_mfma_f32_32x32x16_bf16 v[192:207], v[40:43], v[184:187], v[192:207]
    s_add_u32 s90, s82, 4096
    buffer_load_dwordx4 v[156:159], v7, s[16:19], s90 offen offset:1024 sc1
    v_mfma_f32_32x32x16_bf16 v[208:223], v[44:47], v[184:187], v[208:223]
    s_add_u32 s90, s82, 118784
    buffer_load_dwordx4 v[160:163], v7, s[16:19], s90 offen offset:1024 sc1
    s_waitcnt vmcnt(8)
    v_mfma_f32_32x32x16_bf16 v[224:239], v[40:43], v[188:191], v[224:239]
    buffer_load_dword v2, v4, s[16:19], s81 offen offset:16 sc1
    v_mfma_f32_32x32x16_bf16 v[240:255], v[44:47], v[188:191], v[240:255]
    s_add_u32 m0, s63, 0
    s_add_u32 s52, s61, 37632
    buffer_load_dwordx4 v6, s[24:27], s52 offen lds
    s_add_u32 m0, s63, 1024
    s_add_u32 s52, s61, 44800
    buffer_load_dwordx4 v6, s[24:27], s52 offen lds
    s_waitcnt vmcnt(10)
    v_mfma_f32_32x32x16_bf16 v[192:207], v[48:51], v[20:23], v[192:207]
    v_mfma_f32_32x32x16_bf16 v[208:223], v[52:55], v[20:23], v[208:223]
    s_add_u32 s90, s82, 4096
    buffer_load_dwordx4 v[168:171], v7, s[16:19], s90 offen offset:2048 sc1
    s_waitcnt vmcnt(10)
    v_mfma_f32_32x32x16_bf16 v[224:239], v[48:51], v[144:147], v[224:239]
    v_mfma_f32_32x32x16_bf16 v[240:255], v[52:55], v[144:147], v[240:255]
    s_add_u32 s90, s82, 118784
    buffer_load_dwordx4 v[172:175], v7, s[16:19], s90 offen offset:2048 sc1
    s_waitcnt vmcnt(10)
    v_mfma_f32_32x32x16_bf16 v[192:207], v[56:59], v[148:151], v[192:207]
    v_mfma_f32_32x32x16_bf16 v[208:223], v[60:63], v[148:151], v[208:223]
    s_add_u32 s90, s82, 4096
    buffer_load_dwordx4 v[24:27], v7, s[16:19], s90 offen offset:3072 sc1
    s_waitcnt vmcnt(10)
    v_mfma_f32_32x32x16_bf16 v[224:239], v[56:59], v[152:155], v[224:239]
    v_mfma_f32_32x32x16_bf16 v[240:255], v[60:63], v[152:155], v[240:255]
    s_add_u32 s90, s82, 118784
    buffer_load_dwordx4 v[28:31], v7, s[16:19], s90 offen offset:3072 sc1
    s_and_b32 s52, s5, 12
    s_cbranch_scc0 L_kn_4
    s_waitcnt vmcnt(6)
    v_cmp_ne_u32_e64 vcc, s49, v2
    s_nop 0
    s_cmp_eq_u64 vcc, 0
    s_cbranch_scc0 L_fa1slow_6
L_fa1ok_5:
L_kn_4:
    s_waitcnt vmcnt(8)
    v_mfma_f32_32x32x16_bf16 v[192:207], v[64:67], v[156:159], v[192:207]
    v_mfma_f32_32x32x16_bf16 v[208:223], v[68:71], v[156:159], v[208:223]
    s_add_u32 s90, s82, 8192
    buffer_load_dwordx4 v[176:179], v7, s[16:19], s90 offen offset:0 sc1
    s_waitcnt vmcnt(8)
    v_mfma_f32_32x32x16_bf16 v[224:239], v[64:67], v[160:163], v[224:239]
    v_mfma_f32_32x32x16_bf16 v[240:255], v[68:71], v[160:163], v[240:255]
    s_add_u32 s90, s82, 122880
    buffer_load_dwordx4 v[180:183], v7, s[16:19], s90 offen offset:0 sc1
    s_waitcnt vmcnt(5)
    v_mfma_f32_32x32x16_bf16 v[192:207], v[72:75], v[168:171], v[192:207]
    v_mfma_f32_32x32x16_bf16 v[208:223], v[76:79], v[168:171], v[208:223]
    s_add_u32 s90, s82, 8192
    buffer_load_dwordx4 v[32:35], v7, s[16:19], s90 offen offset:1024 sc1
    s_waitcnt vmcnt(5)
    v_mfma_f32_32x32x16_bf16 v[224:239], v[72:75], v[172:175], v[224:239]
    v_mfma_f32_32x32x16_bf16 v[240:255], v[76:79], v[172:175], v[240:255]
    s_add_u32 s90, s82, 122880
    buffer_load_dwordx4 v[36:39], v7, s[16:19], s90 offen offset:1024 sc1
    s_waitcnt vmcnt(5)
    v_mfma_f32_32x32x16_bf16 v[192:207], v[80:83], v[24:27], v[192:207]
    s_add_u32 s90, s82, 8192
    buffer_load_dwordx4 v[184:187], v7, s[16:19], s90 offen offset:2048 sc1
    s_add_u32 s90, s82, 122880
    buffer_load_dwordx4 v[188:191], v7, s[16:19], s90 offen offset:2048 sc1
    v_and_b32_e64 v52, 4, v0
    v_mfma_f32_32x32x16_bf16 v[208:223], v[84:87], v[24:27], v[208:223]
    v_bfe_u32 v53, v0, 1, 1
    v_or_b32 v52, v52, v53
    v_and_b32_e64 v53, 1, v0
    s_waitcnt vmcnt(6)
    v_mfma_f32_32x32x16_bf16 v[224:239], v[80:83], v[28:31], v[224:239]
    v_cmp_eq_u32 s[86:87], 1, v53
    v_lshl_or_b32 v52, v53, 1, v52
    v_lshrrev_b32_e64 v53, 5, v0
    v_mfma_f32_32x32x16_bf16 v[240:255], v[84:87], v[28:31], v[240:255]
    v_xor_b32 v52, v52, v53
    v_lshlrev_b32 v52, 4, v52
    v_and_b32_e64 v54, 31, v0
    v_lshl_or_b32 v52, v54, 7, v52
    s_waitcnt vmcnt(5)
    v_mfma_f32_32x32x16_bf16 v[192:207], v[88:91], v[176:179], v[192:207]
    s_add_u32 s90, s82, 8192
    buffer_load_dwordx4 v[56:59], v7, s[16:19], s90 offen offset:3072 sc1
    s_add_u32 s90, s82, 122880
    buffer_load_dwordx4 v[60:63], v7, s[16:19], s90 offen offset:3072 sc1
    buffer_load_dword v3, v1, s[16:19], s79 offen sc1
    v_mfma_f32_32x32x16_bf16 v[208:223], v[92:95], v[176:179], v[208:223]
    v_add_u32 v40, s62, v52
    v_xor_b32 v41, 32, v40
    v_xor_b32 v42, 64, v40
    v_xor_b32 v43, 96, v40
    s_waitcnt vmcnt(7)
    v_mfma_f32_32x32x16_bf16 v[224:239], v[88:91], v[180:183], v[224:239]
    v_and_b32 v52, 3, v0
    v_bfe_u32 v54, v0, 2, 1
    v_xor_b32_e64 v52, v52, v54
    v_mfma_f32_32x32x16_bf16 v[240:255], v[92:95], v[180:183], v[240:255]
    v_bfe_u32 v54, v0, 3, 1
    v_lshl_or_b32 v52, v52, 1, v54
    v_lshlrev_b32_e64 v52, 4, v52
    v_bfe_u32 v54, v0, 2, 2
    s_waitcnt vmcnt(6)
    v_mfma_f32_32x32x16_bf16 v[192:207], v[96:99], v[32:35], v[192:207]
    s_add_u32 s90, s82, 12288
    buffer_load_dwordx4 v[64:67], v7, s[16:19], s90 offen offset:0 sc1
    s_add_u32 s90, s82, 126976
    buffer_load_dwordx4 v[68:71], v7, s[16:19], s90 offen offset:0 sc1
    ds_read_b64_tr_b16 v[136:137], v16 offset:16384
    ds_read_b64_tr_b16 v[138:139], v16 offset:16896
    v_mfma_f32_32x32x16_bf16 v[208:223], v[100:103], v[32:35], v[208:223]
    ds_read_b64_tr_b16 v[140:141], v17 offset:16384
    ds_read_b64_tr_b16 v[142:143], v17 offset:16896
    ds_read_b64_tr_b16 v[144:145], v16 offset:49152
    ds_read_b64_tr_b16 v[146:147], v16 offset:49664
    ds_read_b64_tr_b16 v[148:149], v17 offset:49152
    ds_read_b64_tr_b16 v[150:151], v17 offset:49664
    s_waitcnt vmcnt(7)
    v_mfma_f32_32x32x16_bf16 v[224:239], v[96:99], v[36:39], v[224:239]
    v_lshl_or_b32 v52, v54, 7, v52
    v_lshl_add_u32 v53, v53, 2, v54
    v_lshrrev_b32_e64 v54, 4, v0
    v_lshl_or_b32 v52, v54, 12, v52
    s_and_b32 s84, s44, 3
    v_mfma_f32_32x32x16_bf16 v[240:255], v[100:103], v[36:39], v[240:255]
    s_lshl_b32 s84, s84, 10
    s_lshr_b32 s85, s44, 2
    s_lshl_b32 s85, s85, 15
    s_add_u32 s84, s84, s85
    v_add_u32 v48, s84, v52
    v_xor_b32 v49, 64, v48
    s_waitcnt vmcnt(6)
    v_mfma_f32_32x32x16_bf16 v[192:207], v[104:107], v[184:187], v[192:207]
    s_add_u32 s90, s82, 12288
    buffer_load_dwordx4 v[168:171], v7, s[16:19], s90 offen offset:1024 sc1
    s_add_u32 s90, s82, 126976
    buffer_load_dwordx4 v[172:175], v7, s[16:19], s90 offen offset:1024 sc1
    ds_read_b64_tr_b16 v[152:153], v16 offset:32768
    ds_read_b64_tr_b16 v[154:155], v16 offset:33280
    ds_read_b64_tr_b16 v[156:157], v17 offset:32768
    v_mfma_f32_32x32x16_bf16 v[208:223], v[108:111], v[184:187], v[208:223]
    ds_read_b64_tr_b16 v[158:159], v17 offset:33280
    ds_read_b64_tr_b16 v[160:161], v16 offset:0
    ds_read_b64_tr_b16 v[162:163], v16 offset:512
    ds_read_b64_tr_b16 v[164:165], v17 offset:0
    ds_read_b64_tr_b16 v[166:167], v17 offset:512
    s_waitcnt vmcnt(7)
    v_mfma_f32_32x32x16_bf16 v[224:239], v[104:107], v[188:191], v[224:239]
    v_xor_b32 v50, 16, v48
    v_xor_b32 v51, 80, v48
    v_lshlrev_b32_e64 v55, 3, v53
    v_mul_u32_u24 v52, 896, v53
    v_and_b32_e64 v53, 16, v0
    v_mfma_f32_32x32x16_bf16 v[240:255], v[108:111], v[188:191], v[240:255]
    v_lshl_add_u32 v52, v53, 2, v52
    v_and_b32_e64 v53, 3, v0
    v_lshl_add_u32 v52, v53, 4, v52
    v_mov_b32 v53, 0x3f80
    v_mov_b32_e64 v54, 0x3f800000
    v_cndmask_b32 v53, v53, v54, s[86:87]
    s_waitcnt vmcnt(4)
    v_cmp_ne_u32_e64 vcc, s49, v3
    s_nop 0
    s_cmp_eq_u64 vcc, 0
    s_cbranch_scc0 L_fohslow_8
L_fohok_7:
    v_mfma_f32_32x32x16_bf16 v[192:207], v[112:115], v[56:59], v[192:207]
    buffer_load_dwordx4 v[72:75], v7, s[16:19], s78 offen offset:0 sc1
    buffer_load_dwordx4 v[76:79], v7, s[16:19], s78 offen offset:1024 sc1
    v_bfe_u32 v54, v0, 1, 3
    v_mfma_f32_32x32x16_bf16 v[208:223], v[116:119], v[56:59], v[208:223]
    s_lshl_b32 s98, s47, 3
    s_add_u32 s98, s98, s44
    s_lshl_b32 s83, s98, 6
    v_mfma_f32_32x32x16_bf16 v[224:239], v[112:115], v[60:63], v[224:239]
    s_add_u32 s83, s83, 180224
    s_mul_i32 s98, s98, 7168
    s_lshl_b32 s85, s48, 7
    v_mfma_f32_32x32x16_bf16 v[240:255], v[116:119], v[60:63], v[240:255]
    s_add_u32 s98, s98, s85
    v_cmp_eq_u32 s[86:87], 0, v54
    s_nop 1
    v_cndmask_b32 v44, 0, v53, s[86:87]
    v_cmp_eq_u32 s[86:87], 1, v54
    s_nop 1
    v_cndmask_b32 v45, 0, v53, s[86:87]
    v_cmp_eq_u32 s[86:87], 2, v54
    s_nop 1
    v_cndmask_b32 v46, 0, v53, s[86:87]
    s_waitcnt vmcnt(5)
    v_mfma_f32_32x32x16_bf16 v[192:207], v[120:123], v[64:67], v[192:207]
    buffer_load_dwordx4 v[24:27], v7, s[16:19], s78 offen offset:2048 sc1
    buffer_load_dwordx4 v[28:31], v7, s[16:19], s78 offen offset:3072 sc1
    v_mfma_f32_32x32x16_bf16 v[208:223], v[124:127], v[64:67], v[208:223]
    v_cmp_eq_u32 s[86:87], 3, v54
    s_nop 1
    v_cndmask_b32 v47, 0, v53, s[86:87]
    v_cmp_eq_u32 s[86:87], 4, v54
    s_nop 1
    v_cndmask_b32 v20, 0, v53, s[86:87]
    s_waitcnt vmcnt(6)
    v_mfma_f32_32x32x16_bf16 v[224:239], v[120:123], v[68:71], v[224:239]
    v_cmp_eq_u32 s[86:87], 5, v54
    s_nop 1
    v_cndmask_b32 v21, 0, v53, s[86:87]
    v_cmp_eq_u32 s[86:87], 6, v54
    s_nop 1
    v_cndmask_b32 v22, 0, v53, s[86:87]
    v_mfma_f32_32x32x16_bf16 v[240:255], v[124:127], v[68:71], v[240:255]
    v_cmp_eq_u32 s[86:87], 7, v54
    s_nop 1
    v_cndmask_b32 v23, 0, v53, s[86:87]
    buffer_load_dwordx2 v[4:5], v55, s[16:19], s83 offen sc1
    s_waitcnt vmcnt(6)
    v_mfma_f32_32x32x16_bf16 v[192:207], v[128:131], v[168:171], v[192:207]
    v_mfma_f32_32x32x16_bf16 v[208:223], v[132:135], v[168:171], v[208:223]
    buffer_load_dwordx4 v[80:83], v7, s[16:19], s96 offen offset:0 sc1
    s_waitcnt vmcnt(6)
    v_mfma_f32_32x32x16_bf16 v[224:239], v[128:131], v[172:175], v[224:239]
    v_mfma_f32_32x32x16_bf16 v[240:255], v[132:135], v[172:175], v[240:255]
    buffer_load_dwordx4 v[84:87], v7, s[16:19], s96 offen offset:1024 sc1
    s_waitcnt lgkmcnt(0)
    s_waitcnt vmcnt(6)
    v_cmp_ne_u16_sdwa vcc, v75, s80 src0_sel:WORD_1 src1_sel:WORD_0
    s_waitcnt vmcnt(5)
    v_cmp_ne_u16_sdwa s[56:57], v79, s80 src0_sel:WORD_1 src1_sel:WORD_0
    s_nop 0
    s_or_b64 vcc, vcc, s[56:57]
    s_nop 0
    s_cmp_eq_u64 vcc, 0
    s_cbranch_scc0 L_fo0slow_10
L_fo0ok_9:
    v_and_b32 v75, 0xffff, v75
    v_and_b32 v79, 0xffff, v79
    s_nop 0
    v_mfma_f32_32x32x16_bf16 v[192:207], v[136:139], v[72:75], v[192:207]
    v_mfma_f32_32x32x16_bf16 v[208:223], v[140:143], v[72:75], v[208:223]
    s_waitcnt vmcnt(4)
    v_cmp_ne_u16_sdwa vcc, v27, s80 src0_sel:WORD_1 src1_sel:WORD_0
    s_waitcnt vmcnt(3)
    v_cmp_ne_u16_sdwa s[56:57], v31, s80 src0_sel:WORD_1 src1_sel:WORD_0
    s_nop 0
    s_or_b64 vcc, vcc, s[56:57]
    s_nop 0
    s_cmp_eq_u64 vcc, 0
    s_cbranch_scc0 L_fo1slow_12
L_fo1ok_11:
    v_and_b32 v27, 0xffff, v27
    v_and_b32 v31, 0xffff, v31
    v_mfma_f32_32x32x16_bf16 v[192:207], v[144:147], v[76:79], v[192:207]
    buffer_load_dwordx4 v[176:179], v7, s[16:19], s96 offen offset:2048 sc1
    v_mfma_f32_32x32x16_bf16 v[208:223], v[148:151], v[76:79], v[208:223]
    buffer_load_dwordx4 v[180:183], v7, s[16:19], s96 offen offset:3072 sc1
    v_mfma_f32_32x32x16_bf16 v[192:207], v[152:155], v[24:27], v[192:207]
    v_mfma_f32_32x32x16_bf16 v[208:223], v[156:159], v[24:27], v[208:223]
    s_waitcnt vmcnt(3)
    v_cmp_ne_u16_sdwa vcc, v83, s80 src0_sel:WORD_1 src1_sel:WORD_0
    s_waitcnt vmcnt(2)
    v_cmp_ne_u16_sdwa s[56:57], v87, s80 src0_sel:WORD_1 src1_sel:WORD_0
    s_nop 0
    s_or_b64 vcc, vcc, s[56:57]
    s_nop 0
    s_cmp_eq_u64 vcc, 0
    s_cbranch_scc0 L_fo2slow_14
L_fo2ok_13:
    v_and_b32 v83, 0xffff, v83
    v_and_b32 v87, 0xffff, v87
    v_mfma_f32_32x32x16_bf16 v[192:207], v[160:163], v[28:31], v[192:207]
    v_mfma_f32_32x32x16_bf16 v[208:223], v[164:167], v[28:31], v[208:223]
    v_mfma_f32_32x32x16_bf16 v[224:239], v[136:139], v[80:83], v[224:239]
    v_mfma_f32_32x32x16_bf16 v[240:255], v[140:143], v[80:83], v[240:255]
    s_waitcnt vmcnt(1)
    v_cmp_ne_u16_sdwa vcc, v179, s80 src0_sel:WORD_1 src1_sel:WORD_0
    s_waitcnt vmcnt(0)
    v_cmp_ne_u16_sdwa s[56:57], v183, s80 src0_sel:WORD_1 src1_sel:WORD_0
    s_nop 0
    s_or_b64 vcc, vcc, s[56:57]
    s_nop 0
    s_cmp_eq_u64 vcc, 0
    s_cbranch_scc0 L_fo3slow_16
L_fo3ok_15:
    v_and_b32 v179, 0xffff, v179
    v_and_b32 v183, 0xffff, v183
    v_mfma_f32_32x32x16_bf16 v[224:239], v[144:147], v[84:87], v[224:239]
    v_cvt_pk_bf16_f32 v192, v192, v193
    v_cvt_pk_bf16_f32 v193, v194, v195
    v_cvt_pk_bf16_f32 v194, v208, v209
    v_cvt_pk_bf16_f32 v195, v210, v211
    ds_write_b128 v40, v[192:195] offset:0
    v_mfma_f32_32x32x16_bf16 v[240:255], v[148:151], v[84:87], v[240:255]
    v_cvt_pk_bf16_f32 v196, v196, v197
    v_cvt_pk_bf16_f32 v197, v198, v199
    v_cvt_pk_bf16_f32 v198, v212, v213
    v_cvt_pk_bf16_f32 v199, v214, v215
    ds_write_b128 v41, v[196:199] offset:0
    v_mfma_f32_32x32x16_bf16 v[224:239], v[152:155], v[176:179], v[224:239]
    v_cvt_pk_bf16_f32 v200, v200, v201
    v_cvt_pk_bf16_f32 v201, v202, v203
    v_mfma_f32_32x32x16_bf16 v[240:255], v[156:159], v[176:179], v[240:255]
    v_cvt_pk_bf16_f32 v202, v216, v217
    v_cvt_pk_bf16_f32 v203, v218, v219
    ds_write_b128 v42, v[200:203] offset:0
    v_mfma_f32_32x32x16_bf16 v[224:239], v[160:163], v[180:183], v[224:239]
    v_cvt_pk_bf16_f32 v204, v204, v205
    v_cvt_pk_bf16_f32 v205, v206, v207
    v_mfma_f32_32x32x16_bf16 v[240:255], v[164:167], v[180:183], v[240:255]
    v_cvt_pk_bf16_f32 v206, v220, v221
    v_cvt_pk_bf16_f32 v207, v222, v223
    ds_write_b128 v43, v[204:207] offset:0
    v_cmp_ne_u32 vcc, s49, v5
    s_nop 0
    s_cmp_eq_u64 vcc, 0
    s_cbranch_scc0 L_fgslow_18
L_fgok_17:
    s_nop 1
    v_cvt_pk_bf16_f32 v224, v224, v225
    v_cvt_pk_bf16_f32 v225, v226, v227
    s_nop 0
    v_cvt_pk_bf16_f32 v226, v240, v241
    v_cvt_pk_bf16_f32 v227, v242, v243
    ds_write_b128 v40, v[224:227] offset:32768
    v_cvt_pk_bf16_f32 v228, v228, v229
    v_cvt_pk_bf16_f32 v229, v230, v231
    v_cvt_pk_bf16_f32 v230, v244, v245
    v_cvt_pk_bf16_f32 v231, v246, v247
    ds_write_b128 v41, v[228:231] offset:32768
    v_cvt_pk_bf16_f32 v232, v232, v233
    v_cvt_pk_bf16_f32 v233, v234, v235
    v_cvt_pk_bf16_f32 v234, v248, v249
    v_cvt_pk_bf16_f32 v235, v250, v251
    ds_write_b128 v42, v[232:235] offset:32768
    v_cvt_pk_bf16_f32 v236, v236, v237
    v_cvt_pk_bf16_f32 v237, v238, v239
    v_cvt_pk_bf16_f32 v238, v252, v253
    v_cvt_pk_bf16_f32 v239, v254, v255
    ds_write_b128 v43, v[236:239] offset:32768
    s_waitcnt lgkmcnt(0)
    s_barrier
    ds_read_b128 v[208:211], v48 offset:0
    ds_read_b128 v[212:215], v48 offset:16384
    ds_read_b128 v[216:219], v49 offset:512
    ds_read_b128 v[220:223], v49 offset:16896
    ds_read_b128 v[224:227], v50 offset:0
    ds_read_b128 v[228:231], v50 offset:16384
    ds_read_b128 v[232:235], v51 offset:512
    ds_read_b128 v[236:239], v51 offset:16896
    s_waitcnt lgkmcnt(7)
    v_mfma_f32_16x16x32_bf16 v[192:195], v[44:47], v[208:211], 0
    s_waitcnt lgkmcnt(6)
    v_mfma_f32_16x16x32_bf16 v[192:195], v[44:47], v[212:215], v[192:195]
    s_waitcnt lgkmcnt(5)
    v_mfma_f32_16x16x32_bf16 v[192:195], v[20:23], v[216:219], v[192:195]
    s_waitcnt lgkmcnt(4)
    v_mfma_f32_16x16x32_bf16 v[192:195], v[20:23], v[220:223], v[192:195]
    s_waitcnt lgkmcnt(3)
    v_mfma_f32_16x16x32_bf16 v[196:199], v[44:47], v[224:227], 0
    s_waitcnt lgkmcnt(2)
    v_mfma_f32_16x16x32_bf16 v[196:199], v[44:47], v[228:231], v[196:199]
    s_waitcnt lgkmcnt(1)
    v_mfma_f32_16x16x32_bf16 v[196:199], v[20:23], v[232:235], v[196:199]
    s_waitcnt lgkmcnt(0)
    v_mfma_f32_16x16x32_bf16 v[196:199], v[20:23], v[236:239], v[196:199]
    v_pk_mul_f32 v[192:193], v[192:193], v[4:5] op_sel_hi:[1,0]
    v_pk_mul_f32 v[194:195], v[194:195], v[4:5] op_sel_hi:[1,0]
    s_nop 5
    v_pk_mul_f32 v[196:197], v[196:197], v[4:5] op_sel_hi:[1,0]
    v_pk_mul_f32 v[198:199], v[198:199], v[4:5] op_sel_hi:[1,0]
    v_cvt_pk_bf16_f32 v40, v192, v193
    v_cvt_pk_bf16_f32 v41, v194, v195
    v_cvt_pk_bf16_f32 v42, v196, v197
    v_cvt_pk_bf16_f32 v43, v198, v199
    buffer_store_dwordx4 v[40:43], v52, s[28:31], s98 offen sc1
    s_endpgm
L_faslow:
    s_nop 11
    s_mov_b32 s88, 200000
    s_nop 1
L_fa_19:
    buffer_load_dword v5, v4, s[16:19], s81 offen offset:32 sc1
    s_waitcnt vmcnt(0)
    v_cmp_ne_u32_e64 vcc, s49, v5
    s_nop 0
    s_cmp_eq_u64 vcc, 0
    s_cbranch_scc1 L_fad_20
    s_sub_u32 s88, s88, 1
    s_cmp_lg_u32 s88, 0
    s_cbranch_scc1 L_fa_19
L_fad_20:
    s_branch L_faok
L_fabslow_3:
    s_nop 11
    s_mov_b32 s88, 200000
    s_nop 1
L_fab_21:
    buffer_load_dword v5, v4, s[16:19], s81 offen sc1
    s_waitcnt vmcnt(0)
    v_cmp_ne_u32_e64 vcc, s49, v5
    s_nop 0
    s_cmp_eq_u64 vcc, 0
    s_cbranch_scc1 L_fabd_22
    s_sub_u32 s88, s88, 1
    s_cmp_lg_u32 s88, 0
    s_cbranch_scc1 L_fab_21
L_fabd_22:
    s_branch L_fabok_2
L_fa1slow_6:
    s_nop 11
    s_mov_b32 s88, 200000
    s_nop 1
L_fa1_23:
    buffer_load_dword v2, v4, s[16:19], s81 offen offset:16 sc1
    s_waitcnt vmcnt(0)
    v_cmp_ne_u32_e64 vcc, s49, v2
    s_nop 0
    s_cmp_eq_u64 vcc, 0
    s_cbranch_scc1 L_fa1d_24
    s_sub_u32 s88, s88, 1
    s_cmp_lg_u32 s88, 0
    s_cbranch_scc1 L_fa1_23
L_fa1d_24:
    s_branch L_fa1ok_5
L_fohslow_8:
    s_nop 11
    s_mov_b32 s88, 200000
    s_nop 1
L_foh_25:
    buffer_load_dword v3, v1, s[16:19], s79 offen sc1
    s_waitcnt vmcnt(0)
    v_cmp_ne_u32_e64 vcc, s49, v3
    s_nop 0
    s_cmp_eq_u64 vcc, 0
    s_cbranch_scc1 L_fohd_26
    s_sub_u32 s88, s88, 1
    s_cmp_lg_u32 s88, 0
    s_cbranch_scc1 L_foh_25
L_fohd_26:
    s_branch L_fohok_7
L_fo0slow_10:
    s_nop 11
    s_mov_b32 s88, 200000
    s_nop 1
L_fo0_27:
    buffer_load_dwordx4 v[72:75], v7, s[16:19], s78 offen offset:0 sc1
    buffer_load_dwordx4 v[76:79], v7, s[16:19], s78 offen offset:1024 sc1
    s_waitcnt vmcnt(0)
    v_cmp_ne_u16_sdwa vcc, v75, s80 src0_sel:WORD_1 src1_sel:WORD_0
    v_cmp_ne_u16_sdwa s[56:57], v79, s80 src0_sel:WORD_1 src1_sel:WORD_0
    s_nop 0
    s_or_b64 vcc, vcc, s[56:57]
    s_nop 0
    s_cmp_eq_u64 vcc, 0
    s_cbranch_scc1 L_fo0d_28
    s_sub_u32 s88, s88, 1
    s_cmp_lg_u32 s88, 0
    s_cbranch_scc1 L_fo0_27
L_fo0d_28:
    s_branch L_fo0ok_9
L_fo1slow_12:
    s_nop 11
    s_mov_b32 s88, 200000
    s_nop 1
L_fo1_29:
    buffer_load_dwordx4 v[24:27], v7, s[16:19], s78 offen offset:2048 sc1
    buffer_load_dwordx4 v[28:31], v7, s[16:19], s78 offen offset:3072 sc1
    s_waitcnt vmcnt(0)
    v_cmp_ne_u16_sdwa vcc, v27, s80 src0_sel:WORD_1 src1_sel:WORD_0
    v_cmp_ne_u16_sdwa s[56:57], v31, s80 src0_sel:WORD_1 src1_sel:WORD_0
    s_nop 0
    s_or_b64 vcc, vcc, s[56:57]
    s_nop 0
    s_cmp_eq_u64 vcc, 0
    s_cbranch_scc1 L_fo1d_30
    s_sub_u32 s88, s88, 1
    s_cmp_lg_u32 s88, 0
    s_cbranch_scc1 L_fo1_29
L_fo1d_30:
    s_branch L_fo1ok_11
L_fo2slow_14:
    s_nop 11
    s_mov_b32 s88, 200000
    s_nop 1
L_fo2_31:
    buffer_load_dwordx4 v[80:83], v7, s[16:19], s96 offen offset:0 sc1
    buffer_load_dwordx4 v[84:87], v7, s[16:19], s96 offen offset:1024 sc1
    s_waitcnt vmcnt(0)
    v_cmp_ne_u16_sdwa vcc, v83, s80 src0_sel:WORD_1 src1_sel:WORD_0
    v_cmp_ne_u16_sdwa s[56:57], v87, s80 src0_sel:WORD_1 src1_sel:WORD_0
    s_nop 0
    s_or_b64 vcc, vcc, s[56:57]
    s_nop 0
    s_cmp_eq_u64 vcc, 0
    s_cbranch_scc1 L_fo2d_32
    s_sub_u32 s88, s88, 1
    s_cmp_lg_u32 s88, 0
    s_cbranch_scc1 L_fo2_31
L_fo2d_32:
    s_branch L_fo2ok_13
L_fo3slow_16:
    s_nop 11
    s_mov_b32 s88, 200000
    s_nop 1
L_fo3_33:
    buffer_load_dwordx4 v[176:179], v7, s[16:19], s96 offen offset:2048 sc1
    buffer_load_dwordx4 v[180:183], v7, s[16:19], s96 offen offset:3072 sc1
    s_waitcnt vmcnt(0)
    v_cmp_ne_u16_sdwa vcc, v179, s80 src0_sel:WORD_1 src1_sel:WORD_0
    v_cmp_ne_u16_sdwa s[56:57], v183, s80 src0_sel:WORD_1 src1_sel:WORD_0
    s_nop 0
    s_or_b64 vcc, vcc, s[56:57]
    s_nop 0
    s_cmp_eq_u64 vcc, 0
    s_cbranch_scc1 L_fo3d_34
    s_sub_u32 s88, s88, 1
    s_cmp_lg_u32 s88, 0
    s_cbranch_scc1 L_fo3_33
L_fo3d_34:
    s_branch L_fo3ok_15
L_fgslow_18:
    s_nop 11
    s_mov_b32 s88, 200000
    s_nop 1
L_fg_35:
    buffer_load_dwordx2 v[4:5], v55, s[16:19], s83 offen sc1
    s_waitcnt vmcnt(0)
    v_cmp_ne_u32 vcc, s49, v5
    s_nop 0
    s_cmp_eq_u64 vcc, 0
    s_cbranch_scc1 L_fgd_36
    s_sub_u32 s88, s88, 1
    s_cmp_lg_u32 s88, 0
    s_cbranch_scc1 L_fg_35
L_fgd_36:
    s_branch L_fgok_17
L_F3:
    s_add_u32 m0, s51, 32768
    s_mov_b64 exec, s[56:57]
    buffer_load_dwordx4 v4, s[12:15], s7 offen lds
    s_mov_b64 exec, -1
    s_add_u32 s7, s7, s95
    s_add_u32 m0, s51, 40960
    s_mov_b64 exec, s[56:57]
    buffer_load_dwordx4 v4, s[12:15], s7 offen lds
    s_mov_b64 exec, -1
    s_add_u32 s7, s7, s95
    s_add_u32 m0, s51, 49152
    s_mov_b64 exec, s[56:57]
    buffer_load_dwordx4 v4, s[12:15], s7 offen lds
    s_mov_b64 exec, -1
    s_add_u32 s7, s7, s95
    s_add_u32 m0, s51, 57344
    s_mov_b64 exec, s[56:57]
    buffer_load_dwordx4 v4, s[12:15], s7 offen lds
    s_mov_b64 exec, -1
    s_waitcnt lgkmcnt(0)
    s_lshr_b32 s80, s49, 16
    s_add_u32 s80, s80, 0x2a5b
    s_and_b32 s80, s80, 0x3fff
    s_lshl_b32 s50, s80, 16
    s_mul_i32 s49, s49, 1664525
    s_add_u32 s49, s49, 1013904223
    s_lshr_b32 s49, s49, 16
    s_or_b32 s49, s49, s50
    s_waitcnt vmcnt(6)
    v_lshlrev_b32 v34, 16, v32
    ds_write_b32 v107, v34
    s_waitcnt lgkmcnt(0)
    s_barrier
    ds_read_b128 v[144:147], v16 offset:0
    ds_read_b128 v[148:151], v16 offset:2048
    ds_read_b64_tr_b16 v[160:161], v8 offset:0
    ds_read_b64_tr_b16 v[162:163], v8 offset:2048
    ds_read_b64_tr_b16 v[164:165], v9 offset:0
    ds_read_b64_tr_b16 v[166:167], v9 offset:2048
    ds_read_b64_tr_b16 v[168:169], v10 offset:0
    ds_read_b64_tr_b16 v[170:171], v10 offset:2048
    ds_read_b128 v[192:195], v109 offset:0
    ds_read_b128 v[196:199], v109 offset:32
    ds_read_b128 v[200:203], v109 offset:0
    ds_read_b128 v[204:207], v109 offset:32
    ds_read_b128 v[208:211], v109 offset:128
    ds_read_b128 v[212:215], v109 offset:160
    ds_read_b128 v[216:219], v109 offset:128
    ds_read_b128 v[220:223], v109 offset:160
    ds_read_b128 v[224:227], v109 offset:256
    ds_read_b128 v[228:231], v109 offset:288
    ds_read_b128 v[232:235], v109 offset:256
    ds_read_b128 v[236:239], v109 offset:288
    s_waitcnt lgkmcnt(11)
    v_mfma_f32_16x16x32_bf16 v[192:195], v[160:163], v[144:147], v[192:195]
    ds_read_b64_tr_b16 v[176:177], v11 offset:0
    s_waitcnt lgkmcnt(10)
    v_mfma_f32_16x16x32_bf16 v[200:203], v[160:163], v[148:151], v[200:203]
    ds_read_b64_tr_b16 v[178:179], v11 offset:2048
    v_mfma_f32_16x16x32_bf16 v[196:199], v[164:167], v[144:147], v[196:199]
    ds_read_b64_tr_b16 v[180:181], v12 offset:0
    ds_read_b64_tr_b16 v[182:183], v12 offset:2048
    s_waitcnt lgkmcnt(12)
    v_mfma_f32_16x16x32_bf16 v[204:207], v[164:167], v[148:151], v[204:207]
    ds_read_b64_tr_b16 v[184:185], v13 offset:0
    s_waitcnt lgkmcnt(12)
    v_mfma_f32_16x16x32_bf16 v[208:211], v[168:171], v[144:147], v[208:211]
    ds_read_b64_tr_b16 v[186:187], v13 offset:2048
    s_waitcnt lgkmcnt(11)
    v_mfma_f32_16x16x32_bf16 v[216:219], v[168:171], v[148:151], v[216:219]
    s_add_u32 s6, s3, 2
    s_sub_u32 s7, s6, 6
    s_cmp_ge_u32 s6, 7
    s_cselect_b32 s6, s7, s6
    s_mul_i32 s7, s6, s95
    s_lshl_b32 s7, s7, 2
    s_lshl_b32 s6, s6, 7
    s_add_u32 m0, s51, 131072
    s_nop 0
    buffer_load_dwordx4 v5, s[8:11], s6 offen lds
    s_add_u32 m0, s51, 139264
    s_add_u32 s52, s6, 57344
    buffer_load_dwordx4 v5, s[8:11], s52 offen lds
    s_waitcnt lgkmcnt(4)
    v_mfma_f32_16x16x32_bf16 v[212:215], v[176:179], v[144:147], v[212:215]
    ds_read_b128 v[152:155], v17 offset:0
    v_mfma_f32_16x16x32_bf16 v[220:223], v[176:179], v[148:151], v[220:223]
    ds_read_b128 v[156:159], v17 offset:2048
    ds_read_b64_tr_b16 v[160:161], v8 offset:16384
    s_waitcnt lgkmcnt(5)
    v_mfma_f32_16x16x32_bf16 v[224:227], v[180:183], v[144:147], v[224:227]
    ds_read_b64_tr_b16 v[162:163], v8 offset:18432
    ds_read_b64_tr_b16 v[164:165], v9 offset:16384
    v_mfma_f32_16x16x32_bf16 v[232:235], v[180:183], v[148:151], v[232:235]
    ds_read_b64_tr_b16 v[166:167], v9 offset:18432
    s_waitcnt lgkmcnt(6)
    v_mfma_f32_16x16x32_bf16 v[228:231], v[184:187], v[144:147], v[228:231]
    ds_read_b64_tr_b16 v[168:169], v10 offset:16384
    ds_read_b64_tr_b16 v[170:171], v10 offset:18432
    v_mfma_f32_16x16x32_bf16 v[236:239], v[184:187], v[148:151], v[236:239]
    s_add_u32 m0, s51, 65536
    s_nop 0
    buffer_load_dwordx4 v4, s[12:15], s7 offen lds
    s_add_u32 s7, s7, s95
    s_add_u32 m0, s51, 73728
    s_nop 0
    buffer_load_dwordx4 v4, s[12:15], s7 offen lds
    s_add_u32 s7, s7, s95
    s_waitcnt lgkmcnt(4)
    v_mfma_f32_16x16x32_bf16 v[192:195], v[160:163], v[152:155], v[192:195]
    ds_read_b64_tr_b16 v[176:177], v11 offset:16384
    v_mfma_f32_16x16x32_bf16 v[200:203], v[160:163], v[156:159], v[200:203]
    ds_read_b64_tr_b16 v[178:179], v11 offset:18432
    s_waitcnt lgkmcnt(4)
    v_mfma_f32_16x16x32_bf16 v[196:199], v[164:167], v[152:155], v[196:199]
    ds_read_b64_tr_b16 v[180:181], v12 offset:16384
    ds_read_b64_tr_b16 v[182:183], v12 offset:18432
    v_mfma_f32_16x16x32_bf16 v[204:207], v[164:167], v[156:159], v[204:207]
    ds_read_b64_tr_b16 v[184:185], v13 offset:16384
    s_waitcnt lgkmcnt(5)
    v_mfma_f32_16x16x32_bf16 v[208:211], v[168:171], v[152:155], v[208:211]
    ds_read_b64_tr_b16 v[186:187], v13 offset:18432
    v_mfma_f32_16x16x32_bf16 v[216:219], v[168:171], v[156:159], v[216:219]
    s_add_u32 m0, s51, 81920
    s_nop 0
    buffer_load_dwordx4 v4, s[12:15], s7 offen lds
    s_add_u32 s7, s7, s95
    s_add_u32 m0, s51, 90112
    s_nop 0
    buffer_load_dwordx4 v4, s[12:15], s7 offen lds
    s_waitcnt lgkmcnt(0)
    v_mfma_f32_16x16x32_bf16 v[212:215], v[176:179], v[152:155], v[212:215]
    s_waitcnt vmcnt(6)
    s_barrier
    v_mfma_f32_16x16x32_bf16 v[220:223], v[176:179], v[156:159], v[220:223]
    ds_read_b128 v[144:147], v16 offset:16384
    ds_read_b128 v[148:151], v16 offset:18432
    v_mfma_f32_16x16x32_bf16 v[224:227], v[180:183], v[152:155], v[224:227]
    ds_read_b64_tr_b16 v[160:161], v8 offset:32768
    ds_read_b64_tr_b16 v[162:163], v8 offset:34816
    v_mfma_f32_16x16x32_bf16 v[232:235], v[180:183], v[156:159], v[232:235]
    ds_read_b64_tr_b16 v[164:165], v9 offset:32768
    ds_read_b64_tr_b16 v[166:167], v9 offset:34816
    v_mfma_f32_16x16x32_bf16 v[228:231], v[184:187], v[152:155], v[228:231]
    ds_read_b64_tr_b16 v[168:169], v10 offset:32768
    ds_read_b64_tr_b16 v[170:171], v10 offset:34816
    v_mfma_f32_16x16x32_bf16 v[236:239], v[184:187], v[156:159], v[236:239]
    s_add_u32 s6, s3, 3
    s_sub_u32 s7, s6, 6
    s_cmp_ge_u32 s6, 7
    s_cselect_b32 s6, s7, s6
    s_mul_i32 s7, s6, s95
    s_lshl_b32 s7, s7, 2
    s_lshl_b32 s6, s6, 7
    s_add_u32 m0, s51, 98304
    s_nop 0
    buffer_load_dwordx4 v5, s[8:11], s6 offen lds
    s_add_u32 m0, s51, 106496
    s_add_u32 s52, s6, 57344
    buffer_load_dwordx4 v5, s[8:11], s52 offen lds
    s_waitcnt lgkmcnt(4)
    v_mfma_f32_16x16x32_bf16 v[192:195], v[160:163], v[144:147], v[192:195]
    ds_read_b64_tr_b16 v[176:177], v11 offset:32768
    v_mfma_f32_16x16x32_bf16 v[200:203], v[160:163], v[148:151], v[200:203]
    ds_read_b64_tr_b16 v[178:179], v11 offset:34816
    s_waitcnt lgkmcnt(4)
    v_mfma_f32_16x16x32_bf16 v[196:199], v[164:167], v[144:147], v[196:199]
    ds_read_b64_tr_b16 v[180:181], v12 offset:32768
    ds_read_b64_tr_b16 v[182:183], v12 offset:34816
    v_mfma_f32_16x16x32_bf16 v[204:207], v[164:167], v[148:151], v[204:207]
    ds_read_b64_tr_b16 v[184:185], v13 offset:32768
    s_waitcnt lgkmcnt(5)
    v_mfma_f32_16x16x32_bf16 v[208:211], v[168:171], v[144:147], v[208:211]
    ds_read_b64_tr_b16 v[186:187], v13 offset:34816
    v_mfma_f32_16x16x32_bf16 v[216:219], v[168:171], v[148:151], v[216:219]
    s_add_u32 m0, s51, 0
    s_nop 0
    buffer_load_dwordx4 v4, s[12:15], s7 offen lds
    s_add_u32 s7, s7, s95
    s_add_u32 m0, s51, 8192
    s_nop 0
    buffer_load_dwordx4 v4, s[12:15], s7 offen lds
    s_add_u32 s7, s7, s95
    s_waitcnt lgkmcnt(4)
    v_mfma_f32_16x16x32_bf16 v[212:215], v[176:179], v[144:147], v[212:215]
    ds_read_b128 v[152:155], v17 offset:16384
    ds_read_b128 v[156:159], v17 offset:18432
    v_mfma_f32_16x16x32_bf16 v[220:223], v[176:179], v[148:151], v[220:223]
    ds_read_b64_tr_b16 v[160:161], v8 offset:49152
    ds_read_b64_tr_b16 v[162:163], v8 offset:51200
    s_waitcnt lgkmcnt(6)
    v_mfma_f32_16x16x32_bf16 v[224:227], v[180:183], v[144:147], v[224:227]
    ds_read_b64_tr_b16 v[164:165], v9 offset:49152
    ds_read_b64_tr_b16 v[166:167], v9 offset:51200
    v_mfma_f32_16x16x32_bf16 v[232:235], v[180:183], v[148:151], v[232:235]
    ds_read_b64_tr_b16 v[168:169], v10 offset:49152
    ds_read_b64_tr_b16 v[170:171], v10 offset:51200
    s_waitcnt lgkmcnt(8)
    v_mfma_f32_16x16x32_bf16 v[228:231], v[184:187], v[144:147], v[228:231]
    s_add_u32 m0, s51, 16384
    s_nop 0
    buffer_load_dwordx4 v4, s[12:15], s7 offen lds
    s_add_u32 s7, s7, s95
    s_add_u32 m0, s51, 24576
    s_nop 0
    buffer_load_dwordx4 v4, s[12:15], s7 offen lds
    v_mfma_f32_16x16x32_bf16 v[236:239], v[184:187], v[148:151], v[236:239]
    buffer_load_dword v108, v104, s[20:23], 0 offen
    buffer_load_dword v108, v105, s[24:27], 0 offen
    buffer_load_dword v108, v106, s[16:19], 0 offen
    s_waitcnt lgkmcnt(4)
    v_mfma_f32_16x16x32_bf16 v[192:195], v[160:163], v[152:155], v[192:195]
    ds_read_b64_tr_b16 v[176:177], v11 offset:49152
    v_mfma_f32_16x16x32_bf16 v[200:203], v[160:163], v[156:159], v[200:203]
    ds_read_b64_tr_b16 v[178:179], v11 offset:51200
    s_waitcnt lgkmcnt(4)
    v_mfma_f32_16x16x32_bf16 v[196:199], v[164:167], v[152:155], v[196:199]
    ds_read_b64_tr_b16 v[180:181], v12 offset:49152
    v_mfma_f32_16x16x32_bf16 v[204:207], v[164:167], v[156:159], v[204:207]
    ds_read_b64_tr_b16 v[182:183], v12 offset:51200
    s_waitcnt lgkmcnt(4)
    v_mfma_f32_16x16x32_bf16 v[208:211], v[168:171], v[152:155], v[208:211]
    ds_read_b64_tr_b16 v[184:185], v13 offset:49152
    v_mfma_f32_16x16x32_bf16 v[216:219], v[168:171], v[156:159], v[216:219]
    ds_read_b64_tr_b16 v[186:187], v13 offset:51200
    s_waitcnt lgkmcnt(0)
    v_mfma_f32_16x16x32_bf16 v[212:215], v[176:179], v[152:155], v[212:215]
    v_xor_b32 v8, 0x10000, v8
    v_xor_b32 v9, 0x10000, v9
    v_xor_b32 v10, 0x10000, v10
    v_xor_b32 v11, 0x10000, v11
    v_xor_b32 v12, 0x10000, v12
    v_xor_b32 v13, 0x10000, v13
    s_waitcnt vmcnt(9)
    s_barrier
    v_mfma_f32_16x16x32_bf16 v[220:223], v[176:179], v[156:159], v[220:223]
    ds_read_b128 v[144:147], v16 offset:32768
    ds_read_b128 v[148:151], v16 offset:34816
    v_mfma_f32_16x16x32_bf16 v[224:227], v[180:183], v[152:155], v[224:227]
    ds_read_b64_tr_b16 v[160:161], v8 offset:0
    ds_read_b64_tr_b16 v[162:163], v8 offset:2048
    v_mfma_f32_16x16x32_bf16 v[232:235], v[180:183], v[156:159], v[232:235]
    ds_read_b64_tr_b16 v[164:165], v9 offset:0
    ds_read_b64_tr_b16 v[166:167], v9 offset:2048
    v_mfma_f32_16x16x32_bf16 v[228:231], v[184:187], v[152:155], v[228:231]
    ds_read_b64_tr_b16 v[168:169], v10 offset:0
    ds_read_b64_tr_b16 v[170:171], v10 offset:2048
    v_mfma_f32_16x16x32_bf16 v[236:239], v[184:187], v[156:159], v[236:239]
    s_add_u32 s6, s3, 4
    s_sub_u32 s7, s6, 6
    s_cmp_ge_u32 s6, 7
    s_cselect_b32 s6, s7, s6
    s_mul_i32 s7, s6, s95
    s_lshl_b32 s7, s7, 2
    s_lshl_b32 s6, s6, 7
    s_add_u32 m0, s51, 114688
    s_nop 0
    buffer_load_dwordx4 v5, s[8:11], s6 offen lds
    s_add_u32 m0, s51, 122880
    s_add_u32 s52, s6, 57344
    buffer_load_dwordx4 v5, s[8:11], s52 offen lds
    s_waitcnt lgkmcnt(4)
    v_mfma_f32_16x16x32_bf16 v[192:195], v[160:163], v[144:147], v[192:195]
    ds_read_b64_tr_b16 v[176:177], v11 offset:0
    v_mfma_f32_16x16x32_bf16 v[200:203], v[160:163], v[148:151], v[200:203]
    ds_read_b64_tr_b16 v[178:179], v11 offset:2048
    s_waitcnt lgkmcnt(4)
    v_mfma_f32_16x16x32_bf16 v[196:199], v[164:167], v[144:147], v[196:199]
    ds_read_b64_tr_b16 v[180:181], v12 offset:0
    ds_read_b64_tr_b16 v[182:183], v12 offset:2048
    v_mfma_f32_16x16x32_bf16 v[204:207], v[164:167], v[148:151], v[204:207]
    ds_read_b64_tr_b16 v[184:185], v13 offset:0
    s_waitcnt lgkmcnt(5)
    v_mfma_f32_16x16x32_bf16 v[208:211], v[168:171], v[144:147], v[208:211]
    ds_read_b64_tr_b16 v[186:187], v13 offset:2048
    v_mfma_f32_16x16x32_bf16 v[216:219], v[168:171], v[148:151], v[216:219]
    s_add_u32 m0, s51, 32768
    s_nop 0
    buffer_load_dwordx4 v4, s[12:15], s7 offen lds
    s_add_u32 s7, s7, s95
    s_add_u32 m0, s51, 40960
    s_nop 0
    buffer_load_dwordx4 v4, s[12:15], s7 offen lds
    s_add_u32 s7, s7, s95
    s_waitcnt lgkmcnt(4)
    v_mfma_f32_16x16x32_bf16 v[212:215], v[176:179], v[144:147], v[212:215]
    ds_read_b128 v[152:155], v17 offset:32768
    v_mfma_f32_16x16x32_bf16 v[220:223], v[176:179], v[148:151], v[220:223]
    ds_read_b128 v[156:159], v17 offset:34816
    ds_read_b64_tr_b16 v[160:161], v8 offset:16384
    s_waitcnt lgkmcnt(5)
    v_mfma_f32_16x16x32_bf16 v[224:227], v[180:183], v[144:147], v[224:227]
    ds_read_b64_tr_b16 v[162:163], v8 offset:18432
    ds_read_b64_tr_b16 v[164:165], v9 offset:16384
    v_mfma_f32_16x16x32_bf16 v[232:235], v[180:183], v[148:151], v[232:235]
    ds_read_b64_tr_b16 v[166:167], v9 offset:18432
    s_waitcnt lgkmcnt(6)
    v_mfma_f32_16x16x32_bf16 v[228:231], v[184:187], v[144:147], v[228:231]
    ds_read_b64_tr_b16 v[168:169], v10 offset:16384
    ds_read_b64_tr_b16 v[170:171], v10 offset:18432
    v_mfma_f32_16x16x32_bf16 v[236:239], v[184:187], v[148:151], v[236:239]
    s_add_u32 m0, s51, 49152
    s_nop 0
    buffer_load_dwordx4 v4, s[12:15], s7 offen lds
    s_add_u32 s7, s7, s95
    s_add_u32 m0, s51, 57344
    s_nop 0
    buffer_load_dwordx4 v4, s[12:15], s7 offen lds
    s_waitcnt lgkmcnt(4)
    v_mfma_f32_16x16x32_bf16 v[192:195], v[160:163], v[152:155], v[192:195]
    ds_read_b64_tr_b16 v[176:177], v11 offset:16384
    v_mfma_f32_16x16x32_bf16 v[200:203], v[160:163], v[156:159], v[200:203]
    ds_read_b64_tr_b16 v[178:179], v11 offset:18432
    s_waitcnt lgkmcnt(4)
    v_mfma_f32_16x16x32_bf16 v[196:199], v[164:167], v[152:155], v[196:199]
    ds_read_b64_tr_b16 v[180:181], v12 offset:16384
    v_mfma_f32_16x16x32_bf16 v[204:207], v[164:167], v[156:159], v[204:207]
    ds_read_b64_tr_b16 v[182:183], v12 offset:18432
    s_waitcnt lgkmcnt(4)
    v_mfma_f32_16x16x32_bf16 v[208:211], v[168:171], v[152:155], v[208:211]
    ds_read_b64_tr_b16 v[184:185], v13 offset:16384
    v_mfma_f32_16x16x32_bf16 v[216:219], v[168:171], v[156:159], v[216:219]
    ds_read_b64_tr_b16 v[186:187], v13 offset:18432
    s_waitcnt lgkmcnt(0)
    v_mfma_f32_16x16x32_bf16 v[212:215], v[176:179], v[152:155], v[212:215]
    v_xor_b32 v8, 0x10000, v8
    v_xor_b32 v9, 0x10000, v9
    v_xor_b32 v10, 0x10000, v10
    v_xor_b32 v11, 0x10000, v11
    v_xor_b32 v12, 0x10000, v12
    v_xor_b32 v13, 0x10000, v13
    s_waitcnt vmcnt(9)
    s_barrier
    v_mfma_f32_16x16x32_bf16 v[220:223], v[176:179], v[156:159], v[220:223]
    ds_read_b128 v[144:147], v16 offset:0
    ds_read_b128 v[148:151], v16 offset:2048
    v_mfma_f32_16x16x32_bf16 v[224:227], v[180:183], v[152:155], v[224:227]
    ds_read_b64_tr_b16 v[160:161], v8 offset:0
    ds_read_b64_tr_b16 v[162:163], v8 offset:2048
    v_mfma_f32_16x16x32_bf16 v[232:235], v[180:183], v[156:159], v[232:235]
    ds_read_b64_tr_b16 v[164:165], v9 offset:0
    ds_read_b64_tr_b16 v[166:167], v9 offset:2048
    v_mfma_f32_16x16x32_bf16 v[228:231], v[184:187], v[152:155], v[228:231]
    ds_read_b64_tr_b16 v[168:169], v10 offset:0
    ds_read_b64_tr_b16 v[170:171], v10 offset:2048
    v_mfma_f32_16x16x32_bf16 v[236:239], v[184:187], v[156:159], v[236:239]
    s_add_u32 m0, s63, 49152
    s_add_u32 s52, s60, 0
    buffer_load_dwordx4 v6, s[20:23], s52 offen lds
    s_add_u32 m0, s63, 50176
    s_add_u32 s52, s60, 7168
    buffer_load_dwordx4 v6, s[20:23], s52 offen lds
    s_waitcnt lgkmcnt(4)
    v_mfma_f32_16x16x32_bf16 v[192:195], v[160:163], v[144:147], v[192:195]
    ds_read_b64_tr_b16 v[176:177], v11 offset:0
    v_mfma_f32_16x16x32_bf16 v[200:203], v[160:163], v[148:151], v[200:203]
    ds_read_b64_tr_b16 v[178:179], v11 offset:2048
    s_waitcnt lgkmcnt(4)
    v_mfma_f32_16x16x32_bf16 v[196:199], v[164:167], v[144:147], v[196:199]
    ds_read_b64_tr_b16 v[180:181], v12 offset:0
    ds_read_b64_tr_b16 v[182:183], v12 offset:2048
    v_mfma_f32_16x16x32_bf16 v[204:207], v[164:167], v[148:151], v[204:207]
    ds_read_b64_tr_b16 v[184:185], v13 offset:0
    s_waitcnt lgkmcnt(5)
    v_mfma_f32_16x16x32_bf16 v[208:211], v[168:171], v[144:147], v[208:211]
    ds_read_b64_tr_b16 v[186:187], v13 offset:2048
    v_mfma_f32_16x16x32_bf16 v[216:219], v[168:171], v[148:151], v[216:219]
    s_add_u32 s6, s3, 5
    s_sub_u32 s7, s6, 6
    s_cmp_ge_u32 s6, 7
    s_cselect_b32 s6, s7, s6
    s_mul_i32 s7, s6, s95
    s_lshl_b32 s7, s7, 2
    s_lshl_b32 s6, s6, 7
    s_add_u32 m0, s51, 131072
    s_nop 0
    buffer_load_dwordx4 v5, s[8:11], s6 offen lds
    s_add_u32 m0, s51, 139264
    s_add_u32 s52, s6, 57344
    buffer_load_dwordx4 v5, s[8:11], s52 offen lds
    s_waitcnt lgkmcnt(4)
    v_mfma_f32_16x16x32_bf16 v[212:215], v[176:179], v[144:147], v[212:215]
    ds_read_b128 v[152:155], v17 offset:0
    v_mfma_f32_16x16x32_bf16 v[220:223], v[176:179], v[148:151], v[220:223]
    ds_read_b128 v[156:159], v17 offset:2048
    ds_read_b64_tr_b16 v[160:161], v8 offset:16384
    s_waitcnt lgkmcnt(5)
    v_mfma_f32_16x16x32_bf16 v[224:227], v[180:183], v[144:147], v[224:227]
    ds_read_b64_tr_b16 v[162:163], v8 offset:18432
    ds_read_b64_tr_b16 v[164:165], v9 offset:16384
    v_mfma_f32_16x16x32_bf16 v[232:235], v[180:183], v[148:151], v[232:235]
    ds_read_b64_tr_b16 v[166:167], v9 offset:18432
    s_waitcnt lgkmcnt(6)
    v_mfma_f32_16x16x32_bf16 v[228:231], v[184:187], v[144:147], v[228:231]
    ds_read_b64_tr_b16 v[168:169], v10 offset:16384
    ds_read_b64_tr_b16 v[170:171], v10 offset:18432
    v_mfma_f32_16x16x32_bf16 v[236:239], v[184:187], v[148:151], v[236:239]
    s_add_u32 m0, s51, 65536
    s_nop 0
    buffer_load_dwordx4 v4, s[12:15], s7 offen lds
    s_add_u32 s7, s7, s95
    s_add_u32 m0, s51, 73728
    s_nop 0
    buffer_load_dwordx4 v4, s[12:15], s7 offen lds
    s_add_u32 s7, s7, s95
    s_waitcnt lgkmcnt(4)
    v_mfma_f32_16x16x32_bf16 v[192:195], v[160:163], v[152:155], v[192:195]
    ds_read_b64_tr_b16 v[176:177], v11 offset:16384
    v_mfma_f32_16x16x32_bf16 v[200:203], v[160:163], v[156:159], v[200:203]
    ds_read_b64_tr_b16 v[178:179], v11 offset:18432
    s_waitcnt lgkmcnt(4)
    v_mfma_f32_16x16x32_bf16 v[196:199], v[164:167], v[152:155], v[196:199]
    ds_read_b64_tr_b16 v[180:181], v12 offset:16384
    ds_read_b64_tr_b16 v[182:183], v12 offset:18432
    v_mfma_f32_16x16x32_bf16 v[204:207], v[164:167], v[156:159], v[204:207]
    ds_read_b64_tr_b16 v[184:185], v13 offset:16384
    s_waitcnt lgkmcnt(5)
    v_mfma_f32_16x16x32_bf16 v[208:211], v[168:171], v[152:155], v[208:211]
    ds_read_b64_tr_b16 v[186:187], v13 offset:18432
    v_mfma_f32_16x16x32_bf16 v[216:219], v[168:171], v[156:159], v[216:219]
    s_add_u32 m0, s51, 81920
    s_nop 0
    buffer_load_dwordx4 v4, s[12:15], s7 offen lds
    s_add_u32 s7, s7, s95
    s_add_u32 m0, s51, 90112
    s_nop 0
    buffer_load_dwordx4 v4, s[12:15], s7 offen lds
    s_waitcnt vmcnt(6)
    ds_read_b64_tr_b16 v[24:25], v140 offset:49152
    ds_read_b64_tr_b16 v[26:27], v140 offset:50176
    ds_read_b64_tr_b16 v[28:29], v141 offset:49152
    ds_read_b64_tr_b16 v[30:31], v141 offset:50176
    s_waitcnt lgkmcnt(0)
    v_mfma_f32_16x16x32_bf16 v[212:215], v[176:179], v[152:155], v[212:215]
    s_barrier
    v_mfma_f32_16x16x32_bf16 v[220:223], v[176:179], v[156:159], v[220:223]
    ds_read_b128 v[144:147], v16 offset:16384
    ds_read_b128 v[148:151], v16 offset:18432
    v_mfma_f32_16x16x32_bf16 v[224:227], v[180:183], v[152:155], v[224:227]
    ds_read_b64_tr_b16 v[160:161], v8 offset:32768
    ds_read_b64_tr_b16 v[162:163], v8 offset:34816
    v_mfma_f32_16x16x32_bf16 v[232:235], v[180:183], v[156:159], v[232:235]
    ds_read_b64_tr_b16 v[164:165], v9 offset:32768
    ds_read_b64_tr_b16 v[166:167], v9 offset:34816
    v_mfma_f32_16x16x32_bf16 v[228:231], v[184:187], v[152:155], v[228:231]
    ds_read_b64_tr_b16 v[168:169], v10 offset:32768
    ds_read_b64_tr_b16 v[170:171], v10 offset:34816
    v_mfma_f32_16x16x32_bf16 v[236:239], v[184:187], v[156:159], v[236:239]
    s_add_u32 m0, s63, 49152
    s_add_u32 s52, s60, 14336
    buffer_load_dwordx4 v6, s[20:23], s52 offen lds
    s_add_u32 m0, s63, 50176
    s_add_u32 s52, s60, 21504
    buffer_load_dwordx4 v6, s[20:23], s52 offen lds
    s_waitcnt lgkmcnt(4)
    v_mfma_f32_16x16x32_bf16 v[192:195], v[160:163], v[144:147], v[192:195]
    ds_read_b64_tr_b16 v[176:177], v11 offset:32768
    v_mfma_f32_16x16x32_bf16 v[200:203], v[160:163], v[148:151], v[200:203]
    ds_read_b64_tr_b16 v[178:179], v11 offset:34816
    s_waitcnt lgkmcnt(4)
    v_mfma_f32_16x16x32_bf16 v[196:199], v[164:167], v[144:147], v[196:199]
    ds_read_b64_tr_b16 v[180:181], v12 offset:32768
    ds_read_b64_tr_b16 v[182:183], v12 offset:34816
    v_mfma_f32_16x16x32_bf16 v[204:207], v[164:167], v[148:151], v[204:207]
    ds_read_b64_tr_b16 v[184:185], v13 offset:32768
    s_waitcnt lgkmcnt(5)
    v_mfma_f32_16x16x32_bf16 v[208:211], v[168:171], v[144:147], v[208:211]
    ds_read_b64_tr_b16 v[186:187], v13 offset:34816
    v_mfma_f32_16x16x32_bf16 v[216:219], v[168:171], v[148:151], v[216:219]
    s_add_u32 s6, s3, 6
    s_sub_u32 s7, s6, 6
    s_cmp_ge_u32 s6, 7
    s_cselect_b32 s6, s7, s6
    s_mul_i32 s7, s6, s95
    s_lshl_b32 s7, s7, 2
    s_lshl_b32 s6, s6, 7
    s_add_u32 m0, s51, 98304
    s_nop 0
    buffer_load_dwordx4 v5, s[8:11], s6 offen lds
    s_add_u32 m0, s51, 106496
    s_add_u32 s52, s6, 57344
    buffer_load_dwordx4 v5, s[8:11], s52 offen lds
    s_waitcnt lgkmcnt(4)
    v_mfma_f32_16x16x32_bf16 v[212:215], v[176:179], v[144:147], v[212:215]
    ds_read_b128 v[152:155], v17 offset:16384
    v_mfma_f32_16x16x32_bf16 v[220:223], v[176:179], v[148:151], v[220:223]
    ds_read_b128 v[156:159], v17 offset:18432
    ds_read_b64_tr_b16 v[160:161], v8 offset:49152
    s_waitcnt lgkmcnt(5)
    v_mfma_f32_16x16x32_bf16 v[224:227], v[180:183], v[144:147], v[224:227]
    ds_read_b64_tr_b16 v[162:163], v8 offset:51200
    ds_read_b64_tr_b16 v[164:165], v9 offset:49152
    v_mfma_f32_16x16x32_bf16 v[232:235], v[180:183], v[148:151], v[232:235]
    ds_read_b64_tr_b16 v[166:167], v9 offset:51200
    s_waitcnt lgkmcnt(6)
    v_mfma_f32_16x16x32_bf16 v[228:231], v[184:187], v[144:147], v[228:231]
    ds_read_b64_tr_b16 v[168:169], v10 offset:49152
    ds_read_b64_tr_b16 v[170:171], v10 offset:51200
    v_mfma_f32_16x16x32_bf16 v[236:239], v[184:187], v[148:151], v[236:239]
    s_add_u32 m0, s51, 0
    s_nop 0
    buffer_load_dwordx4 v4, s[12:15], s7 offen lds
    s_add_u32 s7, s7, s95
    s_add_u32 m0, s51, 8192
    s_nop 0
    buffer_load_dwordx4 v4, s[12:15], s7 offen lds
    s_add_u32 s7, s7, s95
    s_waitcnt lgkmcnt(4)
    v_mfma_f32_16x16x32_bf16 v[192:195], v[160:163], v[152:155], v[192:195]
    ds_read_b64_tr_b16 v[176:177], v11 offset:49152
    v_mfma_f32_16x16x32_bf16 v[200:203], v[160:163], v[156:159], v[200:203]
    ds_read_b64_tr_b16 v[178:179], v11 offset:51200
    s_waitcnt lgkmcnt(4)
    v_mfma_f32_16x16x32_bf16 v[196:199], v[164:167], v[152:155], v[196:199]
    ds_read_b64_tr_b16 v[180:181], v12 offset:49152
    ds_read_b64_tr_b16 v[182:183], v12 offset:51200
    v_mfma_f32_16x16x32_bf16 v[204:207], v[164:167], v[156:159], v[204:207]
    ds_read_b64_tr_b16 v[184:185], v13 offset:49152
    s_waitcnt lgkmcnt(5)
    v_mfma_f32_16x16x32_bf16 v[208:211], v[168:171], v[152:155], v[208:211]
    ds_read_b64_tr_b16 v[186:187], v13 offset:51200
    v_mfma_f32_16x16x32_bf16 v[216:219], v[168:171], v[156:159], v[216:219]
    s_add_u32 m0, s51, 16384
    s_nop 0
    buffer_load_dwordx4 v4, s[12:15], s7 offen lds
    s_add_u32 s7, s7, s95
    s_add_u32 m0, s51, 24576
    s_nop 0
    buffer_load_dwordx4 v4, s[12:15], s7 offen lds
    s_waitcnt vmcnt(6)
    ds_read_b64_tr_b16 v[32:33], v140 offset:49152
    ds_read_b64_tr_b16 v[34:35], v140 offset:50176
    ds_read_b64_tr_b16 v[36:37], v141 offset:49152
    ds_read_b64_tr_b16 v[38:39], v141 offset:50176
    s_waitcnt lgkmcnt(0)
    v_mfma_f32_16x16x32_bf16 v[212:215], v[176:179], v[152:155], v[212:215]
    v_xor_b32 v8, 0x10000, v8
    v_xor_b32 v9, 0x10000, v9
    v_xor_b32 v10, 0x10000, v10
    v_xor_b32 v11, 0x10000, v11
    v_xor_b32 v12, 0x10000, v12
    v_xor_b32 v13, 0x10000, v13
    s_barrier
    v_mfma_f32_16x16x32_bf16 v[220:223], v[176:179], v[156:159], v[220:223]
    ds_read_b128 v[144:147], v16 offset:32768
    ds_read_b128 v[148:151], v16 offset:34816
    v_mfma_f32_16x16x32_bf16 v[224:227], v[180:183], v[152:155], v[224:227]
    ds_read_b64_tr_b16 v[160:161], v8 offset:0
    ds_read_b64_tr_b16 v[162:163], v8 offset:2048
    v_mfma_f32_16x16x32_bf16 v[232:235], v[180:183], v[156:159], v[232:235]
    ds_read_b64_tr_b16 v[164:165], v9 offset:0
    ds_read_b64_tr_b16 v[166:167], v9 offset:2048
    v_mfma_f32_16x16x32_bf16 v[228:231], v[184:187], v[152:155], v[228:231]
    ds_read_b64_tr_b16 v[168:169], v10 offset:0
    ds_read_b64_tr_b16 v[170:171], v10 offset:2048
    v_mfma_f32_16x16x32_bf16 v[236:239], v[184:187], v[156:159], v[236:239]
    s_add_u32 m0, s63, 49152
    s_add_u32 s52, s60, 28672
    buffer_load_dwordx4 v6, s[20:23], s52 offen lds
    s_add_u32 m0, s63, 50176
    s_add_u32 s52, s60, 35840
    buffer_load_dwordx4 v6, s[20:23], s52 offen lds
    s_waitcnt lgkmcnt(4)
    v_mfma_f32_16x16x32_bf16 v[192:195], v[160:163], v[144:147], v[192:195]
    ds_read_b64_tr_b16 v[176:177], v11 offset:0
    v_mfma_f32_16x16x32_bf16 v[200:203], v[160:163], v[148:151], v[200:203]
    ds_read_b64_tr_b16 v[178:179], v11 offset:2048
    s_waitcnt lgkmcnt(4)
    v_mfma_f32_16x16x32_bf16 v[196:199], v[164:167], v[144:147], v[196:199]
    ds_read_b64_tr_b16 v[180:181], v12 offset:0
    ds_read_b64_tr_b16 v[182:183], v12 offset:2048
    v_mfma_f32_16x16x32_bf16 v[204:207], v[164:167], v[148:151], v[204:207]
    ds_read_b64_tr_b16 v[184:185], v13 offset:0
    s_waitcnt lgkmcnt(5)
    v_mfma_f32_16x16x32_bf16 v[208:211], v[168:171], v[144:147], v[208:211]
    ds_read_b64_tr_b16 v[186:187], v13 offset:2048
    v_mfma_f32_16x16x32_bf16 v[216:219], v[168:171], v[148:151], v[216:219]
    s_add_u32 m0, s62, 32768
    s_add_u32 s52, s60, 43008
    buffer_load_dwordx4 v6, s[20:23], s52 offen lds
    s_add_u32 m0, s62, 33792
    s_add_u32 s52, s60, 50176
    buffer_load_dwordx4 v6, s[20:23], s52 offen lds
    s_waitcnt lgkmcnt(4)
    v_mfma_f32_16x16x32_bf16 v[212:215], v[176:179], v[144:147], v[212:215]
    ds_read_b128 v[152:155], v17 offset:32768
    v_mfma_f32_16x16x32_bf16 v[220:223], v[176:179], v[148:151], v[220:223]
    ds_read_b128 v[156:159], v17 offset:34816
    ds_read_b64_tr_b16 v[160:161], v8 offset:16384
    s_waitcnt lgkmcnt(5)
    v_mfma_f32_16x16x32_bf16 v[224:227], v[180:183], v[144:147], v[224:227]
    ds_read_b64_tr_b16 v[162:163], v8 offset:18432
    ds_read_b64_tr_b16 v[164:165], v9 offset:16384
    v_mfma_f32_16x16x32_bf16 v[232:235], v[180:183], v[148:151], v[232:235]
    ds_read_b64_tr_b16 v[166:167], v9 offset:18432
    s_waitcnt lgkmcnt(6)
    v_mfma_f32_16x16x32_bf16 v[228:231], v[184:187], v[144:147], v[228:231]
    ds_read_b64_tr_b16 v[168:169], v10 offset:16384
    ds_read_b64_tr_b16 v[170:171], v10 offset:18432
    v_mfma_f32_16x16x32_bf16 v[236:239], v[184:187], v[148:151], v[236:239]
    s_add_u32 m0, s62, 34816
    s_add_u32 s52, s60, 57344
    buffer_load_dwordx4 v6, s[20:23], s52 offen lds
    s_add_u32 m0, s62, 35840
    s_add_u32 s52, s60, 64512
    buffer_load_dwordx4 v6, s[20:23], s52 offen lds
    s_waitcnt lgkmcnt(4)
    v_mfma_f32_16x16x32_bf16 v[192:195], v[160:163], v[152:155], v[192:195]
    ds_read_b64_tr_b16 v[176:177], v11 offset:16384
    v_mfma_f32_16x16x32_bf16 v[200:203], v[160:163], v[156:159], v[200:203]
    ds_read_b64_tr_b16 v[178:179], v11 offset:18432
    s_waitcnt lgkmcnt(4)
    v_mfma_f32_16x16x32_bf16 v[196:199], v[164:167], v[152:155], v[196:199]
    ds_read_b64_tr_b16 v[180:181], v12 offset:16384
    ds_read_b64_tr_b16 v[182:183], v12 offset:18432
    v_mfma_f32_16x16x32_bf16 v[204:207], v[164:167], v[156:159], v[204:207]
    ds_read_b64_tr_b16 v[184:185], v13 offset:16384
    s_waitcnt lgkmcnt(5)
    v_mfma_f32_16x16x32_bf16 v[208:211], v[168:171], v[152:155], v[208:211]
    ds_read_b64_tr_b16 v[186:187], v13 offset:18432
    v_mfma_f32_16x16x32_bf16 v[216:219], v[168:171], v[156:159], v[216:219]
    s_add_u32 m0, s63, 16384
    s_add_u32 s52, s60, 71680
    buffer_load_dwordx4 v6, s[20:23], s52 offen lds
    s_add_u32 m0, s63, 17408
    s_add_u32 s52, s60, 78848
    buffer_load_dwordx4 v6, s[20:23], s52 offen lds
    s_waitcnt vmcnt(6)
    ds_read_b64_tr_b16 v[40:41], v140 offset:49152
    ds_read_b64_tr_b16 v[42:43], v140 offset:50176
    ds_read_b64_tr_b16 v[44:45], v141 offset:49152
    ds_read_b64_tr_b16 v[46:47], v141 offset:50176
    s_waitcnt lgkmcnt(0)
    v_mfma_f32_16x16x32_bf16 v[212:215], v[176:179], v[152:155], v[212:215]
    v_xor_b32 v8, 0x10000, v8
    v_xor_b32 v9, 0x10000, v9
    v_xor_b32 v10, 0x10000, v10
    v_xor_b32 v11, 0x10000, v11
    v_xor_b32 v12, 0x10000, v12
    v_xor_b32 v13, 0x10000, v13
    s_barrier
    v_mfma_f32_16x16x32_bf16 v[220:223], v[176:179], v[156:159], v[220:223]
    ds_read_b128 v[144:147], v16 offset:0
    ds_read_b128 v[148:151], v16 offset:2048
    v_mfma_f32_16x16x32_bf16 v[224:227], v[180:183], v[152:155], v[224:227]
    ds_read_b64_tr_b16 v[160:161], v8 offset:0
    ds_read_b64_tr_b16 v[162:163], v8 offset:2048
    v_mfma_f32_16x16x32_bf16 v[232:235], v[180:183], v[156:159], v[232:235]
    ds_read_b64_tr_b16 v[164:165], v9 offset:0
    ds_read_b64_tr_b16 v[166:167], v9 offset:2048
    v_mfma_f32_16x16x32_bf16 v[228:231], v[184:187], v[152:155], v[228:231]
    ds_read_b64_tr_b16 v[168:169], v10 offset:0
    ds_read_b64_tr_b16 v[170:171], v10 offset:2048
    v_mfma_f32_16x16x32_bf16 v[236:239], v[184:187], v[156:159], v[236:239]
    s_add_u32 m0, s63, 49152
    s_add_u32 s52, s61, 12544
    buffer_load_dwordx4 v6, s[24:27], s52 offen lds
    s_add_u32 m0, s63, 50176
    s_add_u32 s52, s61, 19712
    buffer_load_dwordx4 v6, s[24:27], s52 offen lds
    s_waitcnt lgkmcnt(4)
    v_mfma_f32_16x16x32_bf16 v[192:195], v[160:163], v[144:147], v[192:195]
    ds_read_b64_tr_b16 v[176:177], v11 offset:0
    v_mfma_f32_16x16x32_bf16 v[200:203], v[160:163], v[148:151], v[200:203]
    ds_read_b64_tr_b16 v[178:179], v11 offset:2048
    s_waitcnt lgkmcnt(4)
    v_mfma_f32_16x16x32_bf16 v[196:199], v[164:167], v[144:147], v[196:199]
    ds_read_b64_tr_b16 v[180:181], v12 offset:0
    ds_read_b64_tr_b16 v[182:183], v12 offset:2048
    v_mfma_f32_16x16x32_bf16 v[204:207], v[164:167], v[148:151], v[204:207]
    ds_read_b64_tr_b16 v[184:185], v13 offset:0
    s_waitcnt lgkmcnt(5)
    v_mfma_f32_16x16x32_bf16 v[208:211], v[168:171], v[144:147], v[208:211]
    ds_read_b64_tr_b16 v[186:187], v13 offset:2048
    v_mfma_f32_16x16x32_bf16 v[216:219], v[168:171], v[148:151], v[216:219]
    s_add_u32 m0, s62, 65536
    s_add_u32 s52, s60, 86016
    buffer_load_dwordx4 v6, s[20:23], s52 offen lds
    s_add_u32 m0, s62, 66560
    s_add_u32 s52, s60, 93184
    buffer_load_dwordx4 v6, s[20:23], s52 offen lds
    s_waitcnt lgkmcnt(4)
    v_mfma_f32_16x16x32_bf16 v[212:215], v[176:179], v[144:147], v[212:215]
    ds_read_b128 v[152:155], v17 offset:0
    ds_read_b128 v[156:159], v17 offset:2048
    v_mfma_f32_16x16x32_bf16 v[220:223], v[176:179], v[148:151], v[220:223]
    ds_read_b64_tr_b16 v[160:161], v8 offset:16384
    ds_read_b64_tr_b16 v[162:163], v8 offset:18432
    ds_read_b64_tr_b16 v[164:165], v9 offset:16384
    s_waitcnt lgkmcnt(7)
    v_mfma_f32_16x16x32_bf16 v[224:227], v[180:183], v[144:147], v[224:227]
    ds_read_b64_tr_b16 v[166:167], v9 offset:18432
    ds_read_b64_tr_b16 v[168:169], v10 offset:16384
    ds_read_b64_tr_b16 v[170:171], v10 offset:18432
    v_mfma_f32_16x16x32_bf16 v[232:235], v[180:183], v[148:151], v[232:235]
    s_add_u32 m0, s62, 67584
    s_add_u32 s52, s60, 100352
    buffer_load_dwordx4 v6, s[20:23], s52 offen lds
    s_add_u32 m0, s62, 68608
    s_add_u32 s52, s60, 107520
    buffer_load_dwordx4 v6, s[20:23], s52 offen lds
    s_waitcnt vmcnt(10)
    s_waitcnt vmcnt(8)
    s_waitcnt vmcnt(6)
    s_waitcnt lgkmcnt(8)
    v_mfma_f32_16x16x32_bf16 v[228:231], v[184:187], v[144:147], v[228:231]
    ds_read_b64_tr_b16 v[48:49], v136 offset:32768
    ds_read_b64_tr_b16 v[50:51], v136 offset:33792
    ds_read_b64_tr_b16 v[52:53], v137 offset:32768
    v_mfma_f32_16x16x32_bf16 v[236:239], v[184:187], v[148:151], v[236:239]
    ds_read_b64_tr_b16 v[54:55], v137 offset:33792
    ds_read_b64_tr_b16 v[56:57], v136 offset:34816
    ds_read_b64_tr_b16 v[58:59], v136 offset:35840
    s_waitcnt lgkmcnt(10)
    v_mfma_f32_16x16x32_bf16 v[192:195], v[160:163], v[152:155], v[192:195]
    ds_read_b64_tr_b16 v[176:177], v11 offset:16384
    ds_read_b64_tr_b16 v[178:179], v11 offset:18432
    v_mfma_f32_16x16x32_bf16 v[200:203], v[160:163], v[156:159], v[200:203]
    ds_read_b64_tr_b16 v[180:181], v12 offset:16384
    ds_read_b64_tr_b16 v[182:183], v12 offset:18432
    s_waitcnt lgkmcnt(12)
    v_mfma_f32_16x16x32_bf16 v[196:199], v[164:167], v[152:155], v[196:199]
    ds_read_b64_tr_b16 v[184:185], v13 offset:16384
    ds_read_b64_tr_b16 v[186:187], v13 offset:18432
    s_add_u32 m0, s63, 32768
    s_add_u32 s52, s60, 114688
    buffer_load_dwordx4 v6, s[20:23], s52 offen lds
    v_mfma_f32_16x16x32_bf16 v[204:207], v[164:167], v[156:159], v[204:207]
    s_add_u32 m0, s63, 33792
    s_add_u32 s52, s60, 121856
    buffer_load_dwordx4 v6, s[20:23], s52 offen lds
    ds_read_b64_tr_b16 v[60:61], v137 offset:34816
    s_waitcnt lgkmcnt(13)
    v_mfma_f32_16x16x32_bf16 v[208:211], v[168:171], v[152:155], v[208:211]
    ds_read_b64_tr_b16 v[62:63], v137 offset:35840
    ds_read_b64_tr_b16 v[64:65], v140 offset:16384
    v_mfma_f32_16x16x32_bf16 v[216:219], v[168:171], v[156:159], v[216:219]
    ds_read_b64_tr_b16 v[66:67], v140 offset:17408
    ds_read_b64_tr_b16 v[68:69], v141 offset:16384
    ds_read_b64_tr_b16 v[70:71], v141 offset:17408
    s_waitcnt lgkmcnt(0)
    v_mfma_f32_16x16x32_bf16 v[212:215], v[176:179], v[152:155], v[212:215]
    s_barrier
    v_mfma_f32_16x16x32_bf16 v[220:223], v[176:179], v[156:159], v[220:223]
    v_mfma_f32_16x16x32_bf16 v[224:227], v[180:183], v[152:155], v[224:227]
    v_mfma_f32_16x16x32_bf16 v[232:235], v[180:183], v[156:159], v[232:235]
    v_mfma_f32_16x16x32_bf16 v[228:231], v[184:187], v[152:155], v[228:231]
    v_mfma_f32_16x16x32_bf16 v[236:239], v[184:187], v[156:159], v[236:239]
    s_add_u32 m0, s62, 0
    s_add_u32 s52, s60, 129024
    buffer_load_dwordx4 v6, s[20:23], s52 offen lds
    s_add_u32 m0, s62, 1024
    s_add_u32 s52, s60, 136192
    buffer_load_dwordx4 v6, s[20:23], s52 offen lds
    s_add_u32 m0, s62, 4294950912
    s_add_u32 s52, s60, 4294293504
    buffer_load_dwordx4 v6, s[20:23], s52 offen lds
    s_add_u32 m0, s62, 4294951936
    s_add_u32 s52, s60, 4294300672
    buffer_load_dwordx4 v6, s[20:23], s52 offen lds
    s_add_u32 m0, s62, 2048
    s_add_u32 s52, s60, 143360
    buffer_load_dwordx4 v6, s[20:23], s52 offen lds
    s_add_u32 m0, s62, 3072
    s_add_u32 s52, s60, 150528
    buffer_load_dwordx4 v6, s[20:23], s52 offen lds
    s_add_u32 m0, s62, 4294952960
    s_add_u32 s52, s60, 4294307840
    buffer_load_dwordx4 v6, s[20:23], s52 offen lds
    s_add_u32 m0, s62, 4294953984
    s_add_u32 s52, s60, 4294315008
    buffer_load_dwordx4 v6, s[20:23], s52 offen lds
    s_add_u32 m0, s63, 0
    s_add_u32 s52, s60, 157696
    buffer_load_dwordx4 v6, s[20:23], s52 offen lds
    s_add_u32 m0, s63, 1024
    s_add_u32 s52, s60, 164864
    buffer_load_dwordx4 v6, s[20:23], s52 offen lds
    s_add_u32 m0, s63, 4294959104
    s_add_u32 s52, s60, 4294322176
    buffer_load_dwordx4 v6, s[20:23], s52 offen lds
    s_add_u32 m0, s63, 4294960128
    s_add_u32 s52, s60, 4294329344
    buffer_load_dwordx4 v6, s[20:23], s52 offen lds
    s_add_u32 m0, s62, 32768
    s_add_u32 s52, s60, 172032
    buffer_load_dwordx4 v6, s[20:23], s52 offen lds
    s_add_u32 m0, s62, 33792
    s_add_u32 s52, s60, 179200
    buffer_load_dwordx4 v6, s[20:23], s52 offen lds
    s_add_u32 m0, s62, 34816
    s_add_u32 s52, s60, 186368
    buffer_load_dwordx4 v6, s[20:23], s52 offen lds
    s_add_u32 m0, s62, 35840
    s_add_u32 s52, s60, 193536
    buffer_load_dwordx4 v6, s[20:23], s52 offen lds
    s_add_u32 m0, s63, 16384
    s_add_u32 s52, s61, 0
    buffer_load_dwordx4 v6, s[24:27], s52 offen lds
    s_add_u32 m0, s63, 17408
    s_add_u32 s52, s61, 7168
    buffer_load_dwordx4 v6, s[24:27], s52 offen lds
    s_waitcnt vmcnt(22)
    s_waitcnt vmcnt(20)
    s_waitcnt vmcnt(18)
    ds_read_b64_tr_b16 v[72:73], v138 offset:0
    ds_read_b64_tr_b16 v[74:75], v138 offset:1024
    ds_read_b64_tr_b16 v[76:77], v139 offset:0
    ds_read_b64_tr_b16 v[78:79], v139 offset:1024
    ds_read_b64_tr_b16 v[80:81], v138 offset:2048
    ds_read_b64_tr_b16 v[82:83], v138 offset:3072
    ds_read_b64_tr_b16 v[84:85], v139 offset:2048
    ds_read_b64_tr_b16 v[86:87], v139 offset:3072
    ds_read_b64_tr_b16 v[88:89], v140 offset:32768
    ds_read_b64_tr_b16 v[90:91], v140 offset:33792
    ds_read_b64_tr_b16 v[92:93], v141 offset:32768
    ds_read_b64_tr_b16 v[94:95], v141 offset:33792
    v_pk_mul_f32 v[192:193], v[192:193], s[40:41]
    v_pk_mul_f32 v[194:195], v[194:195], s[40:41]
    v_pk_mul_f32 v[196:197], v[196:197], s[40:41]
    v_pk_mul_f32 v[198:199], v[198:199], s[40:41]
    v_exp_f32 v168, v192
    v_exp_f32 v169, v193
    v_exp_f32 v170, v194
    v_exp_f32 v171, v195
    v_exp_f32 v172, v196
    v_exp_f32 v173, v197
    v_exp_f32 v174, v198
    v_exp_f32 v175, v199
    v_pk_fma_f32 v[176:177], v[168:169], v[20:21], v[22:23]
    v_pk_fma_f32 v[178:179], v[170:171], v[20:21], v[22:23]
    v_pk_fma_f32 v[180:181], v[172:173], v[20:21], v[22:23]
    v_pk_fma_f32 v[182:183], v[174:175], v[20:21], v[22:23]
    v_pk_fma_f32 v[176:177], v[176:177], v[168:169], v[22:23]
    v_pk_fma_f32 v[178:179], v[178:179], v[170:171], v[22:23]
    v_pk_fma_f32 v[180:181], v[180:181], v[172:173], v[22:23]
    v_pk_fma_f32 v[182:183], v[182:183], v[174:175], v[22:23]
    v_rcp_f32 v176, v176
    v_rcp_f32 v177, v177
    v_rcp_f32 v178, v178
    v_rcp_f32 v179, v179
    v_rcp_f32 v180, v180
    v_rcp_f32 v181, v181
    v_rcp_f32 v182, v182
    v_rcp_f32 v183, v183
    v_pk_fma_f32 v[176:177], v[192:193], v[176:177], v[192:193] neg_lo:[1,0,0] neg_hi:[1,0,0]
    v_pk_fma_f32 v[178:179], v[194:195], v[178:179], v[194:195] neg_lo:[1,0,0] neg_hi:[1,0,0]
    s_waitcnt vmcnt(14)
    s_waitcnt vmcnt(10)
    s_waitcnt vmcnt(6)
    s_barrier
    s_setprio 2
    v_pk_fma_f32 v[180:181], v[196:197], v[180:181], v[196:197] neg_lo:[1,0,0] neg_hi:[1,0,0]
    v_pk_fma_f32 v[182:183], v[198:199], v[182:183], v[198:199] neg_lo:[1,0,0] neg_hi:[1,0,0]
    v_cvt_pk_bf16_f32 v192, v176, v177
    v_cvt_pk_bf16_f32 v193, v178, v179
    v_cvt_pk_bf16_f32 v194, v180, v181
    v_cvt_pk_bf16_f32 v195, v182, v183
    v_pk_mul_f32 v[200:201], v[200:201], s[40:41]
    v_pk_mul_f32 v[202:203], v[202:203], s[40:41]
    v_pk_mul_f32 v[204:205], v[204:205], s[40:41]
    v_pk_mul_f32 v[206:207], v[206:207], s[40:41]
    v_exp_f32 v168, v200
    v_exp_f32 v169, v201
    v_exp_f32 v170, v202
    v_exp_f32 v171, v203
    v_exp_f32 v172, v204
    v_exp_f32 v173, v205
    v_exp_f32 v174, v206
    v_exp_f32_e64 v175, v207
    v_pk_fma_f32 v[176:177], v[168:169], v[20:21], v[22:23]
    v_pk_fma_f32 v[178:179], v[170:171], v[20:21], v[22:23]
    v_pk_fma_f32 v[180:181], v[172:173], v[20:21], v[22:23]
    v_pk_fma_f32 v[182:183], v[174:175], v[20:21], v[22:23]
    v_pk_fma_f32 v[176:177], v[176:177], v[168:169], v[22:23]
    v_pk_fma_f32 v[178:179], v[178:179], v[170:171], v[22:23]
    v_pk_fma_f32 v[180:181], v[180:181], v[172:173], v[22:23]
    v_pk_fma_f32 v[182:183], v[182:183], v[174:175], v[22:23]
    v_rcp_f32 v176, v176
    v_rcp_f32 v177, v177
    v_rcp_f32 v178, v178
    v_rcp_f32 v179, v179
    v_rcp_f32 v180, v180
    v_rcp_f32 v181, v181
    v_rcp_f32 v182, v182
    v_rcp_f32 v183, v183
    v_pk_fma_f32 v[176:177], v[200:201], v[176:177], v[200:201] neg_lo:[1,0,0] neg_hi:[1,0,0]
    v_pk_fma_f32 v[178:179], v[202:203], v[178:179], v[202:203] neg_lo:[1,0,0] neg_hi:[1,0,0]
    v_pk_fma_f32 v[180:181], v[204:205], v[180:181], v[204:205] neg_lo:[1,0,0] neg_hi:[1,0,0]
    v_pk_fma_f32 v[182:183], v[206:207], v[182:183], v[206:207] neg_lo:[1,0,0] neg_hi:[1,0,0]
    v_cvt_pk_bf16_f32 v200, v176, v177
    v_cvt_pk_bf16_f32 v201, v178, v179
    v_cvt_pk_bf16_f32 v202, v180, v181
    v_cvt_pk_bf16_f32 v203, v182, v183
    buffer_store_dwordx4 v[192:195], v18, s[16:19], s98 offen offset:0 sc1
    buffer_store_dwordx4 v[200:203], v18, s[16:19], s98 offen offset:256 sc1
    v_pk_mul_f32 v[208:209], v[208:209], s[40:41]
    v_pk_mul_f32 v[210:211], v[210:211], s[40:41]
    v_pk_mul_f32 v[212:213], v[212:213], s[40:41]
    v_pk_mul_f32 v[214:215], v[214:215], s[40:41]
    v_exp_f32 v168, v208
    v_exp_f32 v169, v209
    v_exp_f32 v170, v210
    v_exp_f32 v171, v211
    v_exp_f32 v172, v212
    v_exp_f32 v173, v213
    v_exp_f32 v174, v214
    v_exp_f32 v175, v215
    v_pk_fma_f32 v[176:177], v[168:169], v[20:21], v[22:23]
    v_pk_fma_f32 v[178:179], v[170:171], v[20:21], v[22:23]
    v_pk_fma_f32 v[180:181], v[172:173], v[20:21], v[22:23]
    v_pk_fma_f32 v[182:183], v[174:175], v[20:21], v[22:23]
    v_pk_fma_f32 v[176:177], v[176:177], v[168:169], v[22:23]
    v_pk_fma_f32 v[178:179], v[178:179], v[170:171], v[22:23]
    v_pk_fma_f32 v[180:181], v[180:181], v[172:173], v[22:23]
    v_pk_fma_f32 v[182:183], v[182:183], v[174:175], v[22:23]
    v_rcp_f32 v176, v176
    v_rcp_f32 v177, v177
    v_rcp_f32 v178, v178
    v_rcp_f32 v179, v179
    v_rcp_f32 v180, v180
    v_rcp_f32 v181, v181
    v_rcp_f32 v182, v182
    v_rcp_f32 v183, v183
    v_pk_fma_f32 v[176:177], v[208:209], v[176:177], v[208:209] neg_lo:[1,0,0] neg_hi:[1,0,0]
    v_pk_fma_f32 v[178:179], v[210:211], v[178:179], v[210:211] neg_lo:[1,0,0] neg_hi:[1,0,0]
    v_pk_fma_f32 v[180:181], v[212:213], v[180:181], v[212:213] neg_lo:[1,0,0] neg_hi:[1,0,0]
    v_pk_fma_f32 v[182:183], v[214:215], v[182:183], v[214:215] neg_lo:[1,0,0] neg_hi:[1,0,0]
    v_cvt_pk_bf16_f32 v208, v176, v177
    v_cvt_pk_bf16_f32 v209, v178, v179
    v_cvt_pk_bf16_f32 v210, v180, v181
    v_cvt_pk_bf16_f32 v211, v182, v183
    v_pk_mul_f32 v[216:217], v[216:217], s[40:41]
    v_pk_mul_f32 v[218:219], v[218:219], s[40:41]
    v_pk_mul_f32 v[220:221], v[220:221], s[40:41]
    v_pk_mul_f32 v[222:223], v[222:223], s[40:41]
    v_exp_f32 v168, v216
    v_exp_f32 v169, v217
    v_exp_f32 v170, v218
    v_exp_f32 v171, v219
    v_exp_f32 v172, v220
    v_exp_f32 v173, v221
    v_exp_f32 v174, v222
    v_exp_f32 v175, v223
    v_pk_fma_f32 v[176:177], v[168:169], v[20:21], v[22:23]
    v_pk_fma_f32 v[178:179], v[170:171], v[20:21], v[22:23]
    v_pk_fma_f32 v[180:181], v[172:173], v[20:21], v[22:23]
    v_pk_fma_f32 v[182:183], v[174:175], v[20:21], v[22:23]
    v_pk_fma_f32 v[176:177], v[176:177], v[168:169], v[22:23]
    v_pk_fma_f32 v[178:179], v[178:179], v[170:171], v[22:23]
    v_pk_fma_f32 v[180:181], v[180:181], v[172:173], v[22:23]
    v_pk_fma_f32 v[182:183], v[182:183], v[174:175], v[22:23]
    v_rcp_f32 v176, v176
    v_rcp_f32 v177, v177
    v_rcp_f32 v178, v178
    v_rcp_f32 v179, v179
    v_rcp_f32 v180, v180
    v_rcp_f32 v181, v181
    v_rcp_f32 v182, v182
    v_rcp_f32 v183, v183
    v_pk_fma_f32 v[176:177], v[216:217], v[176:177], v[216:217] neg_lo:[1,0,0] neg_hi:[1,0,0]
    v_pk_fma_f32 v[178:179], v[218:219], v[178:179], v[218:219] neg_lo:[1,0,0] neg_hi:[1,0,0]
    v_pk_fma_f32 v[180:181], v[220:221], v[180:181], v[220:221] neg_lo:[1,0,0] neg_hi:[1,0,0]
    v_pk_fma_f32 v[182:183], v[222:223], v[182:183], v[222:223] neg_lo:[1,0,0] neg_hi:[1,0,0]
    v_cvt_pk_bf16_f32 v216, v176, v177
    v_cvt_pk_bf16_f32 v217, v178, v179
    v_cvt_pk_bf16_f32 v218, v180, v181
    v_cvt_pk_bf16_f32 v219, v182, v183
    buffer_store_dwordx4 v[208:211], v18, s[16:19], s98 offen offset:2048 sc1
    buffer_store_dwordx4 v[216:219], v18, s[16:19], s98 offen offset:2304 sc1
    v_pk_mul_f32 v[224:225], v[224:225], s[40:41]
    v_pk_mul_f32 v[226:227], v[226:227], s[40:41]
    v_pk_mul_f32 v[228:229], v[228:229], s[40:41]
    v_pk_mul_f32 v[230:231], v[230:231], s[40:41]
    v_exp_f32 v168, v224
    v_exp_f32 v169, v225
    v_exp_f32 v170, v226
    v_exp_f32 v171, v227
    v_exp_f32 v172, v228
    v_exp_f32 v173, v229
    v_exp_f32 v174, v230
    v_exp_f32 v175, v231
    v_pk_fma_f32 v[176:177], v[168:169], v[20:21], v[22:23]
    v_pk_fma_f32 v[178:179], v[170:171], v[20:21], v[22:23]
    v_pk_fma_f32 v[180:181], v[172:173], v[20:21], v[22:23]
    v_pk_fma_f32 v[182:183], v[174:175], v[20:21], v[22:23]
    v_pk_fma_f32 v[176:177], v[176:177], v[168:169], v[22:23]
    v_pk_fma_f32 v[178:179], v[178:179], v[170:171], v[22:23]
    v_pk_fma_f32 v[180:181], v[180:181], v[172:173], v[22:23]
    v_pk_fma_f32 v[182:183], v[182:183], v[174:175], v[22:23]
    v_rcp_f32 v176, v176
    v_rcp_f32 v177, v177
    v_rcp_f32 v178, v178
    v_rcp_f32 v179, v179
    v_rcp_f32 v180, v180
    v_rcp_f32 v181, v181
    v_rcp_f32 v182, v182
    v_rcp_f32 v183, v183
    v_pk_fma_f32 v[176:177], v[224:225], v[176:177], v[224:225] neg_lo:[1,0,0] neg_hi:[1,0,0]
    v_pk_fma_f32 v[178:179], v[226:227], v[178:179], v[226:227] neg_lo:[1,0,0] neg_hi:[1,0,0]
    v_pk_fma_f32 v[180:181], v[228:229], v[180:181], v[228:229] neg_lo:[1,0,0] neg_hi:[1,0,0]
    v_pk_fma_f32 v[182:183], v[230:231], v[182:183], v[230:231] neg_lo:[1,0,0] neg_hi:[1,0,0]
    v_cvt_pk_bf16_f32 v224, v176, v177
    v_cvt_pk_bf16_f32 v225, v178, v179
    v_cvt_pk_bf16_f32 v226, v180, v181
    v_cvt_pk_bf16_f32 v227, v182, v183
    v_pk_mul_f32 v[232:233], v[232:233], s[40:41]
    v_pk_mul_f32 v[234:235], v[234:235], s[40:41]
    v_pk_mul_f32 v[236:237], v[236:237], s[40:41]
    v_pk_mul_f32 v[238:239], v[238:239], s[40:41]
    v_exp_f32 v168, v232
    v_exp_f32 v169, v233
    v_exp_f32 v170, v234
    v_exp_f32 v171, v235
    v_exp_f32 v172, v236
    v_exp_f32 v173, v237
    v_exp_f32 v174, v238
    v_exp_f32 v175, v239
    v_pk_fma_f32 v[176:177], v[168:169], v[20:21], v[22:23]
    v_pk_fma_f32 v[178:179], v[170:171], v[20:21], v[22:23]
    v_pk_fma_f32 v[180:181], v[172:173], v[20:21], v[22:23]
    v_pk_fma_f32 v[182:183], v[174:175], v[20:21], v[22:23]
    v_pk_fma_f32 v[176:177], v[176:177], v[168:169], v[22:23]
    v_pk_fma_f32 v[178:179], v[178:179], v[170:171], v[22:23]
    v_pk_fma_f32 v[180:181], v[180:181], v[172:173], v[22:23]
    v_pk_fma_f32 v[182:183], v[182:183], v[174:175], v[22:23]
    v_rcp_f32 v176, v176
    v_rcp_f32 v177, v177
    v_rcp_f32 v178, v178
    v_rcp_f32 v179, v179
    v_rcp_f32 v180, v180
    v_rcp_f32 v181, v181
    v_rcp_f32 v182, v182
    v_rcp_f32 v183, v183
    v_pk_fma_f32 v[176:177], v[232:233], v[176:177], v[232:233] neg_lo:[1,0,0] neg_hi:[1,0,0]
    v_pk_fma_f32 v[178:179], v[234:235], v[178:179], v[234:235] neg_lo:[1,0,0] neg_hi:[1,0,0]
    v_pk_fma_f32 v[180:181], v[236:237], v[180:181], v[236:237] neg_lo:[1,0,0] neg_hi:[1,0,0]
    v_pk_fma_f32 v[182:183], v[238:239], v[182:183], v[238:239] neg_lo:[1,0,0] neg_hi:[1,0,0]
    v_cvt_pk_bf16_f32 v232, v176, v177
    v_cvt_pk_bf16_f32 v233, v178, v179
    v_cvt_pk_bf16_f32 v234, v180, v181
    v_cvt_pk_bf16_f32 v235, v182, v183
    buffer_store_dwordx4 v[224:227], v18, s[16:19], s99 offen offset:0 sc1
    buffer_store_dwordx4 v[232:235], v18, s[16:19], s99 offen offset:256 sc1
    v_and_b32 v4, 1, v0
    v_lshlrev_b32 v4, 2, v4
    v_bfe_u32 v5, v0, 1, 2
    v_min_u32_e64 v5, 2, v5
    v_lshl_add_u32 v5, v5, 4, v4
    buffer_load_dword v5, v5, s[16:19], s81 offen sc1
    s_waitcnt vmcnt(0)
    v_mov_b32 v1, s49
    v_mov_b32 v2, 0
    s_mov_b64 exec, 1
    buffer_store_dword v1, v2, s[16:19], s90 offen sc1
    s_mov_b64 exec, -1
    s_waitcnt lgkmcnt(0)
    s_branch L_S2
L_KV:
    s_sub_u32 s46, s46, 8
    s_lshl_b32 s52, s46, 2
    s_lshr_b32 s89, 0xDA8530, s52
    s_and_b32 s89, s89, 15
    s_lshl_b32 s54, s46, 7
    s_mul_i32 s91, s89, 56
    s_sub_u32 s91, s91, s54
    s_mul_i32 s98, s89, 1568
    s_add_u32 s98, s98, s51
    s_lshr_b32 s53, s44, 2
    s_mov_b32 s54, 147456
    s_lshl_b32 s90, s90, 4
    v_mov_b32 v25, s90
    v_cmp_eq_u32 vcc, 7, v31
    s_lshr_b32 s99, 0x14, s46
    s_and_b32 s99, s99, 1
    s_sub_u32 s84, 0, s99
    s_mov_b32 s85, s84
    v_and_b32_e64 v1, 3, v0
    v_bfe_u32 v2, v0, 3, 2
    v_lshl_add_u32 v1, v2, 2, v1
    v_lshrrev_b32 v2, 3, v1
    v_sub_u32 v1, v1, v2
    v_bfe_u32 v2, v0, 2, 1
    v_mul_u32_u24 v2, 14, v2
    v_add_u32 v1, v1, v2
    v_min_u32 v1, 27, v1
    v_lshlrev_b32 v1, 1, v1
    v_mul_u32_u24 v2, 224, v3
    v_add3_u32 v107, v1, v2, s54
    s_mul_i32 s54, s53, 256
    s_add_u32 s54, s54, s91
    s_add_u32 s54, s54, 0
    v_lshl_add_u32 v26, v29, 3, s54
    v_cndmask_b32 v26, v26, v25, s[84:85]
    v_xor_b32 v8, v26, v28
    v_add_u32 v8, v8, v27
    v_lshl_add_u32 v26, v31, 3, s54
    v_cndmask_b32_e64 v26, v26, v25, vcc
    v_cndmask_b32 v26, v26, v25, s[84:85]
    v_xor_b32 v9, v26, v28
    v_add_u32 v9, v9, v27
    s_mul_i32 s54, s53, 256
    s_add_u32 s54, s54, s91
    s_add_u32 s54, s54, 56
    v_lshl_add_u32 v26, v29, 3, s54
    v_xor_b32 v10, v26, v28
    v_add_u32 v10, v10, v27
    v_lshl_add_u32 v26, v31, 3, s54
    v_cndmask_b32 v26, v26, v25, vcc
    v_xor_b32 v11, v26, v28
    v_add_u32_e64 v11, v11, v27
    s_mul_i32 s54, s53, 256
    s_add_u32 s54, s54, s91
    s_add_u32 s54, s54, 112
    v_lshl_add_u32 v26, v29, 3, s54
    v_xor_b32 v12, v26, v28
    v_add_u32_e64 v12, v12, v27
    v_lshl_add_u32 v26, v31, 3, s54
    v_cndmask_b32 v26, v26, v25, vcc
    v_xor_b32 v13, v26, v28
    v_add_u32 v13, v13, v27
    v_and_b32 v2, 3, v0
    v_lshlrev_b32 v2, 6, v2
    v_xor_b32 v2, v2, v25
    v_and_b32 v1, 8, v0
    v_lshlrev_b32 v1, 1, v1
    v_xor_b32_e64 v2, v1, v2
    v_lshl_add_u32 v14, v0, 9, v2
    s_lshl_b32 s54, s44, 15
    v_add_u32 v14, s54, v14
    v_mov_b32 v34, 0
    v_mov_b32 v35, 0
    s_cmp_ge_u32 s44, 3
    s_cbranch_scc1 L_KVz
    ds_write_b64 v14, v[34:35]
L_KVz:
    v_and_b32 v1, 5, v0
    v_and_b32 v2, 2, v0
    v_lshl_or_b32 v1, v2, 2, v1
    v_bfe_u32 v2, v0, 3, 1
    v_lshl_or_b32 v1, v2, 1, v1
    v_xor_b32 v1, v1, v3
    v_and_b32 v2, 31, v0
    v_lshlrev_b32_e64 v26, 4, v2
    v_lshl_or_b32 v18, v3, 13, v26
    v_lshlrev_b32_e64 v2, 7, v2
    v_lshl_or_b32 v1, v1, 3, v2
    s_and_b32 s84, s44, 3
    s_lshl_b32 s84, s84, 12
    v_add_u32 v240, s84, v1
    v_xor_b32 v241, 16, v240
    v_xor_b32 v242, 32, v240
    v_xor_b32 v243, 48, v240
    v_xor_b32_e64 v244, 64, v240
    v_xor_b32 v245, 80, v240
    v_xor_b32 v246, 96, v240
    v_xor_b32 v247, 112, v240
    v_add_u32 v248, 98304, v240
    v_add_u32 v249, 98304, v241
    v_add_u32 v250, 98304, v242
    v_add_u32 v251, 98304, v243
    v_add_u32 v252, 98304, v244
    v_add_u32 v253, 98304, v245
    v_add_u32 v254, 98304, v246
    v_add_u32 v255, 98304, v247
    v_bfe_u32 v1, v0, 2, 2
    v_lshl_add_u32 v26, v3, 3, v1
    v_lshlrev_b32 v26, 7, v26
    v_and_b32 v20, 1, v1
    v_lshl_or_b32 v20, v3, 1, v20
    v_lshrrev_b32_e64 v1, 1, v1
    v_lshl_or_b32 v20, v1, 3, v20
    v_bfe_u32 v1, v0, 4, 1
    v_and_b32_e64 v2, 3, v0
    v_lshl_add_u32 v1, v1, 2, v2
    v_xor_b32_e64 v20, v20, v1
    v_lshl_add_u32 v20, v20, 3, v26
    s_lshr_b32 s84, s44, 1
    s_and_b32 s85, s44, 1
    s_lshl_b32 s85, s85, 6
    s_and_b32 s86, s84, 1
    s_lshl_b32 s90, s86, 6
    s_lshl_b32 s86, s86, 14
    s_lshr_b32 s87, s84, 1
    s_mul_i32 s91, s87, 98304
    s_add_u32 s86, s86, s91
    s_lshl_b32 s87, s87, 14
    s_add_u32 s87, s87, 131072
    v_xor_b32 v22, s90, v20
    v_xor_b32 v20, s85, v20
    v_xor_b32 v21, 32, v20
    v_xor_b32 v23, 32, v22
    v_add_u32 v20, s86, v20
    v_add_u32 v21, s86, v21
    v_add_u32 v22, s87, v22
    v_add_u32 v23, s87, v23
    s_add_u32 s90, s89, s84
    s_lshl_b32 s90, s90, 1
    s_and_b32 s85, s44, 1
    s_add_u32 s90, s90, s85
    s_lshl_b32 s90, s90, 6
    s_add_u32 s90, s90, s45
    s_lshl_b32 s90, s90, 9
    s_add_u32 s90, s90, 1048576
    s_cmp_lt_u32 s44, 2
    s_cselect_b32 s85, s99, 0
    s_lshl_b32 s85, s85, 28
    s_add_u32 s90, s90, s85
    s_add_u32 s91, s90, 16384
    v_mov_b32 v19, 0x3f80
    s_add_u32 m0, s51, 32768
    s_mov_b64 exec, s[56:57]
    buffer_load_dwordx4 v4, s[12:15], s7 offen lds
    s_mov_b64 exec, -1
    s_add_u32 s7, s7, s95
    s_add_u32 m0, s51, 40960
    s_mov_b64 exec, s[56:57]
    buffer_load_dwordx4 v4, s[12:15], s7 offen lds
    s_mov_b64 exec, -1
    s_add_u32 s7, s7, s95
    s_add_u32 m0, s51, 49152
    s_mov_b64 exec, s[56:57]
    buffer_load_dwordx4 v4, s[12:15], s7 offen lds
    s_mov_b64 exec, -1
    s_add_u32 s7, s7, s95
    s_add_u32 m0, s51, 57344
    s_mov_b64 exec, s[56:57]
    buffer_load_dwordx4 v4, s[12:15], s7 offen lds
    s_mov_b64 exec, -1
    s_add_u32 m0, s51, 147456
    s_nop 0
    buffer_load_dwordx4 v7, s[32:35], s98 offen lds
    s_waitcnt lgkmcnt(0)
    s_lshr_b32 s80, s49, 16
    s_add_u32 s80, s80, 0x2a5b
    s_and_b32 s80, s80, 0x3fff
    s_lshl_b32 s50, s80, 16
    s_mul_i32 s49, s49, 1664525
    s_add_u32 s49, s49, 1013904223
    s_lshr_b32 s49, s49, 16
    s_or_b32 s49, s49, s50
    s_waitcnt vmcnt(8)
    s_waitcnt lgkmcnt(0)
    s_barrier
    ds_read_b128 v[144:147], v16 offset:0
    ds_read_b128 v[148:151], v16 offset:2048
    ds_read_b64_tr_b16 v[160:161], v8 offset:0
    ds_read_b64_tr_b16 v[162:163], v8 offset:2048
    ds_read_b64_tr_b16 v[164:165], v9 offset:0
    ds_read_b64_tr_b16 v[166:167], v9 offset:2048
    ds_read_b64_tr_b16 v[168:169], v10 offset:0
    ds_read_b64_tr_b16 v[170:171], v10 offset:2048
    s_waitcnt lgkmcnt(4)
    v_mfma_f32_16x16x32_bf16 v[192:195], v[160:163], v[144:147], 0
    ds_read_b64_tr_b16 v[176:177], v11 offset:0
    v_mfma_f32_16x16x32_bf16 v[200:203], v[160:163], v[148:151], 0
    ds_read_b64_tr_b16 v[178:179], v11 offset:2048
    s_waitcnt lgkmcnt(4)
    v_mfma_f32_16x16x32_bf16 v[196:199], v[164:167], v[144:147], 0
    ds_read_b64_tr_b16 v[180:181], v12 offset:0
    ds_read_b64_tr_b16 v[182:183], v12 offset:2048
    v_mfma_f32_16x16x32_bf16 v[204:207], v[164:167], v[148:151], 0
    ds_read_b64_tr_b16 v[184:185], v13 offset:0
    s_waitcnt lgkmcnt(5)
    v_mfma_f32_16x16x32_bf16 v[208:211], v[168:171], v[144:147], 0
    ds_read_b64_tr_b16 v[186:187], v13 offset:2048
    v_mfma_f32_16x16x32_bf16 v[216:219], v[168:171], v[148:151], 0
    s_add_u32 s6, s3, 2
    s_sub_u32 s7, s6, 6
    s_cmp_ge_u32 s6, 7
    s_cselect_b32 s6, s7, s6
    s_mul_i32 s7, s6, s95
    s_lshl_b32 s7, s7, 2
    s_lshl_b32 s6, s6, 7
    s_add_u32 m0, s51, 131072
    s_nop 0
    buffer_load_dwordx4 v5, s[8:11], s6 offen lds
    s_add_u32 m0, s51, 139264
    s_add_u32 s52, s6, 57344
    buffer_load_dwordx4 v5, s[8:11], s52 offen lds
    s_waitcnt lgkmcnt(4)
    v_mfma_f32_16x16x32_bf16 v[212:215], v[176:179], v[144:147], 0
    ds_read_b128 v[152:155], v17 offset:0
    v_mfma_f32_16x16x32_bf16 v[220:223], v[176:179], v[148:151], 0
    ds_read_b128 v[156:159], v17 offset:2048
    ds_read_b64_tr_b16 v[160:161], v8 offset:16384
    s_waitcnt lgkmcnt(5)
    v_mfma_f32_16x16x32_bf16 v[224:227], v[180:183], v[144:147], 0
    ds_read_b64_tr_b16 v[162:163], v8 offset:18432
    ds_read_b64_tr_b16 v[164:165], v9 offset:16384
    v_mfma_f32_16x16x32_bf16 v[232:235], v[180:183], v[148:151], 0
    ds_read_b64_tr_b16 v[166:167], v9 offset:18432
    s_waitcnt lgkmcnt(6)
    v_mfma_f32_16x16x32_bf16 v[228:231], v[184:187], v[144:147], 0
    ds_read_b64_tr_b16 v[168:169], v10 offset:16384
    ds_read_b64_tr_b16 v[170:171], v10 offset:18432
    v_mfma_f32_16x16x32_bf16 v[236:239], v[184:187], v[148:151], 0
    s_add_u32 m0, s51, 65536
    s_mov_b64 exec, s[56:57]
    buffer_load_dwordx4 v4, s[12:15], s7 offen lds
    s_mov_b64 exec, -1
    s_add_u32 s7, s7, s95
    s_add_u32 m0, s51, 73728
    s_mov_b64 exec, s[56:57]
    buffer_load_dwordx4 v4, s[12:15], s7 offen lds
    s_mov_b64 exec, -1
    s_add_u32 s7, s7, s95
    s_waitcnt lgkmcnt(4)
    v_mfma_f32_16x16x32_bf16 v[192:195], v[160:163], v[152:155], v[192:195]
    ds_read_b64_tr_b16 v[176:177], v11 offset:16384
    v_mfma_f32_16x16x32_bf16 v[200:203], v[160:163], v[156:159], v[200:203]
    ds_read_b64_tr_b16 v[178:179], v11 offset:18432
    s_waitcnt lgkmcnt(4)
    v_mfma_f32_16x16x32_bf16 v[196:199], v[164:167], v[152:155], v[196:199]
    ds_read_b64_tr_b16 v[180:181], v12 offset:16384
    ds_read_b64_tr_b16 v[182:183], v12 offset:18432
    v_mfma_f32_16x16x32_bf16 v[204:207], v[164:167], v[156:159], v[204:207]
    ds_read_b64_tr_b16 v[184:185], v13 offset:16384
    s_waitcnt lgkmcnt(5)
    v_mfma_f32_16x16x32_bf16 v[208:211], v[168:171], v[152:155], v[208:211]
    ds_read_b64_tr_b16 v[186:187], v13 offset:18432
    v_mfma_f32_16x16x32_bf16 v[216:219], v[168:171], v[156:159], v[216:219]
    s_add_u32 m0, s51, 81920
    s_mov_b64 exec, s[56:57]
    buffer_load_dwordx4 v4, s[12:15], s7 offen lds
    s_mov_b64 exec, -1
    s_add_u32 s7, s7, s95
    s_add_u32 m0, s51, 90112
    s_mov_b64 exec, s[56:57]
    buffer_load_dwordx4 v4, s[12:15], s7 offen lds
    s_mov_b64 exec, -1
    s_waitcnt lgkmcnt(0)
    v_mfma_f32_16x16x32_bf16 v[212:215], v[176:179], v[152:155], v[212:215]
    s_waitcnt vmcnt(6)
    s_barrier
    v_mfma_f32_16x16x32_bf16 v[220:223], v[176:179], v[156:159], v[220:223]
    ds_read_b128 v[144:147], v16 offset:16384
    ds_read_b128 v[148:151], v16 offset:18432
    v_mfma_f32_16x16x32_bf16 v[224:227], v[180:183], v[152:155], v[224:227]
    ds_read_b64_tr_b16 v[160:161], v8 offset:32768
    ds_read_b64_tr_b16 v[162:163], v8 offset:34816
    v_mfma_f32_16x16x32_bf16 v[232:235], v[180:183], v[156:159], v[232:235]
    ds_read_b64_tr_b16 v[164:165], v9 offset:32768
    ds_read_b64_tr_b16 v[166:167], v9 offset:34816
    v_mfma_f32_16x16x32_bf16 v[228:231], v[184:187], v[152:155], v[228:231]
    ds_read_b64_tr_b16 v[168:169], v10 offset:32768
    ds_read_b64_tr_b16 v[170:171], v10 offset:34816
    v_mfma_f32_16x16x32_bf16 v[236:239], v[184:187], v[156:159], v[236:239]
    s_add_u32 s6, s3, 3
    s_sub_u32 s7, s6, 6
    s_cmp_ge_u32 s6, 7
    s_cselect_b32 s6, s7, s6
    s_mul_i32 s7, s6, s95
    s_lshl_b32 s7, s7, 2
    s_lshl_b32 s6, s6, 7
    s_add_u32 m0, s51, 98304
    s_nop 0
    buffer_load_dwordx4 v5, s[8:11], s6 offen lds
    s_add_u32 m0, s51, 106496
    s_add_u32 s52, s6, 57344
    buffer_load_dwordx4 v5, s[8:11], s52 offen lds
    s_waitcnt lgkmcnt(4)
    v_mfma_f32_16x16x32_bf16 v[192:195], v[160:163], v[144:147], v[192:195]
    ds_read_b64_tr_b16 v[176:177], v11 offset:32768
    v_mfma_f32_16x16x32_bf16 v[200:203], v[160:163], v[148:151], v[200:203]
    ds_read_b64_tr_b16 v[178:179], v11 offset:34816
    s_waitcnt lgkmcnt(4)
    v_mfma_f32_16x16x32_bf16 v[196:199], v[164:167], v[144:147], v[196:199]
    ds_read_b64_tr_b16 v[180:181], v12 offset:32768
    ds_read_b64_tr_b16 v[182:183], v12 offset:34816
    v_mfma_f32_16x16x32_bf16 v[204:207], v[164:167], v[148:151], v[204:207]
    ds_read_b64_tr_b16 v[184:185], v13 offset:32768
    s_waitcnt lgkmcnt(5)
    v_mfma_f32_16x16x32_bf16 v[208:211], v[168:171], v[144:147], v[208:211]
    ds_read_b64_tr_b16 v[186:187], v13 offset:34816
    v_mfma_f32_16x16x32_bf16 v[216:219], v[168:171], v[148:151], v[216:219]
    s_add_u32 m0, s51, 0
    s_mov_b64 exec, s[56:57]
    buffer_load_dwordx4 v4, s[12:15], s7 offen lds
    s_mov_b64 exec, -1
    s_add_u32 s7, s7, s95
    s_add_u32 m0, s51, 8192
    s_mov_b64 exec, s[56:57]
    buffer_load_dwordx4 v4, s[12:15], s7 offen lds
    s_mov_b64 exec, -1
    s_add_u32 s7, s7, s95
    s_waitcnt lgkmcnt(4)
    v_mfma_f32_16x16x32_bf16 v[212:215], v[176:179], v[144:147], v[212:215]
    ds_read_b128 v[152:155], v17 offset:16384
    ds_read_b128 v[156:159], v17 offset:18432
    v_mfma_f32_16x16x32_bf16 v[220:223], v[176:179], v[148:151], v[220:223]
    ds_read_b64_tr_b16 v[160:161], v8 offset:49152
    ds_read_b64_tr_b16 v[162:163], v8 offset:51200
    s_waitcnt lgkmcnt(6)
    v_mfma_f32_16x16x32_bf16 v[224:227], v[180:183], v[144:147], v[224:227]
    ds_read_b64_tr_b16 v[164:165], v9 offset:49152
    ds_read_b64_tr_b16 v[166:167], v9 offset:51200
    v_mfma_f32_16x16x32_bf16 v[232:235], v[180:183], v[148:151], v[232:235]
    ds_read_b64_tr_b16 v[168:169], v10 offset:49152
    ds_read_b64_tr_b16 v[170:171], v10 offset:51200
    s_waitcnt lgkmcnt(8)
    v_mfma_f32_16x16x32_bf16 v[228:231], v[184:187], v[144:147], v[228:231]
    s_add_u32 m0, s51, 16384
    s_mov_b64 exec, s[56:57]
    buffer_load_dwordx4 v4, s[12:15], s7 offen lds
    s_mov_b64 exec, -1
    s_add_u32 s7, s7, s95
    s_add_u32 m0, s51, 24576
    s_mov_b64 exec, s[56:57]
    buffer_load_dwordx4 v4, s[12:15], s7 offen lds
    s_mov_b64 exec, -1
    v_mfma_f32_16x16x32_bf16 v[236:239], v[184:187], v[148:151], v[236:239]
    buffer_load_dword v108, v104, s[20:23], 0 offen
    buffer_load_dword v108, v105, s[24:27], 0 offen
    buffer_load_dword v108, v106, s[16:19], 0 offen
    s_waitcnt lgkmcnt(4)
    v_mfma_f32_16x16x32_bf16 v[192:195], v[160:163], v[152:155], v[192:195]
    ds_read_b64_tr_b16 v[176:177], v11 offset:49152
    v_mfma_f32_16x16x32_bf16 v[200:203], v[160:163], v[156:159], v[200:203]
    ds_read_b64_tr_b16 v[178:179], v11 offset:51200
    s_waitcnt lgkmcnt(4)
    v_mfma_f32_16x16x32_bf16 v[196:199], v[164:167], v[152:155], v[196:199]
    ds_read_b64_tr_b16 v[180:181], v12 offset:49152
    v_mfma_f32_16x16x32_bf16 v[204:207], v[164:167], v[156:159], v[204:207]
    ds_read_b64_tr_b16 v[182:183], v12 offset:51200
    s_waitcnt lgkmcnt(4)
    v_mfma_f32_16x16x32_bf16 v[208:211], v[168:171], v[152:155], v[208:211]
    ds_read_b64_tr_b16 v[184:185], v13 offset:49152
    v_mfma_f32_16x16x32_bf16 v[216:219], v[168:171], v[156:159], v[216:219]
    ds_read_b64_tr_b16 v[186:187], v13 offset:51200
    s_cmp_ge_u32 s44, 4
    s_cbranch_scc1 L_wp_37
    ds_read_u16 v40, v107 offset:0
    ds_read_u16 v41, v107 offset:56
    ds_read_u16 v42, v107 offset:112
    ds_read_u16 v43, v107 offset:168
    ds_read_u16 v44, v107 offset:448
    ds_read_u16 v45, v107 offset:504
    ds_read_u16 v46, v107 offset:560
    ds_read_u16 v47, v107 offset:616
    ds_read_u16 v48, v107 offset:896
    ds_read_u16 v49, v107 offset:952
    ds_read_u16 v50, v107 offset:1008
    ds_read_u16 v51, v107 offset:1064
    ds_read_u16 v52, v107 offset:1344
    ds_read_u16 v53, v107 offset:1400
    ds_read_u16 v54, v107 offset:1456
    ds_read_u16 v55, v107 offset:1512
    ds_read_u16 v56, v107 offset:1568
    ds_read_u16 v57, v107 offset:1624
    ds_read_u16 v58, v107 offset:1680
    ds_read_u16 v59, v107 offset:1736
    ds_read_u16 v60, v107 offset:2016
    ds_read_u16 v61, v107 offset:2072
    ds_read_u16 v62, v107 offset:2128
    ds_read_u16 v63, v107 offset:2184
    ds_read_u16 v64, v107 offset:2464
    ds_read_u16 v65, v107 offset:2520
    ds_read_u16 v66, v107 offset:2576
    ds_read_u16 v67, v107 offset:2632
    ds_read_u16 v68, v107 offset:2912
    ds_read_u16 v69, v107 offset:2968
    ds_read_u16 v70, v107 offset:3024
    ds_read_u16 v71, v107 offset:3080
    ds_read_u16 v72, v107 offset:3136
    ds_read_u16 v73, v107 offset:3192
    ds_read_u16 v74, v107 offset:3248
    ds_read_u16 v75, v107 offset:3304
    ds_read_u16 v76, v107 offset:3584
    ds_read_u16 v77, v107 offset:3640
    ds_read_u16 v78, v107 offset:3696
    ds_read_u16 v79, v107 offset:3752
    ds_read_u16 v80, v107 offset:4032
    ds_read_u16 v81, v107 offset:4088
    ds_read_u16 v82, v107 offset:4144
    ds_read_u16 v83, v107 offset:4200
    ds_read_u16 v84, v107 offset:4480
    ds_read_u16 v85, v107 offset:4536
    ds_read_u16 v86, v107 offset:4592
    ds_read_u16 v87, v107 offset:4648
L_wp_37:
    s_waitcnt lgkmcnt(0)
    v_mfma_f32_16x16x32_bf16 v[212:215], v[176:179], v[152:155], v[212:215]
    v_xor_b32 v8, 0x10000, v8
    v_xor_b32 v9, 0x10000, v9
    v_xor_b32 v10, 0x10000, v10
    v_xor_b32 v11, 0x10000, v11
    v_xor_b32 v12, 0x10000, v12
    v_xor_b32 v13, 0x10000, v13
    s_waitcnt vmcnt(9)
    s_barrier
    v_mfma_f32_16x16x32_bf16 v[220:223], v[176:179], v[156:159], v[220:223]
    ds_read_b128 v[144:147], v16 offset:32768
    ds_read_b128 v[148:151], v16 offset:34816
    v_mfma_f32_16x16x32_bf16 v[224:227], v[180:183], v[152:155], v[224:227]
    ds_read_b64_tr_b16 v[160:161], v8 offset:0
    ds_read_b64_tr_b16 v[162:163], v8 offset:2048
    v_mfma_f32_16x16x32_bf16 v[232:235], v[180:183], v[156:159], v[232:235]
    ds_read_b64_tr_b16 v[164:165], v9 offset:0
    ds_read_b64_tr_b16 v[166:167], v9 offset:2048
    v_mfma_f32_16x16x32_bf16 v[228:231], v[184:187], v[152:155], v[228:231]
    ds_read_b64_tr_b16 v[168:169], v10 offset:0
    ds_read_b64_tr_b16 v[170:171], v10 offset:2048
    v_mfma_f32_16x16x32_bf16 v[236:239], v[184:187], v[156:159], v[236:239]
    s_add_u32 s6, s3, 4
    s_sub_u32 s7, s6, 6
    s_cmp_ge_u32 s6, 7
    s_cselect_b32 s6, s7, s6
    s_mul_i32 s7, s6, s95
    s_lshl_b32 s7, s7, 2
    s_lshl_b32 s6, s6, 7
    s_add_u32 m0, s51, 114688
    s_nop 0
    buffer_load_dwordx4 v5, s[8:11], s6 offen lds
    s_add_u32 m0, s51, 122880
    s_add_u32 s52, s6, 57344
    buffer_load_dwordx4 v5, s[8:11], s52 offen lds
    s_waitcnt lgkmcnt(4)
    v_mfma_f32_16x16x32_bf16 v[192:195], v[160:163], v[144:147], v[192:195]
    ds_read_b64_tr_b16 v[176:177], v11 offset:0
    ds_read_b64_tr_b16 v[178:179], v11 offset:2048
    ds_read_b64_tr_b16 v[180:181], v12 offset:0
    v_mfma_f32_16x16x32_bf16 v[200:203], v[160:163], v[148:151], v[200:203]
    ds_read_b64_tr_b16 v[182:183], v12 offset:2048
    ds_read_b64_tr_b16 v[184:185], v13 offset:0
    ds_read_b64_tr_b16 v[186:187], v13 offset:2048
    s_waitcnt lgkmcnt(8)
    v_mfma_f32_16x16x32_bf16 v[196:199], v[164:167], v[144:147], v[196:199]
    s_add_u32 m0, s51, 32768
    s_mov_b64 exec, s[56:57]
    buffer_load_dwordx4 v4, s[12:15], s7 offen lds
    s_mov_b64 exec, -1
    s_add_u32 s7, s7, s95
    s_add_u32 m0, s51, 40960
    s_mov_b64 exec, s[56:57]
    buffer_load_dwordx4 v4, s[12:15], s7 offen lds
    s_mov_b64 exec, -1
    s_add_u32 s7, s7, s95
    v_lshl_or_b32 v112, v41, 16, v40
    v_mfma_f32_16x16x32_bf16 v[204:207], v[164:167], v[148:151], v[204:207]
    v_lshl_or_b32 v113, v43, 16, v42
    v_lshl_or_b32 v114, v45, 16, v44
    v_lshl_or_b32 v115, v47, 16, v46
    s_waitcnt lgkmcnt(6)
    v_mfma_f32_16x16x32_bf16 v[208:211], v[168:171], v[144:147], v[208:211]
    v_lshl_or_b32 v116, v49, 16, v48
    v_lshl_or_b32 v117, v51, 16, v50
    v_lshl_or_b32 v118, v53, 16, v52
    v_mfma_f32_16x16x32_bf16 v[216:219], v[168:171], v[148:151], v[216:219]
    v_lshl_or_b32 v119, v55, 16, v54
    v_cndmask_b32 v118, v118, 0, s[58:59]
    v_cndmask_b32 v119, v119, 0, s[58:59]
    s_waitcnt lgkmcnt(4)
    v_mfma_f32_16x16x32_bf16 v[212:215], v[176:179], v[144:147], v[212:215]
    ds_read_b128 v[152:155], v17 offset:32768
    ds_read_b128 v[156:159], v17 offset:34816
    ds_read_b64_tr_b16 v[160:161], v8 offset:16384
    v_mfma_f32_16x16x32_bf16 v[220:223], v[176:179], v[148:151], v[220:223]
    ds_read_b64_tr_b16 v[162:163], v8 offset:18432
    ds_read_b64_tr_b16 v[164:165], v9 offset:16384
    ds_read_b64_tr_b16 v[166:167], v9 offset:18432
    s_waitcnt lgkmcnt(8)
    v_mfma_f32_16x16x32_bf16 v[224:227], v[180:183], v[144:147], v[224:227]
    ds_read_b64_tr_b16 v[168:169], v10 offset:16384
    ds_read_b64_tr_b16 v[170:171], v10 offset:18432
    s_add_u32 m0, s51, 49152
    s_mov_b64 exec, s[56:57]
    buffer_load_dwordx4 v4, s[12:15], s7 offen lds
    s_mov_b64 exec, -1
    s_add_u32 s7, s7, s95
    s_add_u32 m0, s51, 57344
    s_mov_b64 exec, s[56:57]
    buffer_load_dwordx4 v4, s[12:15], s7 offen lds
    s_mov_b64 exec, -1
    v_mfma_f32_16x16x32_bf16 v[232:235], v[180:183], v[148:151], v[232:235]
    v_lshl_or_b32 v120, v57, 16, v56
    v_lshl_or_b32 v121, v59, 16, v58
    v_lshl_or_b32 v122, v61, 16, v60
    s_waitcnt lgkmcnt(8)
    v_mfma_f32_16x16x32_bf16 v[228:231], v[184:187], v[144:147], v[228:231]
    v_lshl_or_b32 v123, v63, 16, v62
    v_lshl_or_b32 v124, v65, 16, v64
    v_lshl_or_b32 v125, v67, 16, v66
    v_mfma_f32_16x16x32_bf16 v[236:239], v[184:187], v[148:151], v[236:239]
    v_lshl_or_b32 v126, v69, 16, v68
    v_lshl_or_b32 v127, v71, 16, v70
    v_cndmask_b32 v126, v126, 0, s[58:59]
    v_cndmask_b32 v127, v127, 0, s[58:59]
    s_waitcnt lgkmcnt(4)
    v_mfma_f32_16x16x32_bf16 v[192:195], v[160:163], v[152:155], v[192:195]
    ds_read_b64_tr_b16 v[176:177], v11 offset:16384
    ds_read_b64_tr_b16 v[178:179], v11 offset:18432
    v_mfma_f32_16x16x32_bf16 v[200:203], v[160:163], v[156:159], v[200:203]
    ds_read_b64_tr_b16 v[180:181], v12 offset:16384
    ds_read_b64_tr_b16 v[182:183], v12 offset:18432
    ds_read_b64_tr_b16 v[184:185], v13 offset:16384
    s_waitcnt lgkmcnt(7)
    v_mfma_f32_16x16x32_bf16 v[196:199], v[164:167], v[152:155], v[196:199]
    ds_read_b64_tr_b16 v[186:187], v13 offset:18432
    v_lshl_or_b32 v128, v73, 16, v72
    v_lshl_or_b32 v129, v75, 16, v74
    v_mfma_f32_16x16x32_bf16 v[204:207], v[164:167], v[156:159], v[204:207]
    v_lshl_or_b32 v130, v77, 16, v76
    v_lshl_or_b32 v131, v79, 16, v78
    s_waitcnt lgkmcnt(6)
    v_mfma_f32_16x16x32_bf16 v[208:211], v[168:171], v[152:155], v[208:211]
    v_lshl_or_b32 v132, v81, 16, v80
    v_lshl_or_b32 v133, v83, 16, v82
    v_lshl_or_b32 v134, v85, 16, v84
    v_mfma_f32_16x16x32_bf16 v[216:219], v[168:171], v[156:159], v[216:219]
    v_lshl_or_b32 v135, v87, 16, v86
    v_cndmask_b32 v134, v134, 0, s[58:59]
    v_cndmask_b32 v135, v135, 0, s[58:59]
    s_waitcnt lgkmcnt(0)
    v_mfma_f32_16x16x32_bf16 v[212:215], v[176:179], v[152:155], v[212:215]
    v_xor_b32 v8, 0x10000, v8
    v_xor_b32 v9, 0x10000, v9
    v_xor_b32 v10, 0x10000, v10
    v_xor_b32 v11, 0x10000, v11
    v_xor_b32 v12, 0x10000, v12
    v_xor_b32 v13, 0x10000, v13
    s_waitcnt vmcnt(9)
    s_barrier
    v_mfma_f32_16x16x32_bf16 v[220:223], v[176:179], v[156:159], v[220:223]
    ds_read_b128 v[144:147], v16 offset:0
    ds_read_b128 v[148:151], v16 offset:2048
    v_mfma_f32_16x16x32_bf16 v[224:227], v[180:183], v[152:155], v[224:227]
    ds_read_b64_tr_b16 v[160:161], v8 offset:0
    ds_read_b64_tr_b16 v[162:163], v8 offset:2048
    v_mfma_f32_16x16x32_bf16 v[232:235], v[180:183], v[156:159], v[232:235]
    ds_read_b64_tr_b16 v[164:165], v9 offset:0
    ds_read_b64_tr_b16 v[166:167], v9 offset:2048
    v_mfma_f32_16x16x32_bf16 v[228:231], v[184:187], v[152:155], v[228:231]
    ds_read_b64_tr_b16 v[168:169], v10 offset:0
    ds_read_b64_tr_b16 v[170:171], v10 offset:2048
    v_mfma_f32_16x16x32_bf16 v[236:239], v[184:187], v[156:159], v[236:239]
    s_add_u32 s6, s3, 5
    s_sub_u32 s7, s6, 6
    s_cmp_ge_u32 s6, 7
    s_cselect_b32 s6, s7, s6
    s_mul_i32 s7, s6, s95
    s_lshl_b32 s7, s7, 2
    s_lshl_b32 s6, s6, 7
    s_add_u32 m0, s51, 131072
    s_nop 0
    buffer_load_dwordx4 v5, s[8:11], s6 offen lds
    s_add_u32 m0, s51, 139264
    s_add_u32 s52, s6, 57344
    buffer_load_dwordx4 v5, s[8:11], s52 offen lds
    s_waitcnt lgkmcnt(4)
    v_mfma_f32_16x16x32_bf16 v[192:195], v[160:163], v[144:147], v[192:195]
    ds_read_b64_tr_b16 v[176:177], v11 offset:0
    v_mfma_f32_16x16x32_bf16 v[200:203], v[160:163], v[148:151], v[200:203]
    ds_read_b64_tr_b16 v[178:179], v11 offset:2048
    s_waitcnt lgkmcnt(4)
    v_mfma_f32_16x16x32_bf16 v[196:199], v[164:167], v[144:147], v[196:199]
    ds_read_b64_tr_b16 v[180:181], v12 offset:0
    ds_read_b64_tr_b16 v[182:183], v12 offset:2048
    v_mfma_f32_16x16x32_bf16 v[204:207], v[164:167], v[148:151], v[204:207]
    ds_read_b64_tr_b16 v[184:185], v13 offset:0
    s_waitcnt lgkmcnt(5)
    v_mfma_f32_16x16x32_bf16 v[208:211], v[168:171], v[144:147], v[208:211]
    ds_read_b64_tr_b16 v[186:187], v13 offset:2048
    v_mfma_f32_16x16x32_bf16 v[216:219], v[168:171], v[148:151], v[216:219]
    s_add_u32 m0, s51, 65536
    s_mov_b64 exec, s[56:57]
    buffer_load_dwordx4 v4, s[12:15], s7 offen lds
    s_mov_b64 exec, -1
    s_add_u32 s7, s7, s95
    s_add_u32 m0, s51, 73728
    s_mov_b64 exec, s[56:57]
    buffer_load_dwordx4 v4, s[12:15], s7 offen lds
    s_mov_b64 exec, -1
    s_add_u32 s7, s7, s95
    s_waitcnt lgkmcnt(4)
    v_mfma_f32_16x16x32_bf16 v[212:215], v[176:179], v[144:147], v[212:215]
    ds_read_b128 v[152:155], v17 offset:0
    v_mfma_f32_16x16x32_bf16 v[220:223], v[176:179], v[148:151], v[220:223]
    ds_read_b128 v[156:159], v17 offset:2048
    ds_read_b64_tr_b16 v[160:161], v8 offset:16384
    s_waitcnt lgkmcnt(5)
    v_mfma_f32_16x16x32_bf16 v[224:227], v[180:183], v[144:147], v[224:227]
    ds_read_b64_tr_b16 v[162:163], v8 offset:18432
    ds_read_b64_tr_b16 v[164:165], v9 offset:16384
    v_mfma_f32_16x16x32_bf16 v[232:235], v[180:183], v[148:151], v[232:235]
    ds_read_b64_tr_b16 v[166:167], v9 offset:18432
    s_waitcnt lgkmcnt(6)
    v_mfma_f32_16x16x32_bf16 v[228:231], v[184:187], v[144:147], v[228:231]
    ds_read_b64_tr_b16 v[168:169], v10 offset:16384
    ds_read_b64_tr_b16 v[170:171], v10 offset:18432
    v_mfma_f32_16x16x32_bf16 v[236:239], v[184:187], v[148:151], v[236:239]
    s_add_u32 m0, s51, 81920
    s_mov_b64 exec, s[56:57]
    buffer_load_dwordx4 v4, s[12:15], s7 offen lds
    s_mov_b64 exec, -1
    s_add_u32 s7, s7, s95
    s_add_u32 m0, s51, 90112
    s_mov_b64 exec, s[56:57]
    buffer_load_dwordx4 v4, s[12:15], s7 offen lds
    s_mov_b64 exec, -1
    s_waitcnt lgkmcnt(4)
    v_mfma_f32_16x16x32_bf16 v[192:195], v[160:163], v[152:155], v[192:195]
    ds_read_b64_tr_b16 v[176:177], v11 offset:16384
    v_mfma_f32_16x16x32_bf16 v[200:203], v[160:163], v[156:159], v[200:203]
    ds_read_b64_tr_b16 v[178:179], v11 offset:18432
    s_waitcnt lgkmcnt(4)
    v_mfma_f32_16x16x32_bf16 v[196:199], v[164:167], v[152:155], v[196:199]
    ds_read_b64_tr_b16 v[180:181], v12 offset:16384
    v_mfma_f32_16x16x32_bf16 v[204:207], v[164:167], v[156:159], v[204:207]
    ds_read_b64_tr_b16 v[182:183], v12 offset:18432
    s_waitcnt lgkmcnt(4)
    v_mfma_f32_16x16x32_bf16 v[208:211], v[168:171], v[152:155], v[208:211]
    ds_read_b64_tr_b16 v[184:185], v13 offset:16384
    v_mfma_f32_16x16x32_bf16 v[216:219], v[168:171], v[156:159], v[216:219]
    ds_read_b64_tr_b16 v[186:187], v13 offset:18432
    s_waitcnt lgkmcnt(0)
    v_mfma_f32_16x16x32_bf16 v[212:215], v[176:179], v[152:155], v[212:215]
    s_waitcnt vmcnt(6)
    s_barrier
    v_mfma_f32_16x16x32_bf16 v[220:223], v[176:179], v[156:159], v[220:223]
    ds_read_b128 v[144:147], v16 offset:16384
    ds_read_b128 v[148:151], v16 offset:18432
    v_mfma_f32_16x16x32_bf16 v[224:227], v[180:183], v[152:155], v[224:227]
    ds_read_b64_tr_b16 v[160:161], v8 offset:32768
    ds_read_b64_tr_b16 v[162:163], v8 offset:34816
    v_mfma_f32_16x16x32_bf16 v[232:235], v[180:183], v[156:159], v[232:235]
    ds_read_b64_tr_b16 v[164:165], v9 offset:32768
    ds_read_b64_tr_b16 v[166:167], v9 offset:34816
    v_mfma_f32_16x16x32_bf16 v[228:231], v[184:187], v[152:155], v[228:231]
    ds_read_b64_tr_b16 v[168:169], v10 offset:32768
    ds_read_b64_tr_b16 v[170:171], v10 offset:34816
    v_mfma_f32_16x16x32_bf16 v[236:239], v[184:187], v[156:159], v[236:239]
    s_add_u32 m0, s63, 49152
    s_add_u32 s52, s60, 0
    buffer_load_dwordx4 v6, s[20:23], s52 offen lds
    s_add_u32 m0, s63, 50176
    s_add_u32 s52, s60, 7168
    buffer_load_dwordx4 v6, s[20:23], s52 offen lds
    s_waitcnt lgkmcnt(4)
    v_mfma_f32_16x16x32_bf16 v[192:195], v[160:163], v[144:147], v[192:195]
    ds_read_b64_tr_b16 v[176:177], v11 offset:32768
    v_mfma_f32_16x16x32_bf16 v[200:203], v[160:163], v[148:151], v[200:203]
    ds_read_b64_tr_b16 v[178:179], v11 offset:34816
    s_waitcnt lgkmcnt(4)
    v_mfma_f32_16x16x32_bf16 v[196:199], v[164:167], v[144:147], v[196:199]
    ds_read_b64_tr_b16 v[180:181], v12 offset:32768
    ds_read_b64_tr_b16 v[182:183], v12 offset:34816
    v_mfma_f32_16x16x32_bf16 v[204:207], v[164:167], v[148:151], v[204:207]
    ds_read_b64_tr_b16 v[184:185], v13 offset:32768
    s_waitcnt lgkmcnt(5)
    v_mfma_f32_16x16x32_bf16 v[208:211], v[168:171], v[144:147], v[208:211]
    ds_read_b64_tr_b16 v[186:187], v13 offset:34816
    v_mfma_f32_16x16x32_bf16 v[216:219], v[168:171], v[148:151], v[216:219]
    s_add_u32 s6, s3, 6
    s_sub_u32 s7, s6, 6
    s_cmp_ge_u32 s6, 7
    s_cselect_b32 s6, s7, s6
    s_mul_i32 s7, s6, s95
    s_lshl_b32 s7, s7, 2
    s_lshl_b32 s6, s6, 7
    s_add_u32 m0, s51, 98304
    s_nop 0
    buffer_load_dwordx4 v5, s[8:11], s6 offen lds
    s_add_u32 m0, s51, 106496
    s_add_u32 s52, s6, 57344
    buffer_load_dwordx4 v5, s[8:11], s52 offen lds
    s_waitcnt lgkmcnt(4)
    v_mfma_f32_16x16x32_bf16 v[212:215], v[176:179], v[144:147], v[212:215]
    ds_read_b128 v[152:155], v17 offset:16384
    v_mfma_f32_16x16x32_bf16 v[220:223], v[176:179], v[148:151], v[220:223]
    ds_read_b128 v[156:159], v17 offset:18432
    ds_read_b64_tr_b16 v[160:161], v8 offset:49152
    s_waitcnt lgkmcnt(5)
    v_mfma_f32_16x16x32_bf16 v[224:227], v[180:183], v[144:147], v[224:227]
    ds_read_b64_tr_b16 v[162:163], v8 offset:51200
    ds_read_b64_tr_b16 v[164:165], v9 offset:49152
    v_mfma_f32_16x16x32_bf16 v[232:235], v[180:183], v[148:151], v[232:235]
    ds_read_b64_tr_b16 v[166:167], v9 offset:51200
    s_waitcnt lgkmcnt(6)
    v_mfma_f32_16x16x32_bf16 v[228:231], v[184:187], v[144:147], v[228:231]
    ds_read_b64_tr_b16 v[168:169], v10 offset:49152
    ds_read_b64_tr_b16 v[170:171], v10 offset:51200
    v_mfma_f32_16x16x32_bf16 v[236:239], v[184:187], v[148:151], v[236:239]
    s_add_u32 m0, s51, 0
    s_mov_b64 exec, s[56:57]
    buffer_load_dwordx4 v4, s[12:15], s7 offen lds
    s_mov_b64 exec, -1
    s_add_u32 s7, s7, s95
    s_add_u32 m0, s51, 8192
    s_mov_b64 exec, s[56:57]
    buffer_load_dwordx4 v4, s[12:15], s7 offen lds
    s_mov_b64 exec, -1
    s_add_u32 s7, s7, s95
    s_waitcnt lgkmcnt(4)
    v_mfma_f32_16x16x32_bf16 v[192:195], v[160:163], v[152:155], v[192:195]
    ds_read_b64_tr_b16 v[176:177], v11 offset:49152
    v_mfma_f32_16x16x32_bf16 v[200:203], v[160:163], v[156:159], v[200:203]
    ds_read_b64_tr_b16 v[178:179], v11 offset:51200
    s_waitcnt lgkmcnt(4)
    v_mfma_f32_16x16x32_bf16 v[196:199], v[164:167], v[152:155], v[196:199]
    ds_read_b64_tr_b16 v[180:181], v12 offset:49152
    ds_read_b64_tr_b16 v[182:183], v12 offset:51200
    v_mfma_f32_16x16x32_bf16 v[204:207], v[164:167], v[156:159], v[204:207]
    ds_read_b64_tr_b16 v[184:185], v13 offset:49152
    s_waitcnt lgkmcnt(5)
    v_mfma_f32_16x16x32_bf16 v[208:211], v[168:171], v[152:155], v[208:211]
    ds_read_b64_tr_b16 v[186:187], v13 offset:51200
    v_mfma_f32_16x16x32_bf16 v[216:219], v[168:171], v[156:159], v[216:219]
    s_add_u32 m0, s51, 16384
    s_mov_b64 exec, s[56:57]
    buffer_load_dwordx4 v4, s[12:15], s7 offen lds
    s_mov_b64 exec, -1
    s_add_u32 s7, s7, s95
    s_add_u32 m0, s51, 24576
    s_mov_b64 exec, s[56:57]
    buffer_load_dwordx4 v4, s[12:15], s7 offen lds
    s_mov_b64 exec, -1
    s_waitcnt vmcnt(6)
    ds_read_b64_tr_b16 v[24:25], v140 offset:49152
    ds_read_b64_tr_b16 v[26:27], v140 offset:50176
    ds_read_b64_tr_b16 v[28:29], v141 offset:49152
    ds_read_b64_tr_b16 v[30:31], v141 offset:50176
    s_waitcnt lgkmcnt(0)
    v_mfma_f32_16x16x32_bf16 v[212:215], v[176:179], v[152:155], v[212:215]
    v_xor_b32 v8, 0x10000, v8
    v_xor_b32 v9, 0x10000, v9
    v_xor_b32 v10, 0x10000, v10
    v_xor_b32 v11, 0x10000, v11
    v_xor_b32 v12, 0x10000, v12
    v_xor_b32 v13, 0x10000, v13
    s_barrier
    v_mfma_f32_16x16x32_bf16 v[220:223], v[176:179], v[156:159], v[220:223]
    ds_read_b128 v[144:147], v16 offset:32768
    ds_read_b128 v[148:151], v16 offset:34816
    v_mfma_f32_16x16x32_bf16 v[224:227], v[180:183], v[152:155], v[224:227]
    ds_read_b64_tr_b16 v[160:161], v8 offset:0
    ds_read_b64_tr_b16 v[162:163], v8 offset:2048
    v_mfma_f32_16x16x32_bf16 v[232:235], v[180:183], v[156:159], v[232:235]
    ds_read_b64_tr_b16 v[164:165], v9 offset:0
    ds_read_b64_tr_b16 v[166:167], v9 offset:2048
    v_mfma_f32_16x16x32_bf16 v[228:231], v[184:187], v[152:155], v[228:231]
    ds_read_b64_tr_b16 v[168:169], v10 offset:0
    ds_read_b64_tr_b16 v[170:171], v10 offset:2048
    v_mfma_f32_16x16x32_bf16 v[236:239], v[184:187], v[156:159], v[236:239]
    s_add_u32 m0, s63, 49152
    s_add_u32 s52, s60, 14336
    buffer_load_dwordx4 v6, s[20:23], s52 offen lds
    s_add_u32 m0, s63, 50176
    s_add_u32 s52, s60, 21504
    buffer_load_dwordx4 v6, s[20:23], s52 offen lds
    s_waitcnt lgkmcnt(4)
    v_mfma_f32_16x16x32_bf16 v[192:195], v[160:163], v[144:147], v[192:195]
    ds_read_b64_tr_b16 v[176:177], v11 offset:0
    v_mfma_f32_16x16x32_bf16 v[200:203], v[160:163], v[148:151], v[200:203]
    ds_read_b64_tr_b16 v[178:179], v11 offset:2048
    s_waitcnt lgkmcnt(4)
    v_mfma_f32_16x16x32_bf16 v[196:199], v[164:167], v[144:147], v[196:199]
    ds_read_b64_tr_b16 v[180:181], v12 offset:0
    ds_read_b64_tr_b16 v[182:183], v12 offset:2048
    v_mfma_f32_16x16x32_bf16 v[204:207], v[164:167], v[148:151], v[204:207]
    ds_read_b64_tr_b16 v[184:185], v13 offset:0
    s_waitcnt lgkmcnt(5)
    v_mfma_f32_16x16x32_bf16 v[208:211], v[168:171], v[144:147], v[208:211]
    ds_read_b64_tr_b16 v[186:187], v13 offset:2048
    v_mfma_f32_16x16x32_bf16 v[216:219], v[168:171], v[148:151], v[216:219]
    s_add_u32 m0, s62, 32768
    s_add_u32 s52, s60, 43008
    buffer_load_dwordx4 v6, s[20:23], s52 offen lds
    s_add_u32 m0, s62, 33792
    s_add_u32 s52, s60, 50176
    buffer_load_dwordx4 v6, s[20:23], s52 offen lds
    s_waitcnt lgkmcnt(4)
    v_mfma_f32_16x16x32_bf16 v[212:215], v[176:179], v[144:147], v[212:215]
    ds_read_b128 v[152:155], v17 offset:32768
    v_mfma_f32_16x16x32_bf16 v[220:223], v[176:179], v[148:151], v[220:223]
    ds_read_b128 v[156:159], v17 offset:34816
    ds_read_b64_tr_b16 v[160:161], v8 offset:16384
    s_waitcnt lgkmcnt(5)
    v_mfma_f32_16x16x32_bf16 v[224:227], v[180:183], v[144:147], v[224:227]
    ds_read_b64_tr_b16 v[162:163], v8 offset:18432
    ds_read_b64_tr_b16 v[164:165], v9 offset:16384
    v_mfma_f32_16x16x32_bf16 v[232:235], v[180:183], v[148:151], v[232:235]
    ds_read_b64_tr_b16 v[166:167], v9 offset:18432
    s_waitcnt lgkmcnt(6)
    v_mfma_f32_16x16x32_bf16 v[228:231], v[184:187], v[144:147], v[228:231]
    ds_read_b64_tr_b16 v[168:169], v10 offset:16384
    ds_read_b64_tr_b16 v[170:171], v10 offset:18432
    v_mfma_f32_16x16x32_bf16 v[236:239], v[184:187], v[148:151], v[236:239]
    s_add_u32 m0, s62, 34816
    s_add_u32 s52, s60, 57344
    buffer_load_dwordx4 v6, s[20:23], s52 offen lds
    s_add_u32 m0, s62, 35840
    s_add_u32 s52, s60, 64512
    buffer_load_dwordx4 v6, s[20:23], s52 offen lds
    s_waitcnt lgkmcnt(4)
    v_mfma_f32_16x16x32_bf16 v[192:195], v[160:163], v[152:155], v[192:195]
    ds_read_b64_tr_b16 v[176:177], v11 offset:16384
    v_mfma_f32_16x16x32_bf16 v[200:203], v[160:163], v[156:159], v[200:203]
    ds_read_b64_tr_b16 v[178:179], v11 offset:18432
    s_waitcnt lgkmcnt(4)
    v_mfma_f32_16x16x32_bf16 v[196:199], v[164:167], v[152:155], v[196:199]
    ds_read_b64_tr_b16 v[180:181], v12 offset:16384
    ds_read_b64_tr_b16 v[182:183], v12 offset:18432
    v_mfma_f32_16x16x32_bf16 v[204:207], v[164:167], v[156:159], v[204:207]
    ds_read_b64_tr_b16 v[184:185], v13 offset:16384
    s_waitcnt lgkmcnt(5)
    v_mfma_f32_16x16x32_bf16 v[208:211], v[168:171], v[152:155], v[208:211]
    ds_read_b64_tr_b16 v[186:187], v13 offset:18432
    v_mfma_f32_16x16x32_bf16 v[216:219], v[168:171], v[156:159], v[216:219]
    s_add_u32 m0, s63, 16384
    s_add_u32 s52, s60, 71680
    buffer_load_dwordx4 v6, s[20:23], s52 offen lds
    s_add_u32 m0, s63, 17408
    s_add_u32 s52, s60, 78848
    buffer_load_dwordx4 v6, s[20:23], s52 offen lds
    s_waitcnt vmcnt(6)
    ds_read_b64_tr_b16 v[32:33], v140 offset:49152
    ds_read_b64_tr_b16 v[34:35], v140 offset:50176
    ds_read_b64_tr_b16 v[36:37], v141 offset:49152
    ds_read_b64_tr_b16 v[38:39], v141 offset:50176
    s_waitcnt lgkmcnt(0)
    v_mfma_f32_16x16x32_bf16 v[212:215], v[176:179], v[152:155], v[212:215]
    v_xor_b32 v8, 0x10000, v8
    v_xor_b32 v9, 0x10000, v9
    v_xor_b32 v10, 0x10000, v10
    v_xor_b32 v11, 0x10000, v11
    v_xor_b32 v12, 0x10000, v12
    v_xor_b32 v13, 0x10000, v13
    s_barrier
    v_mfma_f32_16x16x32_bf16 v[220:223], v[176:179], v[156:159], v[220:223]
    ds_read_b128 v[144:147], v16 offset:0
    ds_read_b128 v[148:151], v16 offset:2048
    v_mfma_f32_16x16x32_bf16 v[224:227], v[180:183], v[152:155], v[224:227]
    ds_read_b64_tr_b16 v[160:161], v8 offset:0
    ds_read_b64_tr_b16 v[162:163], v8 offset:2048
    v_mfma_f32_16x16x32_bf16 v[232:235], v[180:183], v[156:159], v[232:235]
    ds_read_b64_tr_b16 v[164:165], v9 offset:0
    ds_read_b64_tr_b16 v[166:167], v9 offset:2048
    v_mfma_f32_16x16x32_bf16 v[228:231], v[184:187], v[152:155], v[228:231]
    ds_read_b64_tr_b16 v[168:169], v10 offset:0
    ds_read_b64_tr_b16 v[170:171], v10 offset:2048
    v_mfma_f32_16x16x32_bf16 v[236:239], v[184:187], v[156:159], v[236:239]
    s_add_u32 m0, s63, 49152
    s_add_u32 s52, s60, 28672
    buffer_load_dwordx4 v6, s[20:23], s52 offen lds
    s_add_u32 m0, s63, 50176
    s_add_u32 s52, s60, 35840
    buffer_load_dwordx4 v6, s[20:23], s52 offen lds
    s_waitcnt lgkmcnt(4)
    v_mfma_f32_16x16x32_bf16 v[192:195], v[160:163], v[144:147], v[192:195]
    ds_read_b64_tr_b16 v[176:177], v11 offset:0
    v_mfma_f32_16x16x32_bf16 v[200:203], v[160:163], v[148:151], v[200:203]
    ds_read_b64_tr_b16 v[178:179], v11 offset:2048
    s_waitcnt lgkmcnt(4)
    v_mfma_f32_16x16x32_bf16 v[196:199], v[164:167], v[144:147], v[196:199]
    ds_read_b64_tr_b16 v[180:181], v12 offset:0
    ds_read_b64_tr_b16 v[182:183], v12 offset:2048
    v_mfma_f32_16x16x32_bf16 v[204:207], v[164:167], v[148:151], v[204:207]
    ds_read_b64_tr_b16 v[184:185], v13 offset:0
    s_waitcnt lgkmcnt(5)
    v_mfma_f32_16x16x32_bf16 v[208:211], v[168:171], v[144:147], v[208:211]
    ds_read_b64_tr_b16 v[186:187], v13 offset:2048
    v_mfma_f32_16x16x32_bf16 v[216:219], v[168:171], v[148:151], v[216:219]
    s_add_u32 m0, s62, 65536
    s_add_u32 s52, s60, 86016
    buffer_load_dwordx4 v6, s[20:23], s52 offen lds
    s_add_u32 m0, s62, 66560
    s_add_u32 s52, s60, 93184
    buffer_load_dwordx4 v6, s[20:23], s52 offen lds
    s_waitcnt lgkmcnt(4)
    v_mfma_f32_16x16x32_bf16 v[212:215], v[176:179], v[144:147], v[212:215]
    ds_read_b128 v[152:155], v17 offset:0
    ds_read_b128 v[156:159], v17 offset:2048
    v_mfma_f32_16x16x32_bf16 v[220:223], v[176:179], v[148:151], v[220:223]
    ds_read_b64_tr_b16 v[160:161], v8 offset:16384
    ds_read_b64_tr_b16 v[162:163], v8 offset:18432
    ds_read_b64_tr_b16 v[164:165], v9 offset:16384
    s_waitcnt lgkmcnt(7)
    v_mfma_f32_16x16x32_bf16 v[224:227], v[180:183], v[144:147], v[224:227]
    ds_read_b64_tr_b16 v[166:167], v9 offset:18432
    ds_read_b64_tr_b16 v[168:169], v10 offset:16384
    ds_read_b64_tr_b16 v[170:171], v10 offset:18432
    v_mfma_f32_16x16x32_bf16 v[232:235], v[180:183], v[148:151], v[232:235]
    s_add_u32 m0, s62, 67584
    s_add_u32 s52, s60, 100352
    buffer_load_dwordx4 v6, s[20:23], s52 offen lds
    s_add_u32 m0, s62, 68608
    s_add_u32 s52, s60, 107520
    buffer_load_dwordx4 v6, s[20:23], s52 offen lds
    s_waitcnt vmcnt(10)
    s_waitcnt vmcnt(8)
    s_waitcnt vmcnt(6)
    s_waitcnt lgkmcnt(8)
    v_mfma_f32_16x16x32_bf16 v[228:231], v[184:187], v[144:147], v[228:231]
    ds_read_b64_tr_b16 v[48:49], v136 offset:32768
    ds_read_b64_tr_b16 v[50:51], v136 offset:33792
    ds_read_b64_tr_b16 v[52:53], v137 offset:32768
    v_mfma_f32_16x16x32_bf16 v[236:239], v[184:187], v[148:151], v[236:239]
    ds_read_b64_tr_b16 v[54:55], v137 offset:33792
    ds_read_b64_tr_b16 v[56:57], v136 offset:34816
    ds_read_b64_tr_b16 v[58:59], v136 offset:35840
    s_waitcnt lgkmcnt(10)
    v_mfma_f32_16x16x32_bf16 v[192:195], v[160:163], v[152:155], v[192:195]
    ds_read_b64_tr_b16 v[176:177], v11 offset:16384
    ds_read_b64_tr_b16 v[178:179], v11 offset:18432
    v_mfma_f32_16x16x32_bf16 v[200:203], v[160:163], v[156:159], v[200:203]
    ds_read_b64_tr_b16 v[180:181], v12 offset:16384
    ds_read_b64_tr_b16 v[182:183], v12 offset:18432
    s_waitcnt lgkmcnt(12)
    v_mfma_f32_16x16x32_bf16 v[196:199], v[164:167], v[152:155], v[196:199]
    ds_read_b64_tr_b16 v[184:185], v13 offset:16384
    ds_read_b64_tr_b16 v[186:187], v13 offset:18432
    v_mfma_f32_16x16x32_bf16 v[204:207], v[164:167], v[156:159], v[204:207]
    ds_read_b64_tr_b16 v[60:61], v137 offset:34816
    ds_read_b64_tr_b16 v[62:63], v137 offset:35840
    s_waitcnt lgkmcnt(14)
    v_mfma_f32_16x16x32_bf16 v[208:211], v[168:171], v[152:155], v[208:211]
    ds_read_b64_tr_b16 v[64:65], v140 offset:16384
    ds_read_b64_tr_b16 v[66:67], v140 offset:17408
    v_mfma_f32_16x16x32_bf16 v[216:219], v[168:171], v[156:159], v[216:219]
    ds_read_b64_tr_b16 v[68:69], v141 offset:16384
    ds_read_b64_tr_b16 v[70:71], v141 offset:17408
    s_waitcnt vmcnt(4)
    ds_read_b64_tr_b16 v[40:41], v140 offset:49152
    ds_read_b64_tr_b16 v[42:43], v140 offset:50176
    ds_read_b64_tr_b16 v[44:45], v141 offset:49152
    ds_read_b64_tr_b16 v[46:47], v141 offset:50176
    s_waitcnt lgkmcnt(0)
    v_mfma_f32_16x16x32_bf16 v[212:215], v[176:179], v[152:155], v[212:215]
    s_barrier
    v_mfma_f32_16x16x32_bf16 v[220:223], v[176:179], v[156:159], v[220:223]
    v_mfma_f32_16x16x32_bf16 v[224:227], v[180:183], v[152:155], v[224:227]
    v_mfma_f32_16x16x32_bf16 v[232:235], v[180:183], v[156:159], v[232:235]
    v_mfma_f32_16x16x32_bf16 v[228:231], v[184:187], v[152:155], v[228:231]
    v_mfma_f32_16x16x32_bf16 v[236:239], v[184:187], v[156:159], v[236:239]
    s_cmp_ge_u32 s44, 4
    s_cbranch_scc1 L_KV1
    v_cvt_pk_bf16_f32 v88, v192, v193
    v_cvt_pk_bf16_f32 v92, v200, v201
    v_cvt_pk_bf16_f32 v89, v194, v195
    v_cvt_pk_bf16_f32 v93, v202, v203
    v_cvt_pk_bf16_f32 v90, v196, v197
    v_cvt_pk_bf16_f32 v94, v204, v205
    v_cvt_pk_bf16_f32 v91, v198, v199
    v_cvt_pk_bf16_f32 v95, v206, v207
    v_permlane16_swap_b32 v88, v92
    v_permlane16_swap_b32 v89, v93
    v_permlane16_swap_b32 v90, v94
    v_permlane16_swap_b32 v91, v95
    s_nop 1
    v_mfma_f32_32x32x16_bf16 v[144:159], v[112:115], v[88:91], 0
    v_mfma_f32_32x32x16_bf16 v[144:159], v[116:119], v[92:95], v[144:159]
    v_cvt_pk_bf16_f32 v96, v208, v209
    v_cvt_pk_bf16_f32 v100, v216, v217
    v_cvt_pk_bf16_f32 v97, v210, v211
    v_cvt_pk_bf16_f32 v101, v218, v219
    v_cvt_pk_bf16_f32 v98, v212, v213
    v_cvt_pk_bf16_f32 v102, v220, v221
    v_cvt_pk_bf16_f32 v99, v214, v215
    v_cvt_pk_bf16_f32 v103, v222, v223
    v_permlane16_swap_b32 v96, v100
    v_permlane16_swap_b32 v97, v101
    v_permlane16_swap_b32 v98, v102
    v_permlane16_swap_b32 v99, v103
    s_nop 1
    v_mfma_f32_32x32x16_bf16 v[160:175], v[120:123], v[96:99], 0
    v_mfma_f32_32x32x16_bf16 v[160:175], v[124:127], v[100:103], v[160:175]
    v_cvt_pk_bf16_f32 v104, v224, v225
    v_cvt_pk_bf16_f32 v108, v232, v233
    v_cvt_pk_bf16_f32 v105, v226, v227
    v_cvt_pk_bf16_f32 v109, v234, v235
    v_cvt_pk_bf16_f32 v106, v228, v229
    v_cvt_pk_bf16_f32 v110, v236, v237
    v_cvt_pk_bf16_f32 v107, v230, v231
    v_cvt_pk_bf16_f32 v111, v238, v239
    v_permlane16_swap_b32 v104, v108
    v_permlane16_swap_b32 v105, v109
    v_permlane16_swap_b32 v106, v110
    v_permlane16_swap_b32 v107, v111
    s_nop 1
    v_mfma_f32_32x32x16_bf16 v[176:191], v[128:131], v[104:107], 0
    v_mfma_f32_32x32x16_bf16 v[176:191], v[132:135], v[108:111], v[176:191]
    v_max_f32 v220, v144, v145
    v_max_f32 v116, v160, v161
    v_max_f32 v221, -v144, -v145
    v_max_f32 v117, -v160, -v161
    v_max3_f32 v220, v220, v146, v147
    v_max3_f32 v116, v116, v162, v163
    v_max3_f32 v221, v221, -v146, -v147
    v_max3_f32 v117, v117, -v162, -v163
    v_max3_f32 v220, v220, v148, v149
    v_max3_f32 v116, v116, v164, v165
    v_max3_f32 v221, v221, -v148, -v149
    v_max3_f32 v117, v117, -v164, -v165
    v_max3_f32 v220, v220, v150, v152
    v_max3_f32 v116, v116, v166, v168
    v_max3_f32 v221, v221, -v150, -v152
    v_max3_f32 v117, v117, -v166, -v168
    v_max3_f32 v220, v220, v153, v154
    v_max3_f32 v116, v116, v169, v170
    v_max3_f32 v221, v221, -v153, -v154
    v_max3_f32 v117, v117, -v169, -v170
    v_max3_f32 v220, v220, v155, v156
    v_max3_f32 v116, v116, v171, v172
    v_max3_f32 v221, v221, -v155, -v156
    v_max3_f32 v117, v117, -v171, -v172
    v_max3_f32 v220, v220, v157, v158
    v_max3_f32 v116, v116, v173, v174
    v_max3_f32 v221, v221, -v157, -v158
    v_max3_f32 v117, v117, -v173, -v174
    s_nop 0
    v_permlane32_swap_b32 v220, v221
    v_permlane32_swap_b32 v116, v117
    v_max_f32 v220, v220, v221
    v_max_f32 v116, v116, v117
    v_mul_f32 v220, s43, v220
    v_mul_f32 v116, s43, v116
    v_mov_b32 v221, v220
    v_mov_b32 v117, v116
    s_nop 0
    v_permlane32_swap_b32 v220, v221
    v_permlane32_swap_b32 v116, v117
    v_pk_fma_f32 v[192:193], v[144:145], s[42:43], v[220:221] op_sel:[0,0,0] op_sel_hi:[0,1,1]
    v_pk_fma_f32 v[88:89], v[160:161], s[42:43], v[116:117] op_sel:[0,0,0] op_sel_hi:[0,1,1]
    v_pk_fma_f32 v[194:195], v[144:145], s[42:43], v[220:221] op_sel:[1,0,0] op_sel_hi:[1,1,1]
    v_pk_fma_f32 v[90:91], v[160:161], s[42:43], v[116:117] op_sel:[1,0,0] op_sel_hi:[1,1,1]
    v_pk_fma_f32 v[196:197], v[146:147], s[42:43], v[220:221] op_sel:[0,0,0] op_sel_hi:[0,1,1]
    v_pk_fma_f32 v[92:93], v[162:163], s[42:43], v[116:117] op_sel:[0,0,0] op_sel_hi:[0,1,1]
    v_pk_fma_f32 v[198:199], v[146:147], s[42:43], v[220:221] op_sel:[1,0,0] op_sel_hi:[1,1,1]
    v_pk_fma_f32 v[94:95], v[162:163], s[42:43], v[116:117] op_sel:[1,0,0] op_sel_hi:[1,1,1]
    v_pk_fma_f32 v[200:201], v[148:149], s[42:43], v[220:221] op_sel:[0,0,0] op_sel_hi:[0,1,1]
    v_pk_fma_f32 v[96:97], v[164:165], s[42:43], v[116:117] op_sel:[0,0,0] op_sel_hi:[0,1,1]
    v_pk_fma_f32 v[202:203], v[148:149], s[42:43], v[220:221] op_sel:[1,0,0] op_sel_hi:[1,1,1]
    v_pk_fma_f32 v[98:99], v[164:165], s[42:43], v[116:117] op_sel:[1,0,0] op_sel_hi:[1,1,1]
    v_pk_fma_f32 v[204:205], v[150:151], s[42:43], v[220:221] op_sel:[0,0,0] op_sel_hi:[0,1,1]
    v_pk_fma_f32 v[100:101], v[166:167], s[42:43], v[116:117] op_sel:[0,0,0] op_sel_hi:[0,1,1]
    v_pk_fma_f32 v[206:207], v[152:153], s[42:43], v[220:221] op_sel:[0,0,0] op_sel_hi:[0,1,1]
    v_pk_fma_f32 v[102:103], v[168:169], s[42:43], v[116:117] op_sel:[0,0,0] op_sel_hi:[0,1,1]
    v_pk_fma_f32 v[208:209], v[152:153], s[42:43], v[220:221] op_sel:[1,0,0] op_sel_hi:[1,1,1]
    v_pk_fma_f32 v[104:105], v[168:169], s[42:43], v[116:117] op_sel:[1,0,0] op_sel_hi:[1,1,1]
    v_pk_fma_f32 v[210:211], v[154:155], s[42:43], v[220:221] op_sel:[0,0,0] op_sel_hi:[0,1,1]
    v_pk_fma_f32 v[106:107], v[170:171], s[42:43], v[116:117] op_sel:[0,0,0] op_sel_hi:[0,1,1]
    v_pk_fma_f32 v[212:213], v[154:155], s[42:43], v[220:221] op_sel:[1,0,0] op_sel_hi:[1,1,1]
    v_pk_fma_f32 v[108:109], v[170:171], s[42:43], v[116:117] op_sel:[1,0,0] op_sel_hi:[1,1,1]
    v_pk_fma_f32 v[214:215], v[156:157], s[42:43], v[220:221] op_sel:[0,0,0] op_sel_hi:[0,1,1]
    v_pk_fma_f32 v[110:111], v[172:173], s[42:43], v[116:117] op_sel:[0,0,0] op_sel_hi:[0,1,1]
    v_pk_fma_f32 v[216:217], v[156:157], s[42:43], v[220:221] op_sel:[1,0,0] op_sel_hi:[1,1,1]
    v_pk_fma_f32 v[112:113], v[172:173], s[42:43], v[116:117] op_sel:[1,0,0] op_sel_hi:[1,1,1]
    v_pk_fma_f32 v[218:219], v[158:159], s[42:43], v[220:221] op_sel:[0,0,0] op_sel_hi:[0,1,1]
    v_pk_fma_f32 v[114:115], v[174:175], s[42:43], v[116:117] op_sel:[0,0,0] op_sel_hi:[0,1,1]
    v_exp_f32 v192, v192
    v_exp_f32 v88, v88
    v_exp_f32 v193, v193
    v_exp_f32 v89, v89
    v_exp_f32 v194, v194
    v_exp_f32 v90, v90
    v_exp_f32 v195, v195
    v_exp_f32 v91, v91
    v_exp_f32 v196, v196
    v_exp_f32 v92, v92
    v_exp_f32 v197, v197
    v_exp_f32 v93, v93
    v_exp_f32 v198, v198
    v_exp_f32 v94, v94
    v_exp_f32 v199, v199
    v_exp_f32 v95, v95
    v_exp_f32 v200, v200
    v_exp_f32 v96, v96
    v_exp_f32 v201, v201
    v_exp_f32 v97, v97
    v_exp_f32 v202, v202
    v_exp_f32 v98, v98
    v_exp_f32 v203, v203
    v_exp_f32 v99, v99
    v_exp_f32 v204, v204
    v_exp_f32 v100, v100
    v_exp_f32 v205, v205
    v_exp_f32 v101, v101
    v_exp_f32 v206, v206
    v_exp_f32 v102, v102
    v_exp_f32 v207, v207
    v_exp_f32 v103, v103
    v_exp_f32 v208, v208
    v_exp_f32 v104, v104
    v_exp_f32 v209, v209
    v_exp_f32 v105, v105
    v_exp_f32 v210, v210
    v_exp_f32 v106, v106
    v_exp_f32 v211, v211
    v_exp_f32 v107, v107
    v_exp_f32 v212, v212
    v_exp_f32 v108, v108
    v_exp_f32 v213, v213
    v_exp_f32 v109, v109
    v_exp_f32 v214, v214
    v_exp_f32 v110, v110
    v_exp_f32 v215, v215
    v_exp_f32 v111, v111
    v_exp_f32 v216, v216
    v_exp_f32 v112, v112
    v_exp_f32 v217, v217
    v_exp_f32 v113, v113
    v_exp_f32 v218, v218
    v_exp_f32 v114, v114
    v_exp_f32 v219, v219
    v_exp_f32 v115, v115
    v_pk_add_f32 v[220:221], v[192:193], v[194:195]
    v_pk_add_f32 v[116:117], v[88:89], v[90:91]
    v_pk_add_f32 v[222:223], v[196:197], v[198:199]
    v_pk_add_f32 v[118:119], v[92:93], v[94:95]
    v_pk_add_f32 v[220:221], v[220:221], v[200:201]
    v_pk_add_f32 v[116:117], v[116:117], v[96:97]
    v_pk_add_f32 v[222:223], v[222:223], v[202:203]
    v_pk_add_f32 v[118:119], v[118:119], v[98:99]
    v_pk_add_f32 v[220:221], v[220:221], v[204:205]
    v_pk_add_f32 v[116:117], v[116:117], v[100:101]
    v_pk_add_f32 v[222:223], v[222:223], v[206:207]
    v_pk_add_f32 v[118:119], v[118:119], v[102:103]
    v_pk_add_f32 v[220:221], v[220:221], v[208:209]
    v_pk_add_f32 v[116:117], v[116:117], v[104:105]
    v_pk_add_f32 v[222:223], v[222:223], v[210:211]
    v_pk_add_f32 v[118:119], v[118:119], v[106:107]
    v_pk_add_f32 v[220:221], v[220:221], v[212:213]
    v_pk_add_f32 v[116:117], v[116:117], v[108:109]
    v_pk_add_f32 v[222:223], v[222:223], v[214:215]
    v_pk_add_f32 v[118:119], v[118:119], v[110:111]
    v_pk_add_f32 v[220:221], v[220:221], v[216:217]
    v_pk_add_f32 v[116:117], v[116:117], v[112:113]
    v_pk_add_f32 v[222:223], v[222:223], v[218:219]
    v_pk_add_f32 v[118:119], v[118:119], v[114:115]
    v_pk_add_f32 v[220:221], v[220:221], v[222:223]
    v_pk_add_f32 v[116:117], v[116:117], v[118:119]
    s_nop 0
    v_permlane32_swap_b32 v220, v221
    v_permlane32_swap_b32 v116, v117
    v_add_f32 v220, v220, v221
    v_add_f32 v116, v116, v117
    v_rcp_f32 v220, v220
    v_rcp_f32 v116, v116
    v_mov_b32 v221, v220
    v_mov_b32 v117, v116
    s_nop 0
    v_permlane32_swap_b32 v220, v221
    v_permlane32_swap_b32 v116, v117
    v_pk_mul_f32 v[192:193], v[192:193], v[220:221]
    v_pk_mul_f32 v[88:89], v[88:89], v[116:117]
    v_pk_mul_f32 v[194:195], v[194:195], v[220:221]
    v_pk_mul_f32 v[90:91], v[90:91], v[116:117]
    v_pk_mul_f32 v[196:197], v[196:197], v[220:221]
    v_pk_mul_f32 v[92:93], v[92:93], v[116:117]
    v_pk_mul_f32 v[198:199], v[198:199], v[220:221]
    v_pk_mul_f32 v[94:95], v[94:95], v[116:117]
    v_pk_mul_f32 v[200:201], v[200:201], v[220:221]
    v_pk_mul_f32 v[96:97], v[96:97], v[116:117]
    v_pk_mul_f32 v[202:203], v[202:203], v[220:221]
    v_pk_mul_f32 v[98:99], v[98:99], v[116:117]
    v_pk_mul_f32 v[204:205], v[204:205], v[220:221]
    v_pk_mul_f32 v[100:101], v[100:101], v[116:117]
    v_pk_mul_f32 v[206:207], v[206:207], v[220:221]
    v_pk_mul_f32 v[102:103], v[102:103], v[116:117]
    v_pk_mul_f32 v[208:209], v[208:209], v[220:221]
    v_pk_mul_f32 v[104:105], v[104:105], v[116:117]
    v_pk_mul_f32 v[210:211], v[210:211], v[220:221]
    v_pk_mul_f32 v[106:107], v[106:107], v[116:117]
    v_pk_mul_f32 v[212:213], v[212:213], v[220:221]
    v_pk_mul_f32 v[108:109], v[108:109], v[116:117]
    v_pk_mul_f32 v[214:215], v[214:215], v[220:221]
    v_pk_mul_f32 v[110:111], v[110:111], v[116:117]
    v_pk_mul_f32 v[216:217], v[216:217], v[220:221]
    v_pk_mul_f32 v[112:113], v[112:113], v[116:117]
    v_pk_mul_f32 v[218:219], v[218:219], v[220:221]
    v_pk_mul_f32 v[114:115], v[114:115], v[116:117]
    v_cvt_pk_bf16_f32 v224, v192, v194
    v_cvt_pk_bf16_f32 v144, v88, v90
    v_cvt_pk_bf16_f32 v225, v196, v198
    v_cvt_pk_bf16_f32 v145, v92, v94
    v_cvt_pk_bf16_f32 v226, v200, v202
    v_cvt_pk_bf16_f32 v146, v96, v98
    v_cvt_pk_bf16_f32 v227, v204, 0
    v_cvt_pk_bf16_f32 v147, v100, 0
    v_cvt_pk_bf16_f32 v228, v206, v208
    v_cvt_pk_bf16_f32 v148, v102, v104
    v_cvt_pk_bf16_f32 v229, v210, v212
    v_cvt_pk_bf16_f32 v149, v106, v108
    v_cvt_pk_bf16_f32 v230, v214, v216
    v_cvt_pk_bf16_f32 v150, v110, v112
    v_cvt_pk_bf16_f32 v231, v218, 0
    v_cvt_pk_bf16_f32 v151, v114, 0
    v_cvt_pk_bf16_f32 v232, v193, v195
    v_cvt_pk_bf16_f32 v152, v89, v91
    v_cvt_pk_bf16_f32 v233, v197, v199
    v_cvt_pk_bf16_f32 v153, v93, v95
    v_cvt_pk_bf16_f32 v234, v201, v203
    v_cvt_pk_bf16_f32 v154, v97, v99
    v_cvt_pk_bf16_f32 v235, v205, 0
    v_cvt_pk_bf16_f32 v155, v101, 0
    v_cvt_pk_bf16_f32 v236, v207, v209
    v_cvt_pk_bf16_f32 v156, v103, v105
    v_cvt_pk_bf16_f32 v237, v211, v213
    v_cvt_pk_bf16_f32 v157, v107, v109
    v_cvt_pk_bf16_f32 v238, v215, v217
    v_cvt_pk_bf16_f32 v158, v111, v113
    v_cvt_pk_bf16_f32 v239, v219, 0
    v_cvt_pk_bf16_f32 v159, v115, 0
    ds_write_b64 v240, v[224:225] offset:0
    ds_write_b64 v240, v[144:145] offset:16384
    ds_write_b64 v241, v[226:227] offset:0
    ds_write_b64 v241, v[146:147] offset:16384
    ds_write_b64 v242, v[228:229] offset:0
    ds_write_b64 v242, v[148:149] offset:16384
    ds_write_b64 v243, v[230:231] offset:0
    ds_write_b64 v243, v[150:151] offset:16384
    ds_write_b64 v244, v[232:233] offset:0
    ds_write_b64 v244, v[152:153] offset:16384
    ds_write_b64 v245, v[234:235] offset:0
    ds_write_b64 v245, v[154:155] offset:16384
    ds_write_b64 v246, v[236:237] offset:0
    ds_write_b64 v246, v[156:157] offset:16384
    ds_write_b64 v247, v[238:239] offset:0
    ds_write_b64 v247, v[158:159] offset:16384
    v_max_f32_e64 v220, v176, v177
    v_max_f32 v221, -v176, -v177
    v_max3_f32 v220, v220, v178, v179
    v_max3_f32 v221, v221, -v178, -v179
    v_max3_f32 v220, v220, v180, v181
    v_max3_f32 v221, v221, -v180, -v181
    v_max3_f32 v220, v220, v182, v184
    v_max3_f32 v221, v221, -v182, -v184
    v_max3_f32 v220, v220, v185, v186
    v_max3_f32 v221, v221, -v185, -v186
    v_max3_f32 v220, v220, v187, v188
    v_max3_f32 v221, v221, -v187, -v188
    v_max3_f32 v220, v220, v189, v190
    v_max3_f32 v221, v221, -v189, -v190
    s_nop 1
    v_permlane32_swap_b32 v220, v221
    v_max_f32 v220, v220, v221
    v_mul_f32 v220, s43, v220
    v_mov_b32_e64 v221, v220
    s_nop 1
    v_permlane32_swap_b32 v220, v221
    v_pk_fma_f32 v[192:193], v[176:177], s[42:43], v[220:221] op_sel:[0,0,0] op_sel_hi:[0,1,1]
    v_pk_fma_f32 v[194:195], v[176:177], s[42:43], v[220:221] op_sel:[1,0,0] op_sel_hi:[1,1,1]
    v_pk_fma_f32 v[196:197], v[178:179], s[42:43], v[220:221] op_sel:[0,0,0] op_sel_hi:[0,1,1]
    v_pk_fma_f32 v[198:199], v[178:179], s[42:43], v[220:221] op_sel:[1,0,0] op_sel_hi:[1,1,1]
    v_pk_fma_f32 v[200:201], v[180:181], s[42:43], v[220:221] op_sel:[0,0,0] op_sel_hi:[0,1,1]
    v_pk_fma_f32 v[202:203], v[180:181], s[42:43], v[220:221] op_sel:[1,0,0] op_sel_hi:[1,1,1]
    v_pk_fma_f32 v[204:205], v[182:183], s[42:43], v[220:221] op_sel:[0,0,0] op_sel_hi:[0,1,1]
    v_pk_fma_f32 v[206:207], v[184:185], s[42:43], v[220:221] op_sel:[0,0,0] op_sel_hi:[0,1,1]
    v_pk_fma_f32 v[208:209], v[184:185], s[42:43], v[220:221] op_sel:[1,0,0] op_sel_hi:[1,1,1]
    v_pk_fma_f32 v[210:211], v[186:187], s[42:43], v[220:221] op_sel:[0,0,0] op_sel_hi:[0,1,1]
    v_pk_fma_f32 v[212:213], v[186:187], s[42:43], v[220:221] op_sel:[1,0,0] op_sel_hi:[1,1,1]
    v_pk_fma_f32 v[214:215], v[188:189], s[42:43], v[220:221] op_sel:[0,0,0] op_sel_hi:[0,1,1]
    v_pk_fma_f32 v[216:217], v[188:189], s[42:43], v[220:221] op_sel:[1,0,0] op_sel_hi:[1,1,1]
    v_pk_fma_f32 v[218:219], v[190:191], s[42:43], v[220:221] op_sel:[0,0,0] op_sel_hi:[0,1,1]
    v_exp_f32 v192, v192
    v_exp_f32 v193, v193
    v_exp_f32 v194, v194
    v_exp_f32 v195, v195
    v_exp_f32 v196, v196
    v_exp_f32 v197, v197
    v_exp_f32 v198, v198
    v_exp_f32 v199, v199
    v_exp_f32 v200, v200
    v_exp_f32 v201, v201
    v_exp_f32 v202, v202
    v_exp_f32 v203, v203
    v_exp_f32 v204, v204
    v_exp_f32 v205, v205
    v_exp_f32 v206, v206
    v_exp_f32 v207, v207
    v_exp_f32 v208, v208
    v_exp_f32 v209, v209
    v_exp_f32 v210, v210
    v_exp_f32 v211, v211
    v_exp_f32 v212, v212
    v_exp_f32 v213, v213
    v_exp_f32 v214, v214
    v_exp_f32 v215, v215
    v_exp_f32 v216, v216
    v_exp_f32 v217, v217
    v_exp_f32 v218, v218
    v_exp_f32 v219, v219
    v_pk_add_f32 v[220:221], v[192:193], v[194:195]
    v_pk_add_f32 v[222:223], v[196:197], v[198:199]
    v_pk_add_f32 v[220:221], v[220:221], v[200:201]
    v_pk_add_f32 v[222:223], v[222:223], v[202:203]
    v_pk_add_f32 v[220:221], v[220:221], v[204:205]
    v_pk_add_f32 v[222:223], v[222:223], v[206:207]
    v_pk_add_f32 v[220:221], v[220:221], v[208:209]
    v_pk_add_f32 v[222:223], v[222:223], v[210:211]
    v_pk_add_f32 v[220:221], v[220:221], v[212:213]
    v_pk_add_f32 v[222:223], v[222:223], v[214:215]
    v_pk_add_f32 v[220:221], v[220:221], v[216:217]
    v_pk_add_f32 v[222:223], v[222:223], v[218:219]
    v_pk_add_f32 v[220:221], v[220:221], v[222:223]
    s_nop 1
    v_permlane32_swap_b32 v220, v221
    v_add_f32 v220, v220, v221
    v_rcp_f32 v220, v220
    s_nop 0
    v_mov_b32 v221, v220
    s_nop 1
    v_permlane32_swap_b32 v220, v221
    v_pk_mul_f32 v[192:193], v[192:193], v[220:221]
    v_pk_mul_f32 v[194:195], v[194:195], v[220:221]
    v_pk_mul_f32 v[196:197], v[196:197], v[220:221]
    v_pk_mul_f32 v[198:199], v[198:199], v[220:221]
    v_pk_mul_f32 v[200:201], v[200:201], v[220:221]
    v_pk_mul_f32 v[202:203], v[202:203], v[220:221]
    v_pk_mul_f32 v[204:205], v[204:205], v[220:221]
    v_pk_mul_f32 v[206:207], v[206:207], v[220:221]
    v_pk_mul_f32 v[208:209], v[208:209], v[220:221]
    v_pk_mul_f32 v[210:211], v[210:211], v[220:221]
    v_pk_mul_f32 v[212:213], v[212:213], v[220:221]
    v_pk_mul_f32 v[214:215], v[214:215], v[220:221]
    v_pk_mul_f32 v[216:217], v[216:217], v[220:221]
    v_pk_mul_f32 v[218:219], v[218:219], v[220:221]
    v_cvt_pk_bf16_f32 v160, v192, v194
    v_cvt_pk_bf16_f32 v161, v196, v198
    v_cvt_pk_bf16_f32 v162, v200, v202
    v_cvt_pk_bf16_f32 v163, v204, 0
    v_cvt_pk_bf16_f32 v164, v206, v208
    v_cvt_pk_bf16_f32 v165, v210, v212
    v_cvt_pk_bf16_f32 v166, v214, v216
    v_cvt_pk_bf16_f32 v167, v218, 0
    v_cvt_pk_bf16_f32 v168, v193, v195
    v_cvt_pk_bf16_f32 v169, v197, v199
    v_cvt_pk_bf16_f32 v170, v201, v203
    v_cvt_pk_bf16_f32 v171, v205, 0
    v_cvt_pk_bf16_f32 v172, v207, v209
    v_cvt_pk_bf16_f32 v173, v211, v213
    v_cvt_pk_bf16_f32 v174, v215, v217
    v_cvt_pk_bf16_f32 v175, v219, 0
    ds_write_b64 v248, v[160:161] offset:0
    ds_write_b64 v249, v[162:163] offset:0
    ds_write_b64 v250, v[164:165] offset:0
    ds_write_b64 v251, v[166:167] offset:0
    ds_write_b64 v252, v[168:169] offset:0
    ds_write_b64 v253, v[170:171] offset:0
    ds_write_b64 v254, v[172:173] offset:0
    ds_write_b64 v255, v[174:175] offset:0
    s_waitcnt lgkmcnt(0)
L_KV2:
    s_nop 1
    s_barrier
    s_cmp_ge_u32 s44, 6
    s_cbranch_scc1 L_KV3
    ds_read_b64_tr_b16 v[192:193], v20 offset:0
    ds_read_b64_tr_b16 v[144:145], v22 offset:0
    ds_read_b64_tr_b16 v[194:195], v21 offset:512
    ds_read_b64_tr_b16 v[146:147], v23 offset:512
    ds_read_b64_tr_b16 v[196:197], v20 offset:2048
    ds_read_b64_tr_b16 v[148:149], v22 offset:2048
    ds_read_b64_tr_b16 v[198:199], v21 offset:2560
    ds_read_b64_tr_b16 v[150:151], v23 offset:2560
    ds_read_b64_tr_b16 v[200:201], v20 offset:4096
    ds_read_b64_tr_b16 v[152:153], v22 offset:4096
    ds_read_b64_tr_b16 v[202:203], v21 offset:4608
    ds_read_b64_tr_b16 v[154:155], v23 offset:4608
    s_waitcnt lgkmcnt(8)
    v_mfma_f32_32x32x16_bf16 v[176:191], v[192:195], v[144:147], 0
    ds_read_b64_tr_b16 v[204:205], v20 offset:6144
    ds_read_b64_tr_b16 v[156:157], v22 offset:6144
    ds_read_b64_tr_b16 v[206:207], v21 offset:6656
    ds_read_b64_tr_b16 v[158:159], v23 offset:6656
    s_waitcnt lgkmcnt(8)
    v_mfma_f32_32x32x16_bf16 v[176:191], v[196:199], v[148:151], v[176:191]
    ds_read_b64_tr_b16 v[208:209], v20 offset:8192
    ds_read_b64_tr_b16 v[160:161], v22 offset:8192
    ds_read_b64_tr_b16 v[210:211], v21 offset:8704
    ds_read_b64_tr_b16 v[162:163], v23 offset:8704
    s_waitcnt lgkmcnt(8)
    v_mfma_f32_32x32x16_bf16 v[176:191], v[200:203], v[152:155], v[176:191]
    ds_read_b64_tr_b16 v[212:213], v20 offset:10240
    ds_read_b64_tr_b16 v[164:165], v22 offset:10240
    ds_read_b64_tr_b16 v[214:215], v21 offset:10752
    ds_read_b64_tr_b16 v[166:167], v23 offset:10752
    s_waitcnt lgkmcnt(8)
    v_mfma_f32_32x32x16_bf16 v[176:191], v[204:207], v[156:159], v[176:191]
    ds_read_b64_tr_b16 v[216:217], v20 offset:12288
    ds_read_b64_tr_b16 v[168:169], v22 offset:12288
    ds_read_b64_tr_b16 v[218:219], v21 offset:12800
    ds_read_b64_tr_b16 v[170:171], v23 offset:12800
    s_waitcnt lgkmcnt(8)
    v_mfma_f32_32x32x16_bf16 v[176:191], v[208:211], v[160:163], v[176:191]
    ds_read_b64_tr_b16 v[220:221], v20 offset:14336
    ds_read_b64_tr_b16 v[172:173], v22 offset:14336
    ds_read_b64_tr_b16 v[222:223], v21 offset:14848
    ds_read_b64_tr_b16 v[174:175], v23 offset:14848
    s_waitcnt lgkmcnt(8)
    v_mfma_f32_32x32x16_bf16 v[176:191], v[212:215], v[164:167], v[176:191]
    s_waitcnt lgkmcnt(4)
    v_mfma_f32_32x32x16_bf16 v[176:191], v[216:219], v[168:171], v[176:191]
    s_waitcnt lgkmcnt(0)
    v_mfma_f32_32x32x16_bf16 v[176:191], v[220:223], v[172:175], v[176:191]
    s_nop 11
    v_cvt_pk_bf16_f32 v224, v176, v177
    v_cvt_pk_bf16_f32 v225, v178, v179
    v_cvt_pk_bf16_f32 v226, v180, v181
    v_cvt_pk_bf16_f32 v227, v182, 0
    v_or_b32_e64 v227, s50, v227
    buffer_store_dwordx4 v[224:227], v18, s[16:19], s90 offen sc1
    v_cvt_pk_bf16_f32 v228, v184, v185
    v_cvt_pk_bf16_f32 v229, v186, v187
    v_cvt_pk_bf16_f32 v230, v188, v189
    v_cvt_pk_bf16_f32 v231, v190, 0
    v_or_b32_e64 v231, s50, v231
    buffer_store_dwordx4 v[228:231], v18, s[16:19], s91 offen sc1
L_KV3:
    s_nop 3
    s_barrier
    s_add_u32 m0, s63, 32768
    s_add_u32 s52, s60, 114688
    buffer_load_dwordx4 v6, s[20:23], s52 offen lds
    s_add_u32 m0, s63, 33792
    s_add_u32 s52, s60, 121856
    buffer_load_dwordx4 v6, s[20:23], s52 offen lds
    s_add_u32 m0, s62, 0
    s_add_u32 s52, s60, 129024
    buffer_load_dwordx4 v6, s[20:23], s52 offen lds
    s_add_u32 m0, s62, 1024
    s_add_u32 s52, s60, 136192
    buffer_load_dwordx4 v6, s[20:23], s52 offen lds
    s_add_u32 m0, s62, 2048
    s_add_u32 s52, s60, 143360
    buffer_load_dwordx4 v6, s[20:23], s52 offen lds
    s_add_u32 m0, s62, 3072
    s_add_u32 s52, s60, 150528
    buffer_load_dwordx4 v6, s[20:23], s52 offen lds
    s_add_u32 m0, s63, 0
    s_add_u32 s52, s60, 157696
    buffer_load_dwordx4 v6, s[20:23], s52 offen lds
    s_add_u32 m0, s63, 1024
    s_add_u32 s52, s60, 164864
    buffer_load_dwordx4 v6, s[20:23], s52 offen lds
    s_add_u32 m0, s63, 49152
    s_add_u32 s52, s61, 12544
    buffer_load_dwordx4 v6, s[24:27], s52 offen lds
    s_add_u32 m0, s63, 50176
    s_add_u32 s52, s61, 19712
    buffer_load_dwordx4 v6, s[24:27], s52 offen lds
    v_and_b32 v4, 1, v0
    v_lshlrev_b32 v4, 2, v4
    v_bfe_u32 v5, v0, 1, 2
    v_min_u32_e64 v5, 2, v5
    v_lshl_add_u32 v5, v5, 4, v4
    buffer_load_dword v5, v5, s[16:19], s81 offen sc1
    s_waitcnt vmcnt(9)
    ds_read_b64_tr_b16 v[72:73], v138 offset:0
    ds_read_b64_tr_b16 v[74:75], v138 offset:1024
    ds_read_b64_tr_b16 v[76:77], v139 offset:0
    ds_read_b64_tr_b16 v[78:79], v139 offset:1024
    ds_read_b64_tr_b16 v[80:81], v138 offset:2048
    ds_read_b64_tr_b16 v[82:83], v138 offset:3072
    ds_read_b64_tr_b16 v[84:85], v139 offset:2048
    ds_read_b64_tr_b16 v[86:87], v139 offset:3072
    ds_read_b64_tr_b16 v[88:89], v140 offset:32768
    ds_read_b64_tr_b16 v[90:91], v140 offset:33792
    ds_read_b64_tr_b16 v[92:93], v141 offset:32768
    ds_read_b64_tr_b16 v[94:95], v141 offset:33792
    s_waitcnt vmcnt(0) lgkmcnt(0)
    s_branch L_S2
L_KV1:
    s_add_u32 m0, s62, 32768
    s_add_u32 s52, s60, 172032
    buffer_load_dwordx4 v6, s[20:23], s52 offen lds
    s_add_u32 m0, s62, 33792
    s_add_u32 s52, s60, 179200
    buffer_load_dwordx4 v6, s[20:23], s52 offen lds
    s_add_u32 m0, s62, 16384
    s_add_u32 s52, s60, 4294336512
    buffer_load_dwordx4 v6, s[20:23], s52 offen lds
    s_add_u32 m0, s62, 17408
    s_add_u32 s52, s60, 4294343680
    buffer_load_dwordx4 v6, s[20:23], s52 offen lds
    s_add_u32 m0, s62, 34816
    s_add_u32 s52, s60, 186368
    buffer_load_dwordx4 v6, s[20:23], s52 offen lds
    s_add_u32 m0, s62, 35840
    s_add_u32 s52, s60, 193536
    buffer_load_dwordx4 v6, s[20:23], s52 offen lds
    s_add_u32 m0, s62, 18432
    s_add_u32 s52, s60, 4294350848
    buffer_load_dwordx4 v6, s[20:23], s52 offen lds
    s_add_u32 m0, s62, 19456
    s_add_u32 s52, s60, 4294358016
    buffer_load_dwordx4 v6, s[20:23], s52 offen lds
    s_add_u32 m0, s63, 16384
    s_add_u32 s52, s61, 0
    buffer_load_dwordx4 v6, s[24:27], s52 offen lds
    s_add_u32 m0, s63, 17408
    s_add_u32 s52, s61, 7168
    buffer_load_dwordx4 v6, s[24:27], s52 offen lds
    s_add_u32 m0, s63, 8192
    s_add_u32 s52, s61, 4294766592
    buffer_load_dwordx4 v6, s[24:27], s52 offen lds
    s_add_u32 m0, s63, 9216
    s_add_u32 s52, s61, 4294773760
    buffer_load_dwordx4 v6, s[24:27], s52 offen lds
    s_setprio 1
    v_cvt_pk_bf16_f32 v144, v192, v193
    v_cvt_pk_bf16_f32 v148, v200, v201
    v_cvt_pk_bf16_f32 v145, v194, v195
    v_cvt_pk_bf16_f32 v149, v202, v203
    v_cvt_pk_bf16_f32 v146, v196, v197
    v_cvt_pk_bf16_f32 v150, v204, v205
    v_cvt_pk_bf16_f32 v147, v198, v199
    v_cvt_pk_bf16_f32 v151, v206, v207
    v_permlane16_swap_b32 v144, v148
    v_permlane16_swap_b32 v145, v149
    v_permlane16_swap_b32 v146, v150
    v_permlane16_swap_b32 v147, v151
    v_cndmask_b32 v150, v150, v19, s[58:59]
    ds_write_b64 v248, v[144:145] offset:32768
    ds_write_b64 v249, v[146:147] offset:32768
    ds_write_b64 v250, v[148:149] offset:32768
    ds_write_b64 v251, v[150:151] offset:32768
    v_cvt_pk_bf16_f32 v152, v208, v209
    v_cvt_pk_bf16_f32 v156, v216, v217
    v_cvt_pk_bf16_f32 v153, v210, v211
    v_cvt_pk_bf16_f32 v157, v218, v219
    v_cvt_pk_bf16_f32 v154, v212, v213
    v_cvt_pk_bf16_f32 v158, v220, v221
    v_cvt_pk_bf16_f32 v155, v214, v215
    v_cvt_pk_bf16_f32 v159, v222, v223
    v_permlane16_swap_b32 v152, v156
    v_permlane16_swap_b32 v153, v157
    v_permlane16_swap_b32 v154, v158
    v_permlane16_swap_b32 v155, v159
    v_cndmask_b32 v158, v158, v19, s[58:59]
    ds_write_b64 v252, v[152:153] offset:32768
    ds_write_b64 v253, v[154:155] offset:32768
    ds_write_b64 v254, v[156:157] offset:32768
    ds_write_b64 v255, v[158:159] offset:32768
    v_cvt_pk_bf16_f32 v160, v224, v225
    v_cvt_pk_bf16_f32 v164, v232, v233
    v_cvt_pk_bf16_f32 v161, v226, v227
    v_cvt_pk_bf16_f32 v165, v234, v235
    v_cvt_pk_bf16_f32 v162, v228, v229
    v_cvt_pk_bf16_f32 v166, v236, v237
    v_cvt_pk_bf16_f32 v163, v230, v231
    v_cvt_pk_bf16_f32 v167, v238, v239
    v_permlane16_swap_b32 v160, v164
    v_permlane16_swap_b32 v161, v165
    v_permlane16_swap_b32 v162, v166
    v_permlane16_swap_b32 v163, v167
    v_cndmask_b32 v166, v166, v19, s[58:59]
    ds_write_b64 v248, v[160:161] offset:49152
    ds_write_b64 v249, v[162:163] offset:49152
    ds_write_b64 v250, v[164:165] offset:49152
    ds_write_b64 v251, v[166:167] offset:49152
    s_setprio 0
    s_waitcnt vmcnt(0) lgkmcnt(0)
    s_branch L_KV2
L_Q:
    s_sub_u32 s46, s46, 14
    s_lshl_b32 s89, s46, 3
    s_add_u32 s89, s89, s44
    s_mul_i32 s91, s89, 56
    s_sub_u32 s91, s91, s96
    s_lshl_b32 s90, s90, 4
    s_mul_i32 s98, s89, 1568
    s_lshl_b32 s99, s44, 11
    s_add_u32 s54, s99, 147456
    v_and_b32 v1, 3, v0
    v_bfe_u32 v2, v0, 3, 2
    v_lshl_add_u32 v1, v2, 2, v1
    v_lshrrev_b32 v2, 3, v1
    v_sub_u32 v1, v1, v2
    v_bfe_u32 v2, v0, 2, 1
    v_mul_u32_u24 v2, 14, v2
    v_add_u32 v1, v1, v2
    v_min_u32 v1, 27, v1
    v_lshlrev_b32 v1, 1, v1
    v_mul_u32_u24 v2, 224, v3
    v_add3_u32 v107, v1, v2, s54
    v_lshl_add_u32 v26, v29, 3, s91
    v_xor_b32 v8, v26, v28
    v_add_u32 v8, v8, v27
    v_lshl_add_u32 v26, v31, 3, s91
    v_mov_b32 v1, s90
    v_cmp_eq_u32 vcc, 7, v31
    s_nop 1
    v_cndmask_b32 v26, v26, v1, vcc
    v_xor_b32 v9, v26, v28
    v_add_u32 v9, v9, v27
    v_and_b32 v2, 3, v0
    v_lshlrev_b32 v2, 6, v2
    v_xor_b32 v2, v2, v1
    v_and_b32 v1, 8, v0
    v_lshl_or_b32 v2, v1, 1, v2
    v_lshl_add_u32 v10, v0, 9, v2
    s_mul_i32 s53, s44, 43
    s_lshr_b32 s53, s53, 7
    s_mul_i32 s53, s53, 3
    s_sub_u32 s53, s44, s53
    s_lshl_b32 s53, s53, 15
    v_add_u32 v10, s53, v10
    v_and_b32_e64 v1, 3, v0
    v_bfe_u32 v2, v0, 3, 1
    v_lshl_add_u32 v1, v2, 2, v1
    v_bfe_u32 v2, v0, 4, 1
    v_bfe_u32 v3, v0, 2, 1
    v_lshl_add_u32 v3, v2, 1, v3
    v_mul_u32_u24 v3, 7, v3
    v_add_u32 v3, v3, v1
    v_mov_b32 v2, 28
    v_cmp_eq_u32 vcc, 7, v1
    s_nop 1
    v_cndmask_b32 v3, v3, v2, vcc
    v_and_b32_e64 v2, 16, v3
    v_add_lshl_u32 v20, v3, v2, 2
    v_add_u32 v19, 64, v20
    v_and_b32 v2, 15, v0
    v_lshlrev_b32_e64 v2, 4, v2
    v_lshl_or_b32 v21, v30, 9, v2
    v_lshlrev_b32 v23, 7, v0
    s_and_b32 s84, s45, 1
    s_lshl_b32 s84, s84, 2
    s_and_b32 s85, s89, 11
    s_xor_b32 s85, s85, 8
    s_add_u32 s84, s84, s85
    s_lshl_b32 s84, s84, 3
    s_lshr_b32 s85, s45, 1
    s_add_u32 s84, s84, s85
    s_lshl_b32 s91, s84, 9
    s_add_u32 s91, s91, 196608
    s_lshl_b32 s90, s84, 13
    s_add_u32 s90, s90, 1048576
    s_add_u32 m0, s51, 32768
    s_mov_b64 exec, s[56:57]
    buffer_load_dwordx4 v4, s[12:15], s7 offen lds
    s_mov_b64 exec, -1
    s_add_u32 s7, s7, s95
    s_add_u32 m0, s51, 40960
    s_mov_b64 exec, s[56:57]
    buffer_load_dwordx4 v4, s[12:15], s7 offen lds
    s_mov_b64 exec, -1
    s_add_u32 s7, s7, s95
    s_add_u32 m0, s51, 49152
    s_mov_b64 exec, s[56:57]
    buffer_load_dwordx4 v4, s[12:15], s7 offen lds
    s_mov_b64 exec, -1
    s_add_u32 s7, s7, s95
    s_add_u32 m0, s51, 57344
    s_mov_b64 exec, s[56:57]
    buffer_load_dwordx4 v4, s[12:15], s7 offen lds
    s_mov_b64 exec, -1
    s_add_u32 m0, s99, 147456
    s_nop 0
    buffer_load_dwordx4 v7, s[32:35], s98 offen lds
    s_add_u32 m0, s99, 148480
    s_add_u32 s52, s98, 1024
    buffer_load_dwordx4 v7, s[32:35], s52 offen lds
    s_waitcnt lgkmcnt(0)
    s_lshr_b32 s80, s49, 16
    s_add_u32 s80, s80, 0x2a5b
    s_and_b32 s80, s80, 0x3fff
    s_lshl_b32 s50, s80, 16
    s_mul_i32 s49, s49, 1664525
    s_add_u32 s49, s49, 1013904223
    s_lshr_b32 s49, s49, 16
    s_or_b32 s49, s49, s50
    s_waitcnt vmcnt(8)
    v_mov_b32 v34, v32
    v_mov_b32_e64 v35, 0
    s_cmp_lg_u32 s44, 0
    s_cbranch_scc1 L_g_38
    ds_write_b64 v10, v[34:35]
L_g_38:
    s_waitcnt lgkmcnt(0)
    s_barrier
    ds_read_b64_tr_b16 v[144:145], v8 offset:0
    ds_read_b64_tr_b16 v[146:147], v8 offset:2048
    ds_read_b64_tr_b16 v[148:149], v9 offset:0
    ds_read_b64_tr_b16 v[150:151], v9 offset:2048
    ds_read_b128 v[160:163], v16 offset:0
    ds_read_b128 v[164:167], v16 offset:2048
    ds_read_b128 v[168:171], v16 offset:4096
    ds_read_b128 v[172:175], v16 offset:6144
    s_waitcnt lgkmcnt(3)
    v_mfma_f32_16x16x32_bf16 v[192:195], v[144:147], v[160:163], 0
    v_mfma_f32_16x16x32_bf16 v[196:199], v[148:151], v[160:163], 0
    ds_read_b128 v[176:179], v16 offset:8192
    s_waitcnt lgkmcnt(3)
    v_mfma_f32_16x16x32_bf16 v[200:203], v[144:147], v[164:167], 0
    ds_read_b128 v[180:183], v16 offset:10240
    v_mfma_f32_16x16x32_bf16 v[204:207], v[148:151], v[164:167], 0
    ds_read_b128 v[184:187], v16 offset:12288
    s_waitcnt lgkmcnt(4)
    v_mfma_f32_16x16x32_bf16 v[208:211], v[144:147], v[168:171], 0
    v_mfma_f32_16x16x32_bf16 v[212:215], v[148:151], v[168:171], 0
    ds_read_b128 v[188:191], v16 offset:14336
    s_waitcnt lgkmcnt(4)
    v_mfma_f32_16x16x32_bf16 v[216:219], v[144:147], v[172:175], 0
    s_add_u32 s6, s3, 2
    s_sub_u32 s7, s6, 6
    s_cmp_ge_u32 s6, 7
    s_cselect_b32 s6, s7, s6
    s_mul_i32 s7, s6, s95
    s_lshl_b32 s7, s7, 2
    s_lshl_b32 s6, s6, 7
    s_add_u32 m0, s51, 131072
    s_nop 0
    buffer_load_dwordx4 v5, s[8:11], s6 offen lds
    v_mfma_f32_16x16x32_bf16 v[220:223], v[148:151], v[172:175], 0
    s_add_u32 m0, s51, 139264
    s_add_u32 s52, s6, 57344
    buffer_load_dwordx4 v5, s[8:11], s52 offen lds
    s_waitcnt lgkmcnt(3)
    v_mfma_f32_16x16x32_bf16 v[224:227], v[144:147], v[176:179], 0
    ds_read_b64_tr_b16 v[152:153], v8 offset:16384
    v_mfma_f32_16x16x32_bf16 v[228:231], v[148:151], v[176:179], 0
    ds_read_b64_tr_b16 v[154:155], v8 offset:18432
    s_waitcnt lgkmcnt(4)
    v_mfma_f32_16x16x32_bf16 v[232:235], v[144:147], v[180:183], 0
    ds_read_b64_tr_b16 v[156:157], v9 offset:16384
    v_mfma_f32_16x16x32_bf16 v[236:239], v[148:151], v[180:183], 0
    ds_read_b64_tr_b16 v[158:159], v9 offset:18432
    ds_read_b128 v[160:163], v17 offset:0
    s_waitcnt lgkmcnt(6)
    v_mfma_f32_16x16x32_bf16 v[240:243], v[144:147], v[184:187], 0
    ds_read_b128 v[164:167], v17 offset:2048
    v_mfma_f32_16x16x32_bf16 v[244:247], v[148:151], v[184:187], 0
    ds_read_b128 v[168:171], v17 offset:4096
    s_waitcnt lgkmcnt(7)
    v_mfma_f32_16x16x32_bf16 v[248:251], v[144:147], v[188:191], 0
    ds_read_b128 v[172:175], v17 offset:6144
    v_mfma_f32_16x16x32_bf16 v[252:255], v[148:151], v[188:191], 0
    s_add_u32 m0, s51, 65536
    s_mov_b64 exec, s[56:57]
    buffer_load_dwordx4 v4, s[12:15], s7 offen lds
    s_mov_b64 exec, -1
    s_add_u32 s7, s7, s95
    s_add_u32 m0, s51, 73728
    s_mov_b64 exec, s[56:57]
    buffer_load_dwordx4 v4, s[12:15], s7 offen lds
    s_mov_b64 exec, -1
    s_add_u32 s7, s7, s95
    s_waitcnt lgkmcnt(3)
    v_mfma_f32_16x16x32_bf16 v[192:195], v[152:155], v[160:163], v[192:195]
    v_mfma_f32_16x16x32_bf16 v[196:199], v[156:159], v[160:163], v[196:199]
    ds_read_b128 v[176:179], v17 offset:8192
    s_waitcnt lgkmcnt(3)
    v_mfma_f32_16x16x32_bf16 v[200:203], v[152:155], v[164:167], v[200:203]
    ds_read_b128 v[180:183], v17 offset:10240
    v_mfma_f32_16x16x32_bf16 v[204:207], v[156:159], v[164:167], v[204:207]
    ds_read_b128 v[184:187], v17 offset:12288
    s_waitcnt lgkmcnt(4)
    v_mfma_f32_16x16x32_bf16 v[208:211], v[152:155], v[168:171], v[208:211]
    v_mfma_f32_16x16x32_bf16 v[212:215], v[156:159], v[168:171], v[212:215]
    ds_read_b128 v[188:191], v17 offset:14336
    s_waitcnt lgkmcnt(4)
    v_mfma_f32_16x16x32_bf16 v[216:219], v[152:155], v[172:175], v[216:219]
    s_add_u32 m0, s51, 81920
    s_mov_b64 exec, s[56:57]
    buffer_load_dwordx4 v4, s[12:15], s7 offen lds
    s_mov_b64 exec, -1
    s_add_u32 s7, s7, s95
    v_mfma_f32_16x16x32_bf16 v[220:223], v[156:159], v[172:175], v[220:223]
    s_add_u32 m0, s51, 90112
    s_mov_b64 exec, s[56:57]
    buffer_load_dwordx4 v4, s[12:15], s7 offen lds
    s_mov_b64 exec, -1
    s_cmp_lg_u32 s44, 1
    s_cbranch_scc1 L_g_39
    ds_write_b64 v10, v[34:35]
L_g_39:
    s_waitcnt lgkmcnt(0)
    v_mfma_f32_16x16x32_bf16 v[224:227], v[152:155], v[176:179], v[224:227]
    s_waitcnt vmcnt(6)
    s_barrier
    v_mfma_f32_16x16x32_bf16 v[228:231], v[156:159], v[176:179], v[228:231]
    ds_read_b64_tr_b16 v[144:145], v8 offset:32768
    v_mfma_f32_16x16x32_bf16 v[232:235], v[152:155], v[180:183], v[232:235]
    ds_read_b64_tr_b16 v[146:147], v8 offset:34816
    v_mfma_f32_16x16x32_bf16 v[236:239], v[156:159], v[180:183], v[236:239]
    ds_read_b64_tr_b16 v[148:149], v9 offset:32768
    ds_read_b64_tr_b16 v[150:151], v9 offset:34816
    v_mfma_f32_16x16x32_bf16 v[240:243], v[152:155], v[184:187], v[240:243]
    ds_read_b128 v[160:163], v16 offset:16384
    v_mfma_f32_16x16x32_bf16 v[244:247], v[156:159], v[184:187], v[244:247]
    ds_read_b128 v[164:167], v16 offset:18432
    ds_read_b128 v[168:171], v16 offset:20480
    v_mfma_f32_16x16x32_bf16 v[248:251], v[152:155], v[188:191], v[248:251]
    ds_read_b128 v[172:175], v16 offset:22528
    v_mfma_f32_16x16x32_bf16 v[252:255], v[156:159], v[188:191], v[252:255]
    s_add_u32 s6, s3, 3
    s_sub_u32 s7, s6, 6
    s_cmp_ge_u32 s6, 7
    s_cselect_b32 s6, s7, s6
    s_mul_i32 s7, s6, s95
    s_lshl_b32 s7, s7, 2
    s_lshl_b32 s6, s6, 7
    s_add_u32 m0, s51, 98304
    s_nop 0
    buffer_load_dwordx4 v5, s[8:11], s6 offen lds
    s_add_u32 m0, s51, 106496
    s_add_u32 s52, s6, 57344
    buffer_load_dwordx4 v5, s[8:11], s52 offen lds
    s_waitcnt lgkmcnt(3)
    v_mfma_f32_16x16x32_bf16 v[192:195], v[144:147], v[160:163], v[192:195]
    ds_read_b128 v[176:179], v16 offset:24576
    v_mfma_f32_16x16x32_bf16 v[196:199], v[148:151], v[160:163], v[196:199]
    ds_read_b128 v[180:183], v16 offset:26624
    ds_read_b128 v[184:187], v16 offset:28672
    s_waitcnt lgkmcnt(5)
    v_mfma_f32_16x16x32_bf16 v[200:203], v[144:147], v[164:167], v[200:203]
    ds_read_b128 v[188:191], v16 offset:30720
    s_add_u32 m0, s51, 0
    s_mov_b64 exec, s[56:57]
    buffer_load_dwordx4 v4, s[12:15], s7 offen lds
    s_mov_b64 exec, -1
    s_add_u32 s7, s7, s95
    v_mfma_f32_16x16x32_bf16 v[204:207], v[148:151], v[164:167], v[204:207]
    s_add_u32 m0, s51, 8192
    s_mov_b64 exec, s[56:57]
    buffer_load_dwordx4 v4, s[12:15], s7 offen lds
    s_mov_b64 exec, -1
    s_add_u32 s7, s7, s95
    ds_read_u16 v48, v107 offset:0
    s_waitcnt lgkmcnt(6)
    v_mfma_f32_16x16x32_bf16 v[208:211], v[144:147], v[168:171], v[208:211]
    ds_read_u16 v49, v107 offset:56
    v_mfma_f32_16x16x32_bf16 v[212:215], v[148:151], v[168:171], v[212:215]
    ds_read_u16 v50, v107 offset:112
    ds_read_u16 v51, v107 offset:168
    s_waitcnt lgkmcnt(8)
    v_mfma_f32_16x16x32_bf16 v[216:219], v[144:147], v[172:175], v[216:219]
    ds_read_u16 v52, v107 offset:448
    ds_read_u16 v53, v107 offset:504
    v_mfma_f32_16x16x32_bf16 v[220:223], v[148:151], v[172:175], v[220:223]
    ds_read_u16 v54, v107 offset:560
    ds_read_u16 v55, v107 offset:616
    s_waitcnt lgkmcnt(11)
    v_mfma_f32_16x16x32_bf16 v[224:227], v[144:147], v[176:179], v[224:227]
    ds_read_b64_tr_b16 v[152:153], v8 offset:49152
    ds_read_b64_tr_b16 v[154:155], v8 offset:51200
    v_mfma_f32_16x16x32_bf16 v[228:231], v[148:151], v[176:179], v[228:231]
    ds_read_b64_tr_b16 v[156:157], v9 offset:49152
    ds_read_b64_tr_b16 v[158:159], v9 offset:51200
    ds_read_b128 v[160:163], v17 offset:16384
    s_waitcnt lgkmcnt(15)
    v_mfma_f32_16x16x32_bf16 v[232:235], v[144:147], v[180:183], v[232:235]
    ds_read_b128 v[164:167], v17 offset:18432
    ds_read_b128 v[168:171], v17 offset:20480
    v_mfma_f32_16x16x32_bf16 v[236:239], v[148:151], v[180:183], v[236:239]
    ds_read_b128 v[172:175], v17 offset:22528
    s_add_u32 m0, s51, 16384
    s_mov_b64 exec, s[56:57]
    buffer_load_dwordx4 v4, s[12:15], s7 offen lds
    s_mov_b64 exec, -1
    s_add_u32 s7, s7, s95
    s_add_u32 m0, s51, 24576
    s_mov_b64 exec, s[56:57]
    buffer_load_dwordx4 v4, s[12:15], s7 offen lds
    s_mov_b64 exec, -1
    s_waitcnt lgkmcnt(15)
    v_mfma_f32_16x16x32_bf16 v[240:243], v[144:147], v[184:187], v[240:243]
    ds_read_u16 v56, v107 offset:896
    ds_read_u16 v57, v107 offset:952
    ds_read_u16 v58, v107 offset:1008
    v_mfma_f32_16x16x32_bf16 v[244:247], v[148:151], v[184:187], v[244:247]
    ds_read_u16 v59, v107 offset:1064
    ds_read_u16 v60, v107 offset:1344
    v_mfma_f32_16x16x32_bf16 v[248:251], v[144:147], v[188:191], v[248:251]
    ds_read_u16 v61, v107 offset:1400
    ds_read_u16 v62, v107 offset:1456
    ds_read_u16 v63, v107 offset:1512
    v_mfma_f32_16x16x32_bf16 v[252:255], v[148:151], v[188:191], v[252:255]
    buffer_load_dword v108, v104, s[20:23], 0 offen
    buffer_load_dword v108, v105, s[24:27], 0 offen
    buffer_load_dword v108, v106, s[16:19], 0 offen
    s_waitcnt lgkmcnt(11)
    v_mfma_f32_16x16x32_bf16 v[192:195], v[152:155], v[160:163], v[192:195]
    ds_read_b128 v[176:179], v17 offset:24576
    v_mfma_f32_16x16x32_bf16 v[196:199], v[156:159], v[160:163], v[196:199]
    ds_read_b128 v[180:183], v17 offset:26624
    ds_read_b128 v[184:187], v17 offset:28672
    s_waitcnt lgkmcnt(13)
    v_mfma_f32_16x16x32_bf16 v[200:203], v[152:155], v[164:167], v[200:203]
    ds_read_b128 v[188:191], v17 offset:30720
    v_lshl_or_b32 v128, v49, 16, v48
    v_mfma_f32_16x16x32_bf16 v[204:207], v[156:159], v[164:167], v[204:207]
    v_lshl_or_b32 v129, v51, 16, v50
    v_lshl_or_b32 v130, v53, 16, v52
    s_waitcnt lgkmcnt(13)
    v_mfma_f32_16x16x32_bf16 v[208:211], v[152:155], v[168:171], v[208:211]
    v_lshl_or_b32 v131, v55, 16, v54
    v_mfma_f32_16x16x32_bf16 v[212:215], v[156:159], v[168:171], v[212:215]
    s_waitcnt lgkmcnt(10)
    v_lshl_or_b32 v132, v57, 16, v56
    s_waitcnt lgkmcnt(8)
    v_lshl_or_b32 v133, v59, 16, v58
    v_mfma_f32_16x16x32_bf16 v[216:219], v[152:155], v[172:175], v[216:219]
    s_waitcnt lgkmcnt(6)
    v_lshl_or_b32 v134, v61, 16, v60
    s_waitcnt lgkmcnt(4)
    v_lshl_or_b32 v135, v63, 16, v62
    v_mfma_f32_16x16x32_bf16 v[220:223], v[156:159], v[172:175], v[220:223]
    v_cndmask_b32 v134, v134, 0, s[58:59]
    v_cndmask_b32 v135, v135, 0, s[58:59]
    s_cmp_lg_u32 s44, 2
    s_cbranch_scc1 L_g_40
    ds_write_b64 v10, v[34:35]
L_g_40:
    s_waitcnt lgkmcnt(0)
    v_mfma_f32_16x16x32_bf16 v[224:227], v[152:155], v[176:179], v[224:227]
    v_xor_b32 v8, 0x10000, v8
    v_xor_b32 v9, 0x10000, v9
    s_waitcnt vmcnt(9)
    s_barrier
    v_mfma_f32_16x16x32_bf16 v[228:231], v[156:159], v[176:179], v[228:231]
    ds_read_b64_tr_b16 v[144:145], v8 offset:0
    v_mfma_f32_16x16x32_bf16 v[232:235], v[152:155], v[180:183], v[232:235]
    ds_read_b64_tr_b16 v[146:147], v8 offset:2048
    v_mfma_f32_16x16x32_bf16 v[236:239], v[156:159], v[180:183], v[236:239]
    ds_read_b64_tr_b16 v[148:149], v9 offset:0
    ds_read_b64_tr_b16 v[150:151], v9 offset:2048
    v_mfma_f32_16x16x32_bf16 v[240:243], v[152:155], v[184:187], v[240:243]
    ds_read_b128 v[160:163], v16 offset:32768
    v_mfma_f32_16x16x32_bf16 v[244:247], v[156:159], v[184:187], v[244:247]
    ds_read_b128 v[164:167], v16 offset:34816
    ds_read_b128 v[168:171], v16 offset:36864
    v_mfma_f32_16x16x32_bf16 v[248:251], v[152:155], v[188:191], v[248:251]
    ds_read_b128 v[172:175], v16 offset:38912
    v_mfma_f32_16x16x32_bf16 v[252:255], v[156:159], v[188:191], v[252:255]
    s_add_u32 s6, s3, 4
    s_sub_u32 s7, s6, 6
    s_cmp_ge_u32 s6, 7
    s_cselect_b32 s6, s7, s6
    s_mul_i32 s7, s6, s95
    s_lshl_b32 s7, s7, 2
    s_lshl_b32 s6, s6, 7
    s_add_u32 m0, s51, 114688
    s_nop 0
    buffer_load_dwordx4 v5, s[8:11], s6 offen lds
    s_add_u32 m0, s51, 122880
    s_add_u32 s52, s6, 57344
    buffer_load_dwordx4 v5, s[8:11], s52 offen lds
    s_waitcnt lgkmcnt(3)
    v_mfma_f32_16x16x32_bf16 v[192:195], v[144:147], v[160:163], v[192:195]
    v_mfma_f32_16x16x32_bf16 v[196:199], v[148:151], v[160:163], v[196:199]
    ds_read_b128 v[176:179], v16 offset:40960
    s_waitcnt lgkmcnt(3)
    v_mfma_f32_16x16x32_bf16 v[200:203], v[144:147], v[164:167], v[200:203]
    ds_read_b128 v[180:183], v16 offset:43008
    v_mfma_f32_16x16x32_bf16 v[204:207], v[148:151], v[164:167], v[204:207]
    ds_read_b128 v[184:187], v16 offset:45056
    s_waitcnt lgkmcnt(4)
    v_mfma_f32_16x16x32_bf16 v[208:211], v[144:147], v[168:171], v[208:211]
    v_mfma_f32_16x16x32_bf16 v[212:215], v[148:151], v[168:171], v[212:215]
    ds_read_b128 v[188:191], v16 offset:47104
    s_waitcnt lgkmcnt(4)
    v_mfma_f32_16x16x32_bf16 v[216:219], v[144:147], v[172:175], v[216:219]
    s_add_u32 m0, s51, 32768
    s_mov_b64 exec, s[56:57]
    buffer_load_dwordx4 v4, s[12:15], s7 offen lds
    s_mov_b64 exec, -1
    s_add_u32 s7, s7, s95
    v_mfma_f32_16x16x32_bf16 v[220:223], v[148:151], v[172:175], v[220:223]
    s_add_u32 m0, s51, 40960
    s_mov_b64 exec, s[56:57]
    buffer_load_dwordx4 v4, s[12:15], s7 offen lds
    s_mov_b64 exec, -1
    s_add_u32 s7, s7, s95
    s_waitcnt lgkmcnt(3)
    v_mfma_f32_16x16x32_bf16 v[224:227], v[144:147], v[176:179], v[224:227]
    ds_read_b64_tr_b16 v[152:153], v8 offset:16384
    v_mfma_f32_16x16x32_bf16 v[228:231], v[148:151], v[176:179], v[228:231]
    ds_read_b64_tr_b16 v[154:155], v8 offset:18432
    s_waitcnt lgkmcnt(4)
    v_mfma_f32_16x16x32_bf16 v[232:235], v[144:147], v[180:183], v[232:235]
    ds_read_b64_tr_b16 v[156:157], v9 offset:16384
    v_mfma_f32_16x16x32_bf16 v[236:239], v[148:151], v[180:183], v[236:239]
    ds_read_b64_tr_b16 v[158:159], v9 offset:18432
    ds_read_b128 v[160:163], v17 offset:32768
    s_waitcnt lgkmcnt(6)
    v_mfma_f32_16x16x32_bf16 v[240:243], v[144:147], v[184:187], v[240:243]
    ds_read_b128 v[164:167], v17 offset:34816
    v_mfma_f32_16x16x32_bf16 v[244:247], v[148:151], v[184:187], v[244:247]
    ds_read_b128 v[168:171], v17 offset:36864
    s_waitcnt lgkmcnt(7)
    v_mfma_f32_16x16x32_bf16 v[248:251], v[144:147], v[188:191], v[248:251]
    ds_read_b128 v[172:175], v17 offset:38912
    v_mfma_f32_16x16x32_bf16 v[252:255], v[148:151], v[188:191], v[252:255]
    s_add_u32 m0, s51, 49152
    s_mov_b64 exec, s[56:57]
    buffer_load_dwordx4 v4, s[12:15], s7 offen lds
    s_mov_b64 exec, -1
    s_add_u32 s7, s7, s95
    s_add_u32 m0, s51, 57344
    s_mov_b64 exec, s[56:57]
    buffer_load_dwordx4 v4, s[12:15], s7 offen lds
    s_mov_b64 exec, -1
    s_waitcnt lgkmcnt(3)
    v_mfma_f32_16x16x32_bf16 v[192:195], v[152:155], v[160:163], v[192:195]
    v_mfma_f32_16x16x32_bf16 v[196:199], v[156:159], v[160:163], v[196:199]
    ds_read_b128 v[176:179], v17 offset:40960
    s_waitcnt lgkmcnt(3)
    v_mfma_f32_16x16x32_bf16 v[200:203], v[152:155], v[164:167], v[200:203]
    v_mfma_f32_16x16x32_bf16 v[204:207], v[156:159], v[164:167], v[204:207]
    ds_read_b128 v[180:183], v17 offset:43008
    s_waitcnt lgkmcnt(3)
    v_mfma_f32_16x16x32_bf16 v[208:211], v[152:155], v[168:171], v[208:211]
    v_mfma_f32_16x16x32_bf16 v[212:215], v[156:159], v[168:171], v[212:215]
    ds_read_b128 v[184:187], v17 offset:45056
    s_waitcnt lgkmcnt(3)
    v_mfma_f32_16x16x32_bf16 v[216:219], v[152:155], v[172:175], v[216:219]
    v_mfma_f32_16x16x32_bf16 v[220:223], v[156:159], v[172:175], v[220:223]
    ds_read_b128 v[188:191], v17 offset:47104
    s_cmp_lg_u32 s44, 3
    s_cbranch_scc1 L_g_41
    ds_write_b64 v10, v[34:35]
L_g_41:
    s_waitcnt lgkmcnt(0)
    v_mfma_f32_16x16x32_bf16 v[224:227], v[152:155], v[176:179], v[224:227]
    v_xor_b32 v8, 0x10000, v8
    v_xor_b32 v9, 0x10000, v9
    s_waitcnt vmcnt(9)
    s_barrier
    v_mfma_f32_16x16x32_bf16 v[228:231], v[156:159], v[176:179], v[228:231]
    ds_read_b64_tr_b16 v[144:145], v8 offset:0
    v_mfma_f32_16x16x32_bf16 v[232:235], v[152:155], v[180:183], v[232:235]
    ds_read_b64_tr_b16 v[146:147], v8 offset:2048
    v_mfma_f32_16x16x32_bf16 v[236:239], v[156:159], v[180:183], v[236:239]
    ds_read_b64_tr_b16 v[148:149], v9 offset:0
    ds_read_b64_tr_b16 v[150:151], v9 offset:2048
    v_mfma_f32_16x16x32_bf16 v[240:243], v[152:155], v[184:187], v[240:243]
    ds_read_b128 v[160:163], v16 offset:0
    v_mfma_f32_16x16x32_bf16 v[244:247], v[156:159], v[184:187], v[244:247]
    ds_read_b128 v[164:167], v16 offset:2048
    ds_read_b128 v[168:171], v16 offset:4096
    v_mfma_f32_16x16x32_bf16 v[248:251], v[152:155], v[188:191], v[248:251]
    ds_read_b128 v[172:175], v16 offset:6144
    v_mfma_f32_16x16x32_bf16 v[252:255], v[156:159], v[188:191], v[252:255]
    s_add_u32 s6, s3, 5
    s_sub_u32 s7, s6, 6
    s_cmp_ge_u32 s6, 7
    s_cselect_b32 s6, s7, s6
    s_mul_i32 s7, s6, s95
    s_lshl_b32 s7, s7, 2
    s_lshl_b32 s6, s6, 7
    s_add_u32 m0, s51, 131072
    s_nop 0
    buffer_load_dwordx4 v5, s[8:11], s6 offen lds
    s_add_u32 m0, s51, 139264
    s_add_u32 s52, s6, 57344
    buffer_load_dwordx4 v5, s[8:11], s52 offen lds
    s_waitcnt lgkmcnt(3)
    v_mfma_f32_16x16x32_bf16 v[192:195], v[144:147], v[160:163], v[192:195]
    v_mfma_f32_16x16x32_bf16 v[196:199], v[148:151], v[160:163], v[196:199]
    ds_read_b128 v[176:179], v16 offset:8192
    s_waitcnt lgkmcnt(3)
    v_mfma_f32_16x16x32_bf16 v[200:203], v[144:147], v[164:167], v[200:203]
    ds_read_b128 v[180:183], v16 offset:10240
    v_mfma_f32_16x16x32_bf16 v[204:207], v[148:151], v[164:167], v[204:207]
    ds_read_b128 v[184:187], v16 offset:12288
    s_waitcnt lgkmcnt(4)
    v_mfma_f32_16x16x32_bf16 v[208:211], v[144:147], v[168:171], v[208:211]
    v_mfma_f32_16x16x32_bf16 v[212:215], v[148:151], v[168:171], v[212:215]
    ds_read_b128 v[188:191], v16 offset:14336
    s_waitcnt lgkmcnt(4)
    v_mfma_f32_16x16x32_bf16 v[216:219], v[144:147], v[172:175], v[216:219]
    s_add_u32 m0, s51, 65536
    s_mov_b64 exec, s[56:57]
    buffer_load_dwordx4 v4, s[12:15], s7 offen lds
    s_mov_b64 exec, -1
    s_add_u32 s7, s7, s95
    v_mfma_f32_16x16x32_bf16 v[220:223], v[148:151], v[172:175], v[220:223]
    s_add_u32 m0, s51, 73728
    s_mov_b64 exec, s[56:57]
    buffer_load_dwordx4 v4, s[12:15], s7 offen lds
    s_mov_b64 exec, -1
    s_add_u32 s7, s7, s95
    s_waitcnt lgkmcnt(3)
    v_mfma_f32_16x16x32_bf16 v[224:227], v[144:147], v[176:179], v[224:227]
    ds_read_b64_tr_b16 v[152:153], v8 offset:16384
    v_mfma_f32_16x16x32_bf16 v[228:231], v[148:151], v[176:179], v[228:231]
    ds_read_b64_tr_b16 v[154:155], v8 offset:18432
    s_waitcnt lgkmcnt(4)
    v_mfma_f32_16x16x32_bf16 v[232:235], v[144:147], v[180:183], v[232:235]
    ds_read_b64_tr_b16 v[156:157], v9 offset:16384
    v_mfma_f32_16x16x32_bf16 v[236:239], v[148:151], v[180:183], v[236:239]
    ds_read_b64_tr_b16 v[158:159], v9 offset:18432
    ds_read_b128 v[160:163], v17 offset:0
    s_waitcnt lgkmcnt(6)
    v_mfma_f32_16x16x32_bf16 v[240:243], v[144:147], v[184:187], v[240:243]
    ds_read_b128 v[164:167], v17 offset:2048
    v_mfma_f32_16x16x32_bf16 v[244:247], v[148:151], v[184:187], v[244:247]
    ds_read_b128 v[168:171], v17 offset:4096
    s_waitcnt lgkmcnt(7)
    v_mfma_f32_16x16x32_bf16 v[248:251], v[144:147], v[188:191], v[248:251]
    ds_read_b128 v[172:175], v17 offset:6144
    v_mfma_f32_16x16x32_bf16 v[252:255], v[148:151], v[188:191], v[252:255]
    s_add_u32 m0, s51, 81920
    s_mov_b64 exec, s[56:57]
    buffer_load_dwordx4 v4, s[12:15], s7 offen lds
    s_mov_b64 exec, -1
    s_add_u32 s7, s7, s95
    s_add_u32 m0, s51, 90112
    s_mov_b64 exec, s[56:57]
    buffer_load_dwordx4 v4, s[12:15], s7 offen lds
    s_mov_b64 exec, -1
    s_waitcnt lgkmcnt(3)
    v_mfma_f32_16x16x32_bf16 v[192:195], v[152:155], v[160:163], v[192:195]
    v_mfma_f32_16x16x32_bf16 v[196:199], v[156:159], v[160:163], v[196:199]
    ds_read_b128 v[176:179], v17 offset:8192
    s_waitcnt lgkmcnt(3)
    v_mfma_f32_16x16x32_bf16 v[200:203], v[152:155], v[164:167], v[200:203]
    v_mfma_f32_16x16x32_bf16 v[204:207], v[156:159], v[164:167], v[204:207]
    ds_read_b128 v[180:183], v17 offset:10240
    s_waitcnt lgkmcnt(3)
    v_mfma_f32_16x16x32_bf16 v[208:211], v[152:155], v[168:171], v[208:211]
    v_mfma_f32_16x16x32_bf16 v[212:215], v[156:159], v[168:171], v[212:215]
    ds_read_b128 v[184:187], v17 offset:12288
    s_waitcnt lgkmcnt(3)
    v_mfma_f32_16x16x32_bf16 v[216:219], v[152:155], v[172:175], v[216:219]
    v_mfma_f32_16x16x32_bf16 v[220:223], v[156:159], v[172:175], v[220:223]
    ds_read_b128 v[188:191], v17 offset:14336
    s_cmp_lg_u32 s44, 4
    s_cbranch_scc1 L_g_42
    ds_write_b64 v10, v[34:35]
L_g_42:
    s_waitcnt lgkmcnt(0)
    v_mfma_f32_16x16x32_bf16 v[224:227], v[152:155], v[176:179], v[224:227]
    s_waitcnt vmcnt(6)
    s_barrier
    v_mfma_f32_16x16x32_bf16 v[228:231], v[156:159], v[176:179], v[228:231]
    ds_read_b64_tr_b16 v[144:145], v8 offset:32768
    v_mfma_f32_16x16x32_bf16 v[232:235], v[152:155], v[180:183], v[232:235]
    ds_read_b64_tr_b16 v[146:147], v8 offset:34816
    v_mfma_f32_16x16x32_bf16 v[236:239], v[156:159], v[180:183], v[236:239]
    ds_read_b64_tr_b16 v[148:149], v9 offset:32768
    ds_read_b64_tr_b16 v[150:151], v9 offset:34816
    v_mfma_f32_16x16x32_bf16 v[240:243], v[152:155], v[184:187], v[240:243]
    ds_read_b128 v[160:163], v16 offset:16384
    v_mfma_f32_16x16x32_bf16 v[244:247], v[156:159], v[184:187], v[244:247]
    ds_read_b128 v[164:167], v16 offset:18432
    ds_read_b128 v[168:171], v16 offset:20480
    v_mfma_f32_16x16x32_bf16 v[248:251], v[152:155], v[188:191], v[248:251]
    ds_read_b128 v[172:175], v16 offset:22528
    v_mfma_f32_16x16x32_bf16 v[252:255], v[156:159], v[188:191], v[252:255]
    s_add_u32 s6, s3, 6
    s_sub_u32 s7, s6, 6
    s_cmp_ge_u32 s6, 7
    s_cselect_b32 s6, s7, s6
    s_mul_i32 s7, s6, s95
    s_lshl_b32 s7, s7, 2
    s_lshl_b32 s6, s6, 7
    s_add_u32 m0, s51, 98304
    s_nop 0
    buffer_load_dwordx4 v5, s[8:11], s6 offen lds
    s_add_u32 m0, s51, 106496
    s_add_u32 s52, s6, 57344
    buffer_load_dwordx4 v5, s[8:11], s52 offen lds
    s_waitcnt lgkmcnt(3)
    v_mfma_f32_16x16x32_bf16 v[192:195], v[144:147], v[160:163], v[192:195]
    v_mfma_f32_16x16x32_bf16 v[196:199], v[148:151], v[160:163], v[196:199]
    ds_read_b128 v[176:179], v16 offset:24576
    s_waitcnt lgkmcnt(3)
    v_mfma_f32_16x16x32_bf16 v[200:203], v[144:147], v[164:167], v[200:203]
    ds_read_b128 v[180:183], v16 offset:26624
    v_mfma_f32_16x16x32_bf16 v[204:207], v[148:151], v[164:167], v[204:207]
    ds_read_b128 v[184:187], v16 offset:28672
    s_waitcnt lgkmcnt(4)
    v_mfma_f32_16x16x32_bf16 v[208:211], v[144:147], v[168:171], v[208:211]
    v_mfma_f32_16x16x32_bf16 v[212:215], v[148:151], v[168:171], v[212:215]
    ds_read_b128 v[188:191], v16 offset:30720
    s_waitcnt lgkmcnt(4)
    v_mfma_f32_16x16x32_bf16 v[216:219], v[144:147], v[172:175], v[216:219]
    s_add_u32 m0, s51, 0
    s_mov_b64 exec, s[56:57]
    buffer_load_dwordx4 v4, s[12:15], s7 offen lds
    s_mov_b64 exec, -1
    s_add_u32 s7, s7, s95
    v_mfma_f32_16x16x32_bf16 v[220:223], v[148:151], v[172:175], v[220:223]
    s_add_u32 m0, s51, 8192
    s_mov_b64 exec, s[56:57]
    buffer_load_dwordx4 v4, s[12:15], s7 offen lds
    s_mov_b64 exec, -1
    s_add_u32 s7, s7, s95
    s_waitcnt lgkmcnt(3)
    v_mfma_f32_16x16x32_bf16 v[224:227], v[144:147], v[176:179], v[224:227]
    ds_read_b64_tr_b16 v[152:153], v8 offset:49152
    v_mfma_f32_16x16x32_bf16 v[228:231], v[148:151], v[176:179], v[228:231]
    ds_read_b64_tr_b16 v[154:155], v8 offset:51200
    s_waitcnt lgkmcnt(4)
    v_mfma_f32_16x16x32_bf16 v[232:235], v[144:147], v[180:183], v[232:235]
    ds_read_b64_tr_b16 v[156:157], v9 offset:49152
    v_mfma_f32_16x16x32_bf16 v[236:239], v[148:151], v[180:183], v[236:239]
    ds_read_b64_tr_b16 v[158:159], v9 offset:51200
    ds_read_b128 v[160:163], v17 offset:16384
    s_waitcnt lgkmcnt(6)
    v_mfma_f32_16x16x32_bf16 v[240:243], v[144:147], v[184:187], v[240:243]
    ds_read_b128 v[164:167], v17 offset:18432
    v_mfma_f32_16x16x32_bf16 v[244:247], v[148:151], v[184:187], v[244:247]
    ds_read_b128 v[168:171], v17 offset:20480
    s_waitcnt lgkmcnt(7)
    v_mfma_f32_16x16x32_bf16 v[248:251], v[144:147], v[188:191], v[248:251]
    ds_read_b128 v[172:175], v17 offset:22528
    v_mfma_f32_16x16x32_bf16 v[252:255], v[148:151], v[188:191], v[252:255]
    s_add_u32 m0, s51, 16384
    s_mov_b64 exec, s[56:57]
    buffer_load_dwordx4 v4, s[12:15], s7 offen lds
    s_mov_b64 exec, -1
    s_add_u32 s7, s7, s95
    s_add_u32 m0, s51, 24576
    s_mov_b64 exec, s[56:57]
    buffer_load_dwordx4 v4, s[12:15], s7 offen lds
    s_mov_b64 exec, -1
    s_waitcnt lgkmcnt(3)
    v_mfma_f32_16x16x32_bf16 v[192:195], v[152:155], v[160:163], v[192:195]
    v_mfma_f32_16x16x32_bf16 v[196:199], v[156:159], v[160:163], v[196:199]
    ds_read_b128 v[176:179], v17 offset:24576
    s_waitcnt lgkmcnt(3)
    v_mfma_f32_16x16x32_bf16 v[200:203], v[152:155], v[164:167], v[200:203]
    v_mfma_f32_16x16x32_bf16 v[204:207], v[156:159], v[164:167], v[204:207]
    ds_read_b128 v[180:183], v17 offset:26624
    s_waitcnt lgkmcnt(3)
    v_mfma_f32_16x16x32_bf16 v[208:211], v[152:155], v[168:171], v[208:211]
    v_mfma_f32_16x16x32_bf16 v[212:215], v[156:159], v[168:171], v[212:215]
    ds_read_b128 v[184:187], v17 offset:28672
    s_waitcnt lgkmcnt(3)
    v_mfma_f32_16x16x32_bf16 v[216:219], v[152:155], v[172:175], v[216:219]
    v_mfma_f32_16x16x32_bf16 v[220:223], v[156:159], v[172:175], v[220:223]
    ds_read_b128 v[188:191], v17 offset:30720
    s_cmp_lg_u32 s44, 5
    s_cbranch_scc1 L_g_43
    ds_write_b64 v10, v[34:35]
L_g_43:
    s_waitcnt lgkmcnt(0)
    v_mfma_f32_16x16x32_bf16 v[224:227], v[152:155], v[176:179], v[224:227]
    v_xor_b32 v8, 0x10000, v8
    v_xor_b32 v9, 0x10000, v9
    s_waitcnt vmcnt(6)
    s_barrier
    v_mfma_f32_16x16x32_bf16 v[228:231], v[156:159], v[176:179], v[228:231]
    ds_read_b64_tr_b16 v[144:145], v8 offset:0
    v_mfma_f32_16x16x32_bf16 v[232:235], v[152:155], v[180:183], v[232:235]
    ds_read_b64_tr_b16 v[146:147], v8 offset:2048
    v_mfma_f32_16x16x32_bf16 v[236:239], v[156:159], v[180:183], v[236:239]
    ds_read_b64_tr_b16 v[148:149], v9 offset:0
    v_mfma_f32_16x16x32_bf16 v[240:243], v[152:155], v[184:187], v[240:243]
    ds_read_b64_tr_b16 v[150:151], v9 offset:2048
    ds_read_b128 v[160:163], v16 offset:32768
    v_mfma_f32_16x16x32_bf16 v[244:247], v[156:159], v[184:187], v[244:247]
    ds_read_b128 v[164:167], v16 offset:34816
    v_mfma_f32_16x16x32_bf16 v[248:251], v[152:155], v[188:191], v[248:251]
    ds_read_b128 v[168:171], v16 offset:36864
    v_mfma_f32_16x16x32_bf16 v[252:255], v[156:159], v[188:191], v[252:255]
    ds_read_b128 v[172:175], v16 offset:38912
    buffer_load_dword v18, v23, s[16:19], s90 offen
    s_waitcnt lgkmcnt(3)
    v_mfma_f32_16x16x32_bf16 v[192:195], v[144:147], v[160:163], v[192:195]
    v_mfma_f32_16x16x32_bf16 v[196:199], v[148:151], v[160:163], v[196:199]
    ds_read_b128 v[176:179], v16 offset:40960
    s_waitcnt lgkmcnt(3)
    v_mfma_f32_16x16x32_bf16 v[200:203], v[144:147], v[164:167], v[200:203]
    v_mfma_f32_16x16x32_bf16 v[204:207], v[148:151], v[164:167], v[204:207]
    ds_read_b128 v[180:183], v16 offset:43008
    s_waitcnt lgkmcnt(3)
    v_mfma_f32_16x16x32_bf16 v[208:211], v[144:147], v[168:171], v[208:211]
    v_mfma_f32_16x16x32_bf16 v[212:215], v[148:151], v[168:171], v[212:215]
    ds_read_b128 v[184:187], v16 offset:45056
    s_waitcnt lgkmcnt(3)
    v_mfma_f32_16x16x32_bf16 v[216:219], v[144:147], v[172:175], v[216:219]
    v_mfma_f32_16x16x32_bf16 v[220:223], v[148:151], v[172:175], v[220:223]
    ds_read_b128 v[188:191], v16 offset:47104
    s_waitcnt lgkmcnt(3)
    v_mfma_f32_16x16x32_bf16 v[224:227], v[144:147], v[176:179], v[224:227]
    ds_read_b64_tr_b16 v[152:153], v8 offset:16384
    v_mfma_f32_16x16x32_bf16 v[228:231], v[148:151], v[176:179], v[228:231]
    ds_read_b64_tr_b16 v[154:155], v8 offset:18432
    s_waitcnt lgkmcnt(4)
    v_mfma_f32_16x16x32_bf16 v[232:235], v[144:147], v[180:183], v[232:235]
    ds_read_b64_tr_b16 v[156:157], v9 offset:16384
    v_mfma_f32_16x16x32_bf16 v[236:239], v[148:151], v[180:183], v[236:239]
    ds_read_b64_tr_b16 v[158:159], v9 offset:18432
    s_waitcnt lgkmcnt(5)
    v_mfma_f32_16x16x32_bf16 v[240:243], v[144:147], v[184:187], v[240:243]
    ds_read_b128 v[160:163], v17 offset:32768
    v_mfma_f32_16x16x32_bf16 v[244:247], v[148:151], v[184:187], v[244:247]
    ds_read_b128 v[164:167], v17 offset:34816
    s_waitcnt lgkmcnt(6)
    v_mfma_f32_16x16x32_bf16 v[248:251], v[144:147], v[188:191], v[248:251]
    ds_read_b128 v[168:171], v17 offset:36864
    v_mfma_f32_16x16x32_bf16 v[252:255], v[148:151], v[188:191], v[252:255]
    ds_read_b128 v[172:175], v17 offset:38912
    s_waitcnt lgkmcnt(3)
    v_mfma_f32_16x16x32_bf16 v[192:195], v[152:155], v[160:163], v[192:195]
    v_mfma_f32_16x16x32_bf16 v[196:199], v[156:159], v[160:163], v[196:199]
    ds_read_b128 v[176:179], v17 offset:40960
    s_waitcnt lgkmcnt(3)
    v_mfma_f32_16x16x32_bf16 v[200:203], v[152:155], v[164:167], v[200:203]
    v_mfma_f32_16x16x32_bf16 v[204:207], v[156:159], v[164:167], v[204:207]
    ds_read_b128 v[180:183], v17 offset:43008
    s_waitcnt lgkmcnt(3)
    v_mfma_f32_16x16x32_bf16 v[208:211], v[152:155], v[168:171], v[208:211]
    v_mfma_f32_16x16x32_bf16 v[212:215], v[156:159], v[168:171], v[212:215]
    ds_read_b128 v[184:187], v17 offset:45056
    s_waitcnt lgkmcnt(3)
    v_mfma_f32_16x16x32_bf16 v[216:219], v[152:155], v[172:175], v[216:219]
    v_mfma_f32_16x16x32_bf16 v[220:223], v[156:159], v[172:175], v[220:223]
    ds_read_b128 v[188:191], v17 offset:47104
    s_cmp_lg_u32 s44, 6
    s_cbranch_scc1 L_g_44
    ds_write_b64 v10, v[34:35]
L_g_44:
    s_waitcnt lgkmcnt(0)
    v_mfma_f32_16x16x32_bf16 v[224:227], v[152:155], v[176:179], v[224:227]
    v_xor_b32 v8, 0x10000, v8
    v_xor_b32 v9, 0x10000, v9
    s_waitcnt vmcnt(1)
    s_barrier
    v_mfma_f32_16x16x32_bf16 v[228:231], v[156:159], v[176:179], v[228:231]
    ds_read_b64_tr_b16 v[144:145], v8 offset:0
    v_mfma_f32_16x16x32_bf16 v[232:235], v[152:155], v[180:183], v[232:235]
    ds_read_b64_tr_b16 v[146:147], v8 offset:2048
    v_mfma_f32_16x16x32_bf16 v[236:239], v[156:159], v[180:183], v[236:239]
    ds_read_b64_tr_b16 v[148:149], v9 offset:0
    v_mfma_f32_16x16x32_bf16 v[240:243], v[152:155], v[184:187], v[240:243]
    ds_read_b64_tr_b16 v[150:151], v9 offset:2048
    v_mfma_f32_16x16x32_bf16 v[244:247], v[156:159], v[184:187], v[244:247]
    ds_read_b128 v[160:163], v16 offset:0
    v_mfma_f32_16x16x32_bf16 v[248:251], v[152:155], v[188:191], v[248:251]
    ds_read_b128 v[164:167], v16 offset:2048
    v_mfma_f32_16x16x32_bf16 v[252:255], v[156:159], v[188:191], v[252:255]
    ds_read_b128 v[168:171], v16 offset:4096
    ds_read_b128 v[172:175], v16 offset:6144
    s_waitcnt lgkmcnt(3)
    v_mfma_f32_16x16x32_bf16 v[192:195], v[144:147], v[160:163], v[192:195]
    v_mfma_f32_16x16x32_bf16 v[196:199], v[148:151], v[160:163], v[196:199]
    ds_read_b128 v[176:179], v16 offset:8192
    s_waitcnt lgkmcnt(3)
    v_mfma_f32_16x16x32_bf16 v[200:203], v[144:147], v[164:167], v[200:203]
    v_mfma_f32_16x16x32_bf16 v[204:207], v[148:151], v[164:167], v[204:207]
    ds_read_b128 v[180:183], v16 offset:10240
    s_waitcnt lgkmcnt(3)
    v_mfma_f32_16x16x32_bf16 v[208:211], v[144:147], v[168:171], v[208:211]
    v_mfma_f32_16x16x32_bf16 v[212:215], v[148:151], v[168:171], v[212:215]
    ds_read_b128 v[184:187], v16 offset:12288
    s_waitcnt lgkmcnt(3)
    v_mfma_f32_16x16x32_bf16 v[216:219], v[144:147], v[172:175], v[216:219]
    v_mfma_f32_16x16x32_bf16 v[220:223], v[148:151], v[172:175], v[220:223]
    ds_read_b128 v[188:191], v16 offset:14336
    s_waitcnt lgkmcnt(3)
    v_mfma_f32_16x16x32_bf16 v[224:227], v[144:147], v[176:179], v[224:227]
    ds_read_b64_tr_b16 v[152:153], v8 offset:16384
    v_mfma_f32_16x16x32_bf16 v[228:231], v[148:151], v[176:179], v[228:231]
    ds_read_b64_tr_b16 v[154:155], v8 offset:18432
    s_waitcnt lgkmcnt(4)
    v_mfma_f32_16x16x32_bf16 v[232:235], v[144:147], v[180:183], v[232:235]
    ds_read_b64_tr_b16 v[156:157], v9 offset:16384
    v_mfma_f32_16x16x32_bf16 v[236:239], v[148:151], v[180:183], v[236:239]
    ds_read_b64_tr_b16 v[158:159], v9 offset:18432
    s_waitcnt lgkmcnt(5)
    v_mfma_f32_16x16x32_bf16 v[240:243], v[144:147], v[184:187], v[240:243]
    ds_read_b128 v[160:163], v17 offset:0
    v_mfma_f32_16x16x32_bf16 v[244:247], v[148:151], v[184:187], v[244:247]
    ds_read_b128 v[164:167], v17 offset:2048
    s_waitcnt lgkmcnt(6)
    v_mfma_f32_16x16x32_bf16 v[248:251], v[144:147], v[188:191], v[248:251]
    ds_read_b128 v[168:171], v17 offset:4096
    v_mfma_f32_16x16x32_bf16 v[252:255], v[148:151], v[188:191], v[252:255]
    ds_read_b128 v[172:175], v17 offset:6144
    s_waitcnt lgkmcnt(3)
    v_mfma_f32_16x16x32_bf16 v[192:195], v[152:155], v[160:163], v[192:195]
    v_mfma_f32_16x16x32_bf16 v[196:199], v[156:159], v[160:163], v[196:199]
    ds_read_b128 v[176:179], v17 offset:8192
    s_waitcnt lgkmcnt(3)
    v_mfma_f32_16x16x32_bf16 v[200:203], v[152:155], v[164:167], v[200:203]
    v_mfma_f32_16x16x32_bf16 v[204:207], v[156:159], v[164:167], v[204:207]
    ds_read_b128 v[180:183], v17 offset:10240
    s_waitcnt lgkmcnt(3)
    v_mfma_f32_16x16x32_bf16 v[208:211], v[152:155], v[168:171], v[208:211]
    v_mfma_f32_16x16x32_bf16 v[212:215], v[156:159], v[168:171], v[212:215]
    ds_read_b128 v[184:187], v17 offset:12288
    s_waitcnt lgkmcnt(3)
    v_mfma_f32_16x16x32_bf16 v[216:219], v[152:155], v[172:175], v[216:219]
    v_mfma_f32_16x16x32_bf16 v[220:223], v[156:159], v[172:175], v[220:223]
    ds_read_b128 v[188:191], v17 offset:14336
    s_waitcnt lgkmcnt(0)
    v_mfma_f32_16x16x32_bf16 v[224:227], v[152:155], v[176:179], v[224:227]
    s_barrier
    v_mfma_f32_16x16x32_bf16 v[228:231], v[156:159], v[176:179], v[228:231]
    v_mfma_f32_16x16x32_bf16 v[232:235], v[152:155], v[180:183], v[232:235]
    v_mfma_f32_16x16x32_bf16 v[236:239], v[156:159], v[180:183], v[236:239]
    v_mfma_f32_16x16x32_bf16 v[240:243], v[152:155], v[184:187], v[240:243]
    v_mfma_f32_16x16x32_bf16 v[244:247], v[156:159], v[184:187], v[244:247]
    v_mfma_f32_16x16x32_bf16 v[248:251], v[152:155], v[188:191], v[248:251]
    v_mfma_f32_16x16x32_bf16 v[252:255], v[156:159], v[188:191], v[252:255]
    v_cvt_pk_bf16_f32 v88, v192, v193
    v_cvt_pk_bf16_f32 v92, v200, v201
    v_cvt_pk_bf16_f32 v89, v194, v195
    v_cvt_pk_bf16_f32 v93, v202, v203
    v_cvt_pk_bf16_f32 v90, v196, v197
    v_cvt_pk_bf16_f32 v94, v204, v205
    v_cvt_pk_bf16_f32 v91, v198, v199
    v_cvt_pk_bf16_f32 v95, v206, v207
    v_permlane16_swap_b32 v88, v92
    v_permlane16_swap_b32 v89, v93
    v_permlane16_swap_b32 v90, v94
    v_permlane16_swap_b32 v91, v95
    s_nop 1
    v_mfma_f32_32x32x16_bf16 v[96:111], v[128:131], v[88:91], 0
    v_mfma_f32_32x32x16_bf16 v[96:111], v[132:135], v[92:95], v[96:111]
    v_mul_f32 v172, s40, v196
    v_mul_f32 v168, s40, v204
    v_mul_f32 v173, s40, v212
    v_mul_f32 v169, s40, v220
    v_mul_f32 v174, s40, v228
    v_mul_f32 v170, s40, v236
    v_mul_f32 v175, s40, v244
    v_mul_f32 v171, s40, v252
    v_permlane16_swap_b32 v172, v168
    v_permlane16_swap_b32 v173, v169
    v_permlane16_swap_b32 v174, v170
    v_permlane16_swap_b32 v175, v171
    v_min_f32 v168, 1118568448, v168
    v_min_f32 v169, 1118568448, v169
    v_min_f32 v170, 1118568448, v170
    v_min_f32 v171, 1118568448, v171
    v_exp_f32 v168, v168
    v_exp_f32 v169, v169
    v_exp_f32 v170, v170
    v_exp_f32 v171, v171
    v_mul_f32 v168, s40, v168
    v_mul_f32 v169, s40, v169
    v_mul_f32 v170, s40, v170
    v_mul_f32 v171, s40, v171
    v_mov_b32 v172, v168
    v_mov_b32 v173, v169
    v_mov_b32 v174, v170
    v_mov_b32 v175, v171
    v_permlane32_swap_b32 v172, v168
    v_permlane32_swap_b32 v173, v169
    v_permlane32_swap_b32 v174, v170
    v_permlane32_swap_b32 v175, v171
    s_cmp_lg_u32 s89, 0
    s_cbranch_scc1 L_Q1
    v_cndmask_b32 v2, v168, v169, s[58:59]
    v_cndmask_b32 v10, v170, v171, s[58:59]
    v_add_f32 v2, s40, v2
    v_add_f32 v10, s40, v10
    v_rcp_f32 v2, v2
    v_rcp_f32 v10, v10
    v_mov_b32 v3, s49
    v_mov_b32 v11, s49
    v_lshlrev_b32 v1, 3, v0
    s_lshl_b32 s53, s45, 10
    s_add_u32 s53, s53, 180224
    buffer_store_dwordx2 v[2:3], v1, s[16:19], s53 offen sc1
    buffer_store_dwordx2 v[10:11], v1, s[16:19], s53 offen offset:512 sc1
L_Q1:
    v_cvt_pk_bf16_f32 v176, v208, v209
    v_cvt_pk_bf16_f32 v180, v216, v217
    v_cvt_pk_bf16_f32 v177, v210, v211
    v_cvt_pk_bf16_f32 v181, v218, v219
    v_cvt_pk_bf16_f32 v178, v212, v213
    v_cvt_pk_bf16_f32 v182, v220, v221
    v_cvt_pk_bf16_f32 v179, v214, v215
    v_cvt_pk_bf16_f32 v183, v222, v223
    v_permlane16_swap_b32 v176, v180
    v_permlane16_swap_b32 v177, v181
    v_permlane16_swap_b32 v178, v182
    v_permlane16_swap_b32 v179, v183
    s_nop 1
    v_mfma_f32_32x32x16_bf16 v[112:127], v[128:131], v[176:179], 0
    v_mfma_f32_32x32x16_bf16 v[112:127], v[132:135], v[180:183], v[112:127]
    v_max_f32 v164, v96, v97
    s_nop 10
    v_max_f32 v220, v112, v113
    v_max_f32 v165, -v96, -v97
    v_max_f32 v221, -v112, -v113
    v_max3_f32 v164, v164, v98, v99
    v_max3_f32 v220, v220, v114, v115
    v_max3_f32 v165, v165, -v98, -v99
    v_max3_f32 v221, v221, -v114, -v115
    v_max3_f32 v164, v164, v100, v101
    v_max3_f32 v220, v220, v116, v117
    v_max3_f32 v165, v165, -v100, -v101
    v_max3_f32 v221, v221, -v116, -v117
    v_max3_f32 v164, v164, v102, v104
    v_max3_f32 v220, v220, v118, v120
    v_max3_f32 v165, v165, -v102, -v104
    v_max3_f32 v221, v221, -v118, -v120
    v_max3_f32 v164, v164, v105, v106
    v_max3_f32 v220, v220, v121, v122
    v_max3_f32 v165, v165, -v105, -v106
    v_max3_f32 v221, v221, -v121, -v122
    v_max3_f32 v164, v164, v107, v108
    v_max3_f32 v220, v220, v123, v124
    v_max3_f32 v165, v165, -v107, -v108
    v_max3_f32 v221, v221, -v123, -v124
    v_max3_f32 v164, v164, v109, v110
    v_max3_f32 v220, v220, v125, v126
    v_max3_f32 v165, v165, -v109, -v110
    v_max3_f32 v221, v221, -v125, -v126
    s_nop 0
    v_permlane32_swap_b32 v164, v165
    v_permlane32_swap_b32 v220, v221
    v_max_f32 v164, v164, v165
    v_max_f32 v220, v220, v221
    v_mul_f32 v164, s43, v164
    v_mul_f32 v220, s43, v220
    v_mov_b32 v165, v164
    v_mov_b32 v221, v220
    s_nop 0
    v_permlane32_swap_b32 v164, v165
    v_permlane32_swap_b32 v220, v221
    v_pk_fma_f32 v[136:137], v[96:97], s[42:43], v[164:165] op_sel:[0,0,0] op_sel_hi:[0,1,1]
    v_pk_fma_f32 v[192:193], v[112:113], s[42:43], v[220:221] op_sel:[0,0,0] op_sel_hi:[0,1,1]
    v_pk_fma_f32 v[138:139], v[96:97], s[42:43], v[164:165] op_sel:[1,0,0] op_sel_hi:[1,1,1]
    v_pk_fma_f32 v[194:195], v[112:113], s[42:43], v[220:221] op_sel:[1,0,0] op_sel_hi:[1,1,1]
    v_pk_fma_f32 v[140:141], v[98:99], s[42:43], v[164:165] op_sel:[0,0,0] op_sel_hi:[0,1,1]
    v_pk_fma_f32 v[196:197], v[114:115], s[42:43], v[220:221] op_sel:[0,0,0] op_sel_hi:[0,1,1]
    v_pk_fma_f32 v[142:143], v[98:99], s[42:43], v[164:165] op_sel:[1,0,0] op_sel_hi:[1,1,1]
    v_pk_fma_f32 v[198:199], v[114:115], s[42:43], v[220:221] op_sel:[1,0,0] op_sel_hi:[1,1,1]
    v_pk_fma_f32 v[144:145], v[100:101], s[42:43], v[164:165] op_sel:[0,0,0] op_sel_hi:[0,1,1]
    v_pk_fma_f32 v[200:201], v[116:117], s[42:43], v[220:221] op_sel:[0,0,0] op_sel_hi:[0,1,1]
    v_pk_fma_f32 v[146:147], v[100:101], s[42:43], v[164:165] op_sel:[1,0,0] op_sel_hi:[1,1,1]
    v_pk_fma_f32 v[202:203], v[116:117], s[42:43], v[220:221] op_sel:[1,0,0] op_sel_hi:[1,1,1]
    v_pk_fma_f32 v[148:149], v[102:103], s[42:43], v[164:165] op_sel:[0,0,0] op_sel_hi:[0,1,1]
    v_pk_fma_f32 v[204:205], v[118:119], s[42:43], v[220:221] op_sel:[0,0,0] op_sel_hi:[0,1,1]
    v_pk_fma_f32 v[150:151], v[104:105], s[42:43], v[164:165] op_sel:[0,0,0] op_sel_hi:[0,1,1]
    v_pk_fma_f32 v[206:207], v[120:121], s[42:43], v[220:221] op_sel:[0,0,0] op_sel_hi:[0,1,1]
    v_pk_fma_f32 v[152:153], v[104:105], s[42:43], v[164:165] op_sel:[1,0,0] op_sel_hi:[1,1,1]
    v_pk_fma_f32 v[208:209], v[120:121], s[42:43], v[220:221] op_sel:[1,0,0] op_sel_hi:[1,1,1]
    v_pk_fma_f32 v[154:155], v[106:107], s[42:43], v[164:165] op_sel:[0,0,0] op_sel_hi:[0,1,1]
    v_pk_fma_f32 v[210:211], v[122:123], s[42:43], v[220:221] op_sel:[0,0,0] op_sel_hi:[0,1,1]
    v_pk_fma_f32 v[156:157], v[106:107], s[42:43], v[164:165] op_sel:[1,0,0] op_sel_hi:[1,1,1]
    v_pk_fma_f32 v[212:213], v[122:123], s[42:43], v[220:221] op_sel:[1,0,0] op_sel_hi:[1,1,1]
    v_pk_fma_f32 v[158:159], v[108:109], s[42:43], v[164:165] op_sel:[0,0,0] op_sel_hi:[0,1,1]
    v_pk_fma_f32 v[214:215], v[124:125], s[42:43], v[220:221] op_sel:[0,0,0] op_sel_hi:[0,1,1]
    v_pk_fma_f32 v[160:161], v[108:109], s[42:43], v[164:165] op_sel:[1,0,0] op_sel_hi:[1,1,1]
    v_pk_fma_f32 v[216:217], v[124:125], s[42:43], v[220:221] op_sel:[1,0,0] op_sel_hi:[1,1,1]
    v_pk_fma_f32 v[162:163], v[110:111], s[42:43], v[164:165] op_sel:[0,0,0] op_sel_hi:[0,1,1]
    v_pk_fma_f32 v[218:219], v[126:127], s[42:43], v[220:221] op_sel:[0,0,0] op_sel_hi:[0,1,1]
    v_exp_f32 v136, v136
    v_exp_f32 v192, v192
    v_exp_f32 v137, v137
    v_exp_f32 v193, v193
    v_exp_f32 v138, v138
    v_exp_f32 v194, v194
    v_exp_f32 v139, v139
    v_exp_f32 v195, v195
    v_exp_f32 v140, v140
    v_exp_f32 v196, v196
    v_exp_f32 v141, v141
    v_exp_f32 v197, v197
    v_exp_f32 v142, v142
    v_exp_f32 v198, v198
    v_exp_f32 v143, v143
    v_exp_f32 v199, v199
    v_exp_f32 v144, v144
    v_exp_f32 v200, v200
    v_exp_f32 v145, v145
    v_exp_f32 v201, v201
    v_exp_f32 v146, v146
    v_exp_f32 v202, v202
    v_exp_f32 v147, v147
    v_exp_f32 v203, v203
    v_exp_f32 v148, v148
    v_exp_f32 v204, v204
    v_exp_f32 v149, v149
    v_exp_f32 v205, v205
    v_exp_f32 v150, v150
    v_exp_f32 v206, v206
    v_exp_f32 v151, v151
    v_exp_f32 v207, v207
    v_exp_f32 v152, v152
    v_exp_f32 v208, v208
    v_exp_f32 v153, v153
    v_exp_f32 v209, v209
    v_exp_f32 v154, v154
    v_exp_f32 v210, v210
    v_exp_f32 v155, v155
    v_exp_f32 v211, v211
    v_exp_f32 v156, v156
    v_exp_f32 v212, v212
    v_exp_f32 v157, v157
    v_exp_f32 v213, v213
    v_exp_f32 v158, v158
    v_exp_f32 v214, v214
    v_exp_f32 v159, v159
    v_exp_f32 v215, v215
    v_exp_f32 v160, v160
    v_exp_f32 v216, v216
    v_exp_f32 v161, v161
    v_exp_f32 v217, v217
    v_exp_f32 v162, v162
    v_exp_f32 v218, v218
    v_exp_f32 v163, v163
    v_exp_f32 v219, v219
    v_pk_add_f32 v[164:165], v[136:137], v[138:139]
    v_pk_add_f32 v[220:221], v[192:193], v[194:195]
    v_pk_add_f32 v[166:167], v[140:141], v[142:143]
    v_pk_add_f32 v[222:223], v[196:197], v[198:199]
    v_pk_add_f32 v[164:165], v[164:165], v[144:145]
    v_pk_add_f32 v[220:221], v[220:221], v[200:201]
    v_pk_add_f32 v[166:167], v[166:167], v[146:147]
    v_pk_add_f32 v[222:223], v[222:223], v[202:203]
    v_pk_add_f32 v[164:165], v[164:165], v[148:149]
    v_pk_add_f32 v[220:221], v[220:221], v[204:205]
    v_pk_add_f32 v[166:167], v[166:167], v[150:151]
    v_pk_add_f32 v[222:223], v[222:223], v[206:207]
    v_pk_add_f32 v[164:165], v[164:165], v[152:153]
    v_pk_add_f32 v[220:221], v[220:221], v[208:209]
    v_pk_add_f32 v[166:167], v[166:167], v[154:155]
    v_pk_add_f32 v[222:223], v[222:223], v[210:211]
    v_pk_add_f32 v[164:165], v[164:165], v[156:157]
    v_pk_add_f32 v[220:221], v[220:221], v[212:213]
    v_pk_add_f32 v[166:167], v[166:167], v[158:159]
    v_pk_add_f32 v[222:223], v[222:223], v[214:215]
    v_pk_add_f32 v[164:165], v[164:165], v[160:161]
    v_pk_add_f32 v[220:221], v[220:221], v[216:217]
    v_pk_add_f32 v[166:167], v[166:167], v[162:163]
    v_pk_add_f32 v[222:223], v[222:223], v[218:219]
    v_pk_add_f32 v[164:165], v[164:165], v[166:167]
    v_pk_add_f32 v[220:221], v[220:221], v[222:223]
    s_nop 0
    v_permlane32_swap_b32 v164, v165
    v_permlane32_swap_b32 v220, v221
    v_add_f32 v164, v164, v165
    v_add_f32 v220, v220, v221
    v_rcp_f32 v164, v164
    v_rcp_f32 v220, v220
    v_mov_b32 v165, v164
    v_mov_b32 v221, v220
    s_nop 0
    v_permlane32_swap_b32 v164, v165
    v_permlane32_swap_b32 v220, v221
    v_pk_mul_f32 v[136:137], v[136:137], v[164:165]
    v_pk_mul_f32 v[192:193], v[192:193], v[220:221]
    v_pk_mul_f32 v[138:139], v[138:139], v[164:165]
    v_pk_mul_f32 v[194:195], v[194:195], v[220:221]
    v_pk_mul_f32 v[140:141], v[140:141], v[164:165]
    v_pk_mul_f32 v[196:197], v[196:197], v[220:221]
    v_pk_mul_f32 v[142:143], v[142:143], v[164:165]
    v_pk_mul_f32 v[198:199], v[198:199], v[220:221]
    v_pk_mul_f32 v[144:145], v[144:145], v[164:165]
    v_pk_mul_f32 v[200:201], v[200:201], v[220:221]
    v_pk_mul_f32 v[146:147], v[146:147], v[164:165]
    v_pk_mul_f32 v[202:203], v[202:203], v[220:221]
    v_pk_mul_f32 v[148:149], v[148:149], v[164:165]
    v_pk_mul_f32 v[204:205], v[204:205], v[220:221]
    v_pk_mul_f32 v[150:151], v[150:151], v[164:165]
    v_pk_mul_f32 v[206:207], v[206:207], v[220:221]
    v_pk_mul_f32 v[152:153], v[152:153], v[164:165]
    v_pk_mul_f32 v[208:209], v[208:209], v[220:221]
    v_pk_mul_f32 v[154:155], v[154:155], v[164:165]
    v_pk_mul_f32 v[210:211], v[210:211], v[220:221]
    v_pk_mul_f32 v[156:157], v[156:157], v[164:165]
    v_pk_mul_f32 v[212:213], v[212:213], v[220:221]
    v_pk_mul_f32 v[158:159], v[158:159], v[164:165]
    v_pk_mul_f32 v[214:215], v[214:215], v[220:221]
    v_pk_mul_f32 v[160:161], v[160:161], v[164:165]
    v_pk_mul_f32 v[216:217], v[216:217], v[220:221]
    v_pk_mul_f32 v[162:163], v[162:163], v[164:165]
    v_pk_mul_f32 v[218:219], v[218:219], v[220:221]
    v_cvt_pk_bf16_f32 v24, v136, v138
    v_cvt_pk_bf16_f32 v40, v192, v194
    v_cvt_pk_bf16_f32 v25, v140, v142
    v_cvt_pk_bf16_f32 v41, v196, v198
    v_cvt_pk_bf16_f32 v26, v144, v146
    v_cvt_pk_bf16_f32 v42, v200, v202
    v_cvt_pk_bf16_f32 v27, v148, 0
    v_cvt_pk_bf16_f32 v43, v204, 0
    v_cvt_pk_bf16_f32 v28, v150, v152
    v_cvt_pk_bf16_f32 v44, v206, v208
    v_cvt_pk_bf16_f32 v29, v154, v156
    v_cvt_pk_bf16_f32 v45, v210, v212
    v_cvt_pk_bf16_f32 v30, v158, v160
    v_cvt_pk_bf16_f32 v46, v214, v216
    v_cvt_pk_bf16_f32 v31, v162, 0
    v_cvt_pk_bf16_f32 v47, v218, 0
    v_cvt_pk_bf16_f32 v32, v137, v139
    v_cvt_pk_bf16_f32 v48, v193, v195
    v_cvt_pk_bf16_f32 v33, v141, v143
    v_cvt_pk_bf16_f32 v49, v197, v199
    v_cvt_pk_bf16_f32 v34, v145, v147
    v_cvt_pk_bf16_f32 v50, v201, v203
    v_cvt_pk_bf16_f32 v35, v149, 0
    v_cvt_pk_bf16_f32 v51, v205, 0
    v_cvt_pk_bf16_f32 v36, v151, v153
    v_cvt_pk_bf16_f32 v52, v207, v209
    v_cvt_pk_bf16_f32 v37, v155, v157
    v_cvt_pk_bf16_f32 v53, v211, v213
    v_cvt_pk_bf16_f32 v38, v159, v161
    v_cvt_pk_bf16_f32 v54, v215, v217
    v_cvt_pk_bf16_f32 v39, v163, 0
    v_cvt_pk_bf16_f32 v55, v219, 0
    v_cvt_pk_bf16_f32 v88, v224, v225
    v_cvt_pk_bf16_f32 v92, v232, v233
    v_cvt_pk_bf16_f32 v89, v226, v227
    v_cvt_pk_bf16_f32 v93, v234, v235
    v_cvt_pk_bf16_f32 v90, v228, v229
    v_cvt_pk_bf16_f32 v94, v236, v237
    v_cvt_pk_bf16_f32 v91, v230, v231
    v_cvt_pk_bf16_f32 v95, v238, v239
    v_permlane16_swap_b32 v88, v92
    v_permlane16_swap_b32 v89, v93
    v_permlane16_swap_b32 v90, v94
    v_permlane16_swap_b32 v91, v95
    s_nop 1
    v_mfma_f32_32x32x16_bf16 v[96:111], v[128:131], v[88:91], 0
    v_mfma_f32_32x32x16_bf16 v[96:111], v[132:135], v[92:95], v[96:111]
    v_cvt_pk_bf16_f32 v176, v240, v241
    v_cvt_pk_bf16_f32 v180, v248, v249
    v_cvt_pk_bf16_f32 v177, v242, v243
    v_cvt_pk_bf16_f32 v181, v250, v251
    v_cvt_pk_bf16_f32 v178, v244, v245
    v_cvt_pk_bf16_f32 v182, v252, v253
    v_cvt_pk_bf16_f32 v179, v246, v247
    v_cvt_pk_bf16_f32 v183, v254, v255
    v_permlane16_swap_b32 v176, v180
    v_permlane16_swap_b32 v177, v181
    v_permlane16_swap_b32 v178, v182
    v_permlane16_swap_b32 v179, v183
    s_nop 1
    v_mfma_f32_32x32x16_bf16 v[112:127], v[128:131], v[176:179], 0
    v_mfma_f32_32x32x16_bf16 v[112:127], v[132:135], v[180:183], v[112:127]
    v_max_f32 v164, v96, v97
    s_nop 10
    v_max_f32_e64 v220, v112, v113
    v_max_f32 v165, -v96, -v97
    v_max_f32 v221, -v112, -v113
    v_max3_f32 v164, v164, v98, v99
    v_max3_f32 v220, v220, v114, v115
    v_max3_f32 v165, v165, -v98, -v99
    v_max3_f32 v221, v221, -v114, -v115
    v_max3_f32 v164, v164, v100, v101
    v_max3_f32 v220, v220, v116, v117
    v_max3_f32 v165, v165, -v100, -v101
    v_max3_f32 v221, v221, -v116, -v117
    v_max3_f32 v164, v164, v102, v104
    v_max3_f32 v220, v220, v118, v120
    v_max3_f32 v165, v165, -v102, -v104
    v_max3_f32 v221, v221, -v118, -v120
    v_max3_f32 v164, v164, v105, v106
    v_max3_f32 v220, v220, v121, v122
    v_max3_f32 v165, v165, -v105, -v106
    v_max3_f32 v221, v221, -v121, -v122
    v_max3_f32 v164, v164, v107, v108
    v_max3_f32 v220, v220, v123, v124
    v_max3_f32 v165, v165, -v107, -v108
    v_max3_f32 v221, v221, -v123, -v124
    v_max3_f32 v164, v164, v109, v110
    v_max3_f32 v220, v220, v125, v126
    v_max3_f32 v165, v165, -v109, -v110
    v_max3_f32 v221, v221, -v125, -v126
    s_nop 0
    v_permlane32_swap_b32 v164, v165
    v_permlane32_swap_b32 v220, v221
    v_max_f32 v164, v164, v165
    v_max_f32 v220, v220, v221
    v_mul_f32 v164, s43, v164
    v_mul_f32 v220, s43, v220
    v_mov_b32 v165, v164
    v_mov_b32 v221, v220
    s_nop 0
    v_permlane32_swap_b32 v164, v165
    v_permlane32_swap_b32 v220, v221
    v_pk_fma_f32 v[136:137], v[96:97], s[42:43], v[164:165] op_sel:[0,0,0] op_sel_hi:[0,1,1]
    v_pk_fma_f32 v[192:193], v[112:113], s[42:43], v[220:221] op_sel:[0,0,0] op_sel_hi:[0,1,1]
    v_pk_fma_f32 v[138:139], v[96:97], s[42:43], v[164:165] op_sel:[1,0,0] op_sel_hi:[1,1,1]
    v_pk_fma_f32 v[194:195], v[112:113], s[42:43], v[220:221] op_sel:[1,0,0] op_sel_hi:[1,1,1]
    v_pk_fma_f32 v[140:141], v[98:99], s[42:43], v[164:165] op_sel:[0,0,0] op_sel_hi:[0,1,1]
    v_pk_fma_f32 v[196:197], v[114:115], s[42:43], v[220:221] op_sel:[0,0,0] op_sel_hi:[0,1,1]
    v_pk_fma_f32 v[142:143], v[98:99], s[42:43], v[164:165] op_sel:[1,0,0] op_sel_hi:[1,1,1]
    v_pk_fma_f32 v[198:199], v[114:115], s[42:43], v[220:221] op_sel:[1,0,0] op_sel_hi:[1,1,1]
    v_pk_fma_f32 v[144:145], v[100:101], s[42:43], v[164:165] op_sel:[0,0,0] op_sel_hi:[0,1,1]
    v_pk_fma_f32 v[200:201], v[116:117], s[42:43], v[220:221] op_sel:[0,0,0] op_sel_hi:[0,1,1]
    v_pk_fma_f32 v[146:147], v[100:101], s[42:43], v[164:165] op_sel:[1,0,0] op_sel_hi:[1,1,1]
    v_pk_fma_f32 v[202:203], v[116:117], s[42:43], v[220:221] op_sel:[1,0,0] op_sel_hi:[1,1,1]
    v_pk_fma_f32 v[148:149], v[102:103], s[42:43], v[164:165] op_sel:[0,0,0] op_sel_hi:[0,1,1]
    v_pk_fma_f32 v[204:205], v[118:119], s[42:43], v[220:221] op_sel:[0,0,0] op_sel_hi:[0,1,1]
    v_pk_fma_f32 v[150:151], v[104:105], s[42:43], v[164:165] op_sel:[0,0,0] op_sel_hi:[0,1,1]
    v_pk_fma_f32 v[206:207], v[120:121], s[42:43], v[220:221] op_sel:[0,0,0] op_sel_hi:[0,1,1]
    v_pk_fma_f32 v[152:153], v[104:105], s[42:43], v[164:165] op_sel:[1,0,0] op_sel_hi:[1,1,1]
    v_pk_fma_f32 v[208:209], v[120:121], s[42:43], v[220:221] op_sel:[1,0,0] op_sel_hi:[1,1,1]
    v_pk_fma_f32 v[154:155], v[106:107], s[42:43], v[164:165] op_sel:[0,0,0] op_sel_hi:[0,1,1]
    v_pk_fma_f32 v[210:211], v[122:123], s[42:43], v[220:221] op_sel:[0,0,0] op_sel_hi:[0,1,1]
    v_pk_fma_f32 v[156:157], v[106:107], s[42:43], v[164:165] op_sel:[1,0,0] op_sel_hi:[1,1,1]
    v_pk_fma_f32 v[212:213], v[122:123], s[42:43], v[220:221] op_sel:[1,0,0] op_sel_hi:[1,1,1]
    v_pk_fma_f32 v[158:159], v[108:109], s[42:43], v[164:165] op_sel:[0,0,0] op_sel_hi:[0,1,1]
    v_pk_fma_f32 v[214:215], v[124:125], s[42:43], v[220:221] op_sel:[0,0,0] op_sel_hi:[0,1,1]
    v_pk_fma_f32 v[160:161], v[108:109], s[42:43], v[164:165] op_sel:[1,0,0] op_sel_hi:[1,1,1]
    v_pk_fma_f32 v[216:217], v[124:125], s[42:43], v[220:221] op_sel:[1,0,0] op_sel_hi:[1,1,1]
    v_pk_fma_f32 v[162:163], v[110:111], s[42:43], v[164:165] op_sel:[0,0,0] op_sel_hi:[0,1,1]
    v_pk_fma_f32 v[218:219], v[126:127], s[42:43], v[220:221] op_sel:[0,0,0] op_sel_hi:[0,1,1]
    v_exp_f32 v136, v136
    v_exp_f32 v192, v192
    v_exp_f32 v137, v137
    v_exp_f32 v193, v193
    v_exp_f32 v138, v138
    v_exp_f32 v194, v194
    v_exp_f32 v139, v139
    v_exp_f32 v195, v195
    v_exp_f32 v140, v140
    v_exp_f32 v196, v196
    v_exp_f32 v141, v141
    v_exp_f32 v197, v197
    v_exp_f32 v142, v142
    v_exp_f32 v198, v198
    v_exp_f32 v143, v143
    v_exp_f32 v199, v199
    v_exp_f32 v144, v144
    v_exp_f32 v200, v200
    v_exp_f32 v145, v145
    v_exp_f32 v201, v201
    v_exp_f32 v146, v146
    v_exp_f32 v202, v202
    v_exp_f32 v147, v147
    v_exp_f32 v203, v203
    v_exp_f32 v148, v148
    v_exp_f32 v204, v204
    v_exp_f32 v149, v149
    v_exp_f32 v205, v205
    v_exp_f32 v150, v150
    v_exp_f32 v206, v206
    v_exp_f32 v151, v151
    v_exp_f32 v207, v207
    v_exp_f32 v152, v152
    v_exp_f32 v208, v208
    v_exp_f32 v153, v153
    v_exp_f32 v209, v209
    v_exp_f32 v154, v154
    v_exp_f32 v210, v210
    v_exp_f32 v155, v155
    v_exp_f32 v211, v211
    v_exp_f32 v156, v156
    v_exp_f32 v212, v212
    v_exp_f32 v157, v157
    v_exp_f32 v213, v213
    v_exp_f32 v158, v158
    v_exp_f32 v214, v214
    v_exp_f32 v159, v159
    v_exp_f32 v215, v215
    v_exp_f32 v160, v160
    v_exp_f32 v216, v216
    v_exp_f32 v161, v161
    v_exp_f32 v217, v217
    v_exp_f32 v162, v162
    v_exp_f32 v218, v218
    v_exp_f32 v163, v163
    v_exp_f32 v219, v219
    v_pk_add_f32 v[164:165], v[136:137], v[138:139]
    v_pk_add_f32 v[220:221], v[192:193], v[194:195]
    v_pk_add_f32 v[166:167], v[140:141], v[142:143]
    v_pk_add_f32 v[222:223], v[196:197], v[198:199]
    v_pk_add_f32 v[164:165], v[164:165], v[144:145]
    v_pk_add_f32 v[220:221], v[220:221], v[200:201]
    v_pk_add_f32 v[166:167], v[166:167], v[146:147]
    v_pk_add_f32 v[222:223], v[222:223], v[202:203]
    v_pk_add_f32 v[164:165], v[164:165], v[148:149]
    v_pk_add_f32 v[220:221], v[220:221], v[204:205]
    v_pk_add_f32 v[166:167], v[166:167], v[150:151]
    v_pk_add_f32 v[222:223], v[222:223], v[206:207]
    v_pk_add_f32 v[164:165], v[164:165], v[152:153]
    v_pk_add_f32 v[220:221], v[220:221], v[208:209]
    v_pk_add_f32 v[166:167], v[166:167], v[154:155]
    v_pk_add_f32 v[222:223], v[222:223], v[210:211]
    v_pk_add_f32 v[164:165], v[164:165], v[156:157]
    v_pk_add_f32 v[220:221], v[220:221], v[212:213]
    v_pk_add_f32 v[166:167], v[166:167], v[158:159]
    v_pk_add_f32 v[222:223], v[222:223], v[214:215]
    v_pk_add_f32 v[164:165], v[164:165], v[160:161]
    v_pk_add_f32 v[220:221], v[220:221], v[216:217]
    v_pk_add_f32 v[166:167], v[166:167], v[162:163]
    v_pk_add_f32 v[222:223], v[222:223], v[218:219]
    v_pk_add_f32 v[164:165], v[164:165], v[166:167]
    v_pk_add_f32 v[220:221], v[220:221], v[222:223]
    s_nop 0
    v_permlane32_swap_b32 v164, v165
    v_permlane32_swap_b32 v220, v221
    v_add_f32 v164, v164, v165
    v_add_f32 v220, v220, v221
    v_rcp_f32 v164, v164
    v_rcp_f32 v220, v220
    v_mov_b32 v165, v164
    v_mov_b32 v221, v220
    s_nop 0
    v_permlane32_swap_b32 v164, v165
    v_permlane32_swap_b32 v220, v221
    v_pk_mul_f32 v[136:137], v[136:137], v[164:165]
    v_pk_mul_f32 v[192:193], v[192:193], v[220:221]
    v_pk_mul_f32 v[138:139], v[138:139], v[164:165]
    v_pk_mul_f32 v[194:195], v[194:195], v[220:221]
    v_pk_mul_f32 v[140:141], v[140:141], v[164:165]
    v_pk_mul_f32 v[196:197], v[196:197], v[220:221]
    v_pk_mul_f32 v[142:143], v[142:143], v[164:165]
    v_pk_mul_f32 v[198:199], v[198:199], v[220:221]
    v_pk_mul_f32 v[144:145], v[144:145], v[164:165]
    v_pk_mul_f32 v[200:201], v[200:201], v[220:221]
    v_pk_mul_f32 v[146:147], v[146:147], v[164:165]
    v_pk_mul_f32 v[202:203], v[202:203], v[220:221]
    v_pk_mul_f32 v[148:149], v[148:149], v[164:165]
    v_pk_mul_f32 v[204:205], v[204:205], v[220:221]
    v_pk_mul_f32 v[150:151], v[150:151], v[164:165]
    v_pk_mul_f32 v[206:207], v[206:207], v[220:221]
    v_pk_mul_f32 v[152:153], v[152:153], v[164:165]
    v_pk_mul_f32 v[208:209], v[208:209], v[220:221]
    v_pk_mul_f32 v[154:155], v[154:155], v[164:165]
    v_pk_mul_f32 v[210:211], v[210:211], v[220:221]
    v_pk_mul_f32 v[156:157], v[156:157], v[164:165]
    v_pk_mul_f32 v[212:213], v[212:213], v[220:221]
    v_pk_mul_f32 v[158:159], v[158:159], v[164:165]
    v_pk_mul_f32 v[214:215], v[214:215], v[220:221]
    v_pk_mul_f32 v[160:161], v[160:161], v[164:165]
    v_pk_mul_f32 v[216:217], v[216:217], v[220:221]
    v_pk_mul_f32 v[162:163], v[162:163], v[164:165]
    v_pk_mul_f32 v[218:219], v[218:219], v[220:221]
    v_cvt_pk_bf16_f32 v56, v136, v138
    v_cvt_pk_bf16_f32 v72, v192, v194
    v_cvt_pk_bf16_f32 v57, v140, v142
    v_cvt_pk_bf16_f32 v73, v196, v198
    v_cvt_pk_bf16_f32 v58, v144, v146
    v_cvt_pk_bf16_f32 v74, v200, v202
    v_cvt_pk_bf16_f32 v59, v148, 0
    v_cvt_pk_bf16_f32 v75, v204, 0
    v_cvt_pk_bf16_f32 v60, v150, v152
    v_cvt_pk_bf16_f32 v76, v206, v208
    v_cvt_pk_bf16_f32 v61, v154, v156
    v_cvt_pk_bf16_f32 v77, v210, v212
    v_cvt_pk_bf16_f32 v62, v158, v160
    v_cvt_pk_bf16_f32 v78, v214, v216
    v_cvt_pk_bf16_f32 v63, v162, 0
    v_cvt_pk_bf16_f32 v79, v218, 0
    v_cvt_pk_bf16_f32 v64, v137, v139
    v_cvt_pk_bf16_f32 v80, v193, v195
    v_cvt_pk_bf16_f32 v65, v141, v143
    v_cvt_pk_bf16_f32 v81, v197, v199
    v_cvt_pk_bf16_f32 v66, v145, v147
    v_cvt_pk_bf16_f32 v82, v201, v203
    v_cvt_pk_bf16_f32 v67, v149, 0
    v_cvt_pk_bf16_f32 v83, v205, 0
    v_cvt_pk_bf16_f32 v68, v151, v153
    v_cvt_pk_bf16_f32 v84, v207, v209
    v_cvt_pk_bf16_f32 v69, v155, v157
    v_cvt_pk_bf16_f32 v85, v211, v213
    v_cvt_pk_bf16_f32 v70, v159, v161
    v_cvt_pk_bf16_f32 v86, v215, v217
    v_cvt_pk_bf16_f32 v71, v163, 0
    v_cvt_pk_bf16_f32 v87, v219, 0
    s_lshl_b32 s98, s89, 12
    s_add_u32 s98, s98, 196608
    s_cmp_ge_u32 s44, 4
    s_cbranch_scc1 L_Q2
    s_add_u32 s53, s90, 4096
    v_and_b32 v1, 1, v0
    v_cmp_eq_u32_e64 vcc, 1, v1
    v_mov_b32 v2, 0x3f80
    v_mov_b32 v3, 0x3f800000
    v_cndmask_b32 v2, v2, v3, vcc
    v_bfe_u32 v1, v0, 1, 3
    v_cmp_eq_u32 vcc, 0, v1
    s_nop 1
    v_cndmask_b32 v200, 0, v2, vcc
    v_cmp_eq_u32 vcc, 1, v1
    s_nop 1
    v_cndmask_b32 v201, 0, v2, vcc
    v_cmp_eq_u32 vcc, 2, v1
    s_nop 1
    v_cndmask_b32 v202, 0, v2, vcc
    v_cmp_eq_u32 vcc, 3, v1
    s_nop 1
    v_cndmask_b32 v203, 0, v2, vcc
    v_cmp_eq_u32 vcc, 4, v1
    s_nop 1
    v_cndmask_b32 v204, 0, v2, vcc
    v_cmp_eq_u32 vcc, 5, v1
    s_nop 1
    v_cndmask_b32 v205, 0, v2, vcc
    v_cmp_eq_u32 vcc, 6, v1
    s_nop 1
    v_cndmask_b32 v206, 0, v2, vcc
    v_cmp_eq_u32 vcc, 7, v1
    s_nop 1
    v_cndmask_b32 v207, 0, v2, vcc
    s_mov_b32 s88, 200000
    s_nop 1
L_p1_45:
    buffer_load_dwordx4 v[96:99], v21, s[16:19], s90 offen offset:0 sc1
    buffer_load_dwordx4 v[100:103], v21, s[16:19], s90 offen offset:256 sc1
    buffer_load_dwordx4 v[104:107], v21, s[16:19], s90 offen offset:2048 sc1
    buffer_load_dwordx4 v[108:111], v21, s[16:19], s90 offen offset:2304 sc1
    buffer_load_dwordx4 v[112:115], v21, s[16:19], s53 offen offset:0 sc1
    buffer_load_dwordx4 v[116:119], v21, s[16:19], s53 offen offset:256 sc1
    buffer_load_dwordx4 v[120:123], v21, s[16:19], s53 offen offset:2048 sc1
    buffer_load_dwordx4 v[124:127], v21, s[16:19], s53 offen offset:2304 sc1
    s_waitcnt vmcnt(0)
    v_cmp_ne_u16_sdwa vcc, v99, s80 src0_sel:WORD_1 src1_sel:WORD_0
    v_cmp_ne_u16_sdwa s[56:57], v103, s80 src0_sel:WORD_1 src1_sel:WORD_0
    s_nop 0
    s_or_b64 vcc, vcc, s[56:57]
    v_cmp_ne_u16_sdwa s[56:57], v107, s80 src0_sel:WORD_1 src1_sel:WORD_0
    s_nop 0
    s_or_b64 vcc, vcc, s[56:57]
    v_cmp_ne_u16_sdwa s[56:57], v111, s80 src0_sel:WORD_1 src1_sel:WORD_0
    s_nop 0
    s_or_b64 vcc, vcc, s[56:57]
    v_cmp_ne_u16_sdwa s[56:57], v115, s80 src0_sel:WORD_1 src1_sel:WORD_0
    s_nop 0
    s_or_b64 vcc, vcc, s[56:57]
    v_cmp_ne_u16_sdwa s[56:57], v119, s80 src0_sel:WORD_1 src1_sel:WORD_0
    s_nop 0
    s_or_b64 vcc, vcc, s[56:57]
    v_cmp_ne_u16_sdwa s[56:57], v123, s80 src0_sel:WORD_1 src1_sel:WORD_0
    s_nop 0
    s_or_b64 vcc, vcc, s[56:57]
    v_cmp_ne_u16_sdwa s[56:57], v127, s80 src0_sel:WORD_1 src1_sel:WORD_0
    s_nop 0
    s_or_b64 vcc, vcc, s[56:57]
    s_nop 0
    s_cmp_eq_u64 vcc, 0
    s_cbranch_scc1 L_p1d_46
    s_sub_u32 s88, s88, 1
    s_cmp_lg_u32 s88, 0
    s_cbranch_scc1 L_p1_45
L_p1d_46:
    v_mfma_f32_16x16x32_bf16 v[192:195], v[200:203], v[96:99], 0
    v_mfma_f32_16x16x32_bf16 v[192:195], v[204:207], v[100:103], v[192:195]
    v_mfma_f32_16x16x32_bf16 v[192:195], v[200:203], v[104:107], v[192:195]
    v_mfma_f32_16x16x32_bf16 v[192:195], v[204:207], v[108:111], v[192:195]
    v_mfma_f32_16x16x32_bf16 v[192:195], v[200:203], v[112:115], v[192:195]
    v_mfma_f32_16x16x32_bf16 v[192:195], v[204:207], v[116:119], v[192:195]
    v_mfma_f32_16x16x32_bf16 v[192:195], v[200:203], v[120:123], v[192:195]
    v_mfma_f32_16x16x32_bf16 v[192:195], v[204:207], v[124:127], v[192:195]
    s_nop 7
    v_cvt_pk_bf16_f32 v12, v192, v193
    v_cvt_pk_bf16_f32 v13, v194, v195
    ds_bpermute_b32 v8, v20, v12
    ds_bpermute_b32 v9, v20, v13
    ds_bpermute_b32 v10, v19, v12
    ds_bpermute_b32 v11, v19, v13
    s_waitcnt lgkmcnt(0)
    v_and_b32 v11, 0xffff, v11
    v_or_b32 v11, s50, v11
    s_not_b64 exec, s[58:59]
    buffer_store_dwordx4 v[8:11], v7, s[16:19], s91 offen sc1
    s_mov_b64 exec, -1
L_Q2:
    s_nop 1
    s_barrier
    s_lshl_b32 s90, s45, 6
    s_add_u32 s90, s90, s89
    s_lshl_b32 s90, s90, 11
    s_add_u32 s90, s90, 2097152
    s_mov_b32 s53, 897988541
    s_lshl_b32 s99, s45, 4
    s_add_u32 s99, s99, s89
    s_lshl_b32 s99, s99, 7
    s_add_u32 s99, s99, 147456
    s_mov_b32 s88, 200000
    s_nop 1
L_p2_47:
    buffer_load_dwordx4 v[136:139], v7, s[16:19], s98 offen offset:0 sc1
    buffer_load_dwordx4 v[140:143], v7, s[16:19], s98 offen offset:1024 sc1
    buffer_load_dwordx4 v[144:147], v7, s[16:19], s98 offen offset:2048 sc1
    buffer_load_dwordx4 v[148:151], v7, s[16:19], s98 offen offset:3072 sc1
    s_waitcnt vmcnt(0)
    v_cmp_ne_u16_sdwa vcc, v139, s80 src0_sel:WORD_1 src1_sel:WORD_0
    v_cmp_ne_u16_sdwa s[56:57], v143, s80 src0_sel:WORD_1 src1_sel:WORD_0
    s_nop 0
    s_or_b64 vcc, vcc, s[56:57]
    v_cmp_ne_u16_sdwa s[56:57], v147, s80 src0_sel:WORD_1 src1_sel:WORD_0
    s_nop 0
    s_or_b64 vcc, vcc, s[56:57]
    v_cmp_ne_u16_sdwa s[56:57], v151, s80 src0_sel:WORD_1 src1_sel:WORD_0
    s_nop 0
    s_or_b64 vcc, vcc, s[56:57]
    s_nop 0
    s_cmp_eq_u64 vcc, 0
    s_cbranch_scc1 L_p2d_48
    s_sub_u32 s88, s88, 1
    s_cmp_lg_u32 s88, 0
    s_cbranch_scc1 L_p2_47
L_p2d_48:
    v_mfma_f32_32x32x16_bf16 v[192:207], v[136:139], v[24:27], 0
    v_mfma_f32_32x32x16_bf16 v[192:207], v[140:143], v[28:31], v[192:207]
    v_mfma_f32_32x32x16_bf16 v[192:207], v[144:147], v[32:35], v[192:207]
    v_mfma_f32_32x32x16_bf16 v[192:207], v[148:151], v[36:39], v[192:207]
    v_mfma_f32_32x32x16_bf16 v[224:239], v[136:139], v[56:59], 0
    v_mfma_f32_32x32x16_bf16 v[224:239], v[140:143], v[60:63], v[224:239]
    v_mfma_f32_32x32x16_bf16 v[224:239], v[144:147], v[64:67], v[224:239]
    v_mfma_f32_32x32x16_bf16 v[224:239], v[148:151], v[68:71], v[224:239]
    v_mfma_f32_32x32x16_bf16 v[208:223], v[136:139], v[40:43], 0
    s_nop 6
    v_add_f32 v8, s53, v199
    v_rcp_f32 v8, v8
    s_nop 0
    v_mul_f32 v8, v8, v168
    v_mul_f32 v192, v8, v192
    v_mul_f32 v193, v8, v193
    v_mul_f32 v194, v8, v194
    v_mul_f32 v195, v8, v195
    v_mfma_f32_32x32x16_bf16 v[208:223], v[140:143], v[44:47], v[208:223]
    v_mul_f32 v196, v8, v196
    v_mul_f32 v197, v8, v197
    v_mul_f32_e64 v198, v8, v198
    v_cvt_pk_bf16_f32 v96, v192, v193
    v_cvt_pk_bf16_f32 v97, v194, v195
    v_cvt_pk_bf16_f32 v98, v196, v197
    v_cvt_pk_bf16_f32 v99, v198, 0
    v_mfma_f32_32x32x16_bf16 v[208:223], v[144:147], v[48:51], v[208:223]
    v_or_b32 v99, s50, v99
    s_add_u32 s52, s90, 0
    buffer_store_dwordx4 v[96:99], v7, s[16:19], s52 offen offset:0 sc1
    v_mul_f32 v200, v8, v200
    v_mul_f32 v201, v8, v201
    v_mul_f32 v202, v8, v202
    v_mul_f32 v203, v8, v203
    v_mul_f32_e64 v204, v8, v204
    v_mfma_f32_32x32x16_bf16 v[208:223], v[148:151], v[52:55], v[208:223]
    v_mul_f32 v205, v8, v205
    v_mul_f32 v206, v8, v206
    v_cvt_pk_bf16_f32 v100, v200, v201
    v_cvt_pk_bf16_f32 v101, v202, v203
    v_cvt_pk_bf16_f32 v102, v204, v205
    v_cvt_pk_bf16_f32 v103, v206, 0
    v_or_b32 v103, s50, v103
    s_add_u32 s52, s90, 0
    buffer_store_dwordx4 v[100:103], v7, s[16:19], s52 offen offset:1024 sc1
    v_mfma_f32_32x32x16_bf16 v[240:255], v[136:139], v[72:75], 0
    v_add_f32 v10, s53, v231
    v_rcp_f32 v10, v10
    s_nop 0
    v_mul_f32 v10, v10, v170
    v_mul_f32 v224, v10, v224
    v_mul_f32 v225, v10, v225
    v_mul_f32 v226, v10, v226
    v_mul_f32 v227, v10, v227
    v_mfma_f32_32x32x16_bf16 v[240:255], v[140:143], v[76:79], v[240:255]
    v_mul_f32 v228, v10, v228
    v_mul_f32 v229, v10, v229
    v_mul_f32_e64 v230, v10, v230
    v_cvt_pk_bf16_f32 v112, v224, v225
    v_cvt_pk_bf16_f32 v113, v226, v227
    v_cvt_pk_bf16_f32 v114, v228, v229
    v_cvt_pk_bf16_f32 v115, v230, 0
    v_mfma_f32_32x32x16_bf16 v[240:255], v[144:147], v[80:83], v[240:255]
    v_or_b32_e64 v115, s50, v115
    s_add_u32 s52, s90, 65536
    buffer_store_dwordx4 v[112:115], v7, s[16:19], s52 offen offset:0 sc1
    v_mul_f32 v232, v10, v232
    v_mul_f32 v233, v10, v233
    v_mul_f32 v234, v10, v234
    v_mul_f32 v235, v10, v235
    v_mul_f32_e64 v236, v10, v236
    v_mfma_f32_32x32x16_bf16 v[240:255], v[148:151], v[84:87], v[240:255]
    v_mul_f32 v237, v10, v237
    v_mul_f32 v238, v10, v238
    v_cvt_pk_bf16_f32 v116, v232, v233
    v_cvt_pk_bf16_f32 v117, v234, v235
    v_cvt_pk_bf16_f32 v118, v236, v237
    v_cvt_pk_bf16_f32 v119, v238, 0
    v_or_b32_e64 v119, s50, v119
    s_add_u32 s52, s90, 65536
    buffer_store_dwordx4 v[116:119], v7, s[16:19], s52 offen offset:1024 sc1
    v_mov_b32 v1, s49
    v_mov_b32_e64 v2, 0
    s_mov_b64 exec, 1
    buffer_store_dword v1, v2, s[16:19], s99 offen sc1
    s_mov_b64 exec, -1
    v_add_f32 v9, s53, v215
    v_rcp_f32 v9, v9
    s_nop 0
    v_mul_f32 v9, v9, v169
    v_mul_f32 v208, v9, v208
    v_mul_f32 v209, v9, v209
    v_mul_f32 v210, v9, v210
    v_mul_f32 v211, v9, v211
    v_mul_f32 v212, v9, v212
    v_mul_f32 v213, v9, v213
    v_mul_f32 v214, v9, v214
    v_cvt_pk_bf16_f32 v104, v208, v209
    v_cvt_pk_bf16_f32 v105, v210, v211
    v_cvt_pk_bf16_f32 v106, v212, v213
    v_cvt_pk_bf16_f32 v107, v214, 0
    v_or_b32_e64 v107, s50, v107
    s_add_u32 s52, s90, 32768
    buffer_store_dwordx4 v[104:107], v7, s[16:19], s52 offen offset:0 sc1
    v_mul_f32 v216, v9, v216
    v_mul_f32 v217, v9, v217
    v_mul_f32 v218, v9, v218
    v_mul_f32 v219, v9, v219
    v_mul_f32 v220, v9, v220
    v_mul_f32 v221, v9, v221
    v_mul_f32_e64 v222, v9, v222
    v_cvt_pk_bf16_f32 v108, v216, v217
    v_cvt_pk_bf16_f32 v109, v218, v219
    v_cvt_pk_bf16_f32 v110, v220, v221
    v_cvt_pk_bf16_f32 v111, v222, 0
    v_or_b32_e64 v111, s50, v111
    s_add_u32 s52, s90, 32768
    buffer_store_dwordx4 v[108:111], v7, s[16:19], s52 offen offset:1024 sc1
    v_add_f32 v11, s53, v247
    v_rcp_f32 v11, v11
    s_nop 0
    v_mul_f32 v11, v11, v171
    v_mul_f32 v240, v11, v240
    v_mul_f32 v241, v11, v241
    v_mul_f32 v242, v11, v242
    v_mul_f32 v243, v11, v243
    v_mul_f32 v244, v11, v244
    v_mul_f32 v245, v11, v245
    v_mul_f32_e64 v246, v11, v246
    v_cvt_pk_bf16_f32 v120, v240, v241
    v_cvt_pk_bf16_f32 v121, v242, v243
    v_cvt_pk_bf16_f32 v122, v244, v245
    v_cvt_pk_bf16_f32 v123, v246, 0
    v_or_b32_e64 v123, s50, v123
    s_add_u32 s52, s90, 98304
    buffer_store_dwordx4 v[120:123], v7, s[16:19], s52 offen offset:0 sc1
    v_mul_f32 v248, v11, v248
    v_mul_f32 v249, v11, v249
    v_mul_f32 v250, v11, v250
    v_mul_f32 v251, v11, v251
    v_mul_f32 v252, v11, v252
    v_mul_f32 v253, v11, v253
    v_mul_f32_e64 v254, v11, v254
    v_cvt_pk_bf16_f32 v124, v248, v249
    v_cvt_pk_bf16_f32 v125, v250, v251
    v_cvt_pk_bf16_f32 v126, v252, v253
    v_cvt_pk_bf16_f32 v127, v254, 0
    v_or_b32_e64 v127, s50, v127
    s_add_u32 s52, s90, 98304
    buffer_store_dwordx4 v[124:127], v7, s[16:19], s52 offen offset:1024 sc1
    s_cmp_lg_u32 s2, 0
    s_cbranch_scc1 L_Qend
    s_cmp_lg_u32 s44, 0
    s_cbranch_scc1 L_Qend
    v_lshlrev_b32_e64 v1, 7, v0
    s_mov_b32 s90, 131072
    s_mov_b32 s91, 139264
    s_mov_b32 s52, 147456
    s_mov_b32 s53, 155648
    s_mov_b32 s54, 163840
    s_mov_b32 s55, 172032
    s_mov_b32 s88, 200000
    s_nop 1
L_ep_49:
    buffer_load_dword v8, v1, s[16:19], s90 offen sc1
    buffer_load_dword v9, v1, s[16:19], s91 offen sc1
    buffer_load_dword v10, v1, s[16:19], s52 offen sc1
    buffer_load_dword v11, v1, s[16:19], s53 offen sc1
    buffer_load_dword v12, v1, s[16:19], s54 offen sc1
    buffer_load_dword v13, v1, s[16:19], s55 offen sc1
    s_waitcnt vmcnt(0)
    v_cmp_ne_u32_e64 vcc, s49, v8
    v_cmp_ne_u32 s[56:57], s49, v9
    s_nop 0
    s_or_b64 vcc, vcc, s[56:57]
    v_cmp_ne_u32 s[56:57], s49, v10
    s_nop 0
    s_or_b64 vcc, vcc, s[56:57]
    v_cmp_ne_u32 s[56:57], s49, v11
    s_nop 0
    s_or_b64 vcc, vcc, s[56:57]
    v_cmp_ne_u32 s[56:57], s49, v12
    s_nop 0
    s_or_b64 vcc, vcc, s[56:57]
    v_cmp_ne_u32 s[56:57], s49, v13
    s_nop 0
    s_or_b64 vcc, vcc, s[56:57]
    s_nop 0
    s_cmp_eq_u64 vcc, 0
    s_cbranch_scc1 L_epd_50
    s_sub_u32 s88, s88, 1
    s_cmp_lg_u32 s88, 0
    s_cbranch_scc1 L_ep_49
L_epd_50:
    s_mov_b32 s90, 0
    v_mov_b32 v1, s49
    v_mov_b32 v2, 0
    s_mov_b64 exec, 1
    buffer_store_dword v1, v2, s[16:19], s90 offen sc1
    s_mov_b64 exec, -1
L_Qend:
    s_nop 1
L_end:
    s_endpgm
L_codeend:
.section .rodata,"a"
.p2align 6
.amdhsa_kernel gated_mix__linear_kernel_hedgehog__dense_activation_mish__prompt_kernel
  .amdhsa_next_free_vgpr 256
  .amdhsa_next_free_sgpr 102
  .amdhsa_accum_offset 256
  .amdhsa_group_segment_fixed_size 0
  .amdhsa_kernarg_size 96
  .amdhsa_user_sgpr_count 2
  .amdhsa_user_sgpr_kernarg_segment_ptr 1
  .amdhsa_system_sgpr_workgroup_id_x 1
.end_amdhsa_kernel
```
